```python
import torch

def _softmax(x, axis=-1):
    return torch.softmax(x, dim=axis)

def _gelu(x):
    return torch.nn.functional.gelu(x, approximate='tanh')

def _silu(x):
    return torch.nn.functional.silu(x)

def _sigmoid(x):
    return torch.sigmoid(x)

def _layernorm(x, axis=-1, eps=1e-05):
    m = x.mean(dim=axis, keepdim=True)
    v = x.var(dim=axis, keepdim=True, unbiased=False)
    return (x - m) / torch.sqrt(v + eps)

def _scatter_add(tgt, idx, src, axis=0):
    return tgt.clone().index_add_(axis, idx, src)

def _segment_sum(src, seg, n):
    out = torch.zeros((n,) + src.shape[1:], dtype=src.dtype)
    return out.index_add_(0, seg, src)

def _pad(x, pw):
    flat = tuple((v for pair in reversed(pw) for v in pair))
    return torch.nn.functional.pad(x, flat)
kernel_name = 'adaLN_cond__softmax_full_mha__mixer_gmlp__prompt'

def setup_inputs():

    _w = lambda a: (lambda t: t.to(torch.bfloat16) if t.is_floating_point() else t)(torch.as_tensor(a))

    def _A_setup():
        B, S, D = (1, 2048, 576)
        return {'x': _w((lambda *s: torch.randn(*s, dtype=torch.bfloat16) * 0.05)(B, S, D)), 'wqkv': _w((lambda *s: torch.randn(*s, dtype=torch.bfloat16) * 0.05)(D, 3 * D)), 'wo': _w((lambda *s: torch.randn(*s, dtype=torch.bfloat16) * 0.05)(D, D))}
    _A_in = _A_setup()

    def _B_setup():
        B, S, D, F = (1, 2048, 576, 4608)
        Fh = F // 2
        return {'x': _w((lambda *s: torch.randn(*s, dtype=torch.bfloat16) * 0.05)(B, S, D)), 'w_in': _w((lambda *s: torch.randn(*s, dtype=torch.bfloat16) * 0.4)(D, 2 * Fh)), 'w_sp': _w(0.01 * (lambda *s: torch.randn(*s, dtype=torch.bfloat16) * 0.4)(S, S)), 'b_sp': _w(1.0 + 0.01 * (lambda *s: torch.randn(*s, dtype=torch.bfloat16) * 0.05)(S)), 'w_out': _w((lambda *s: torch.randn(*s, dtype=torch.bfloat16) * 0.05)(Fh, D))}
    _B_in = _B_setup()
    return {'A_x': _A_in['x'], 'A_wqkv': _A_in['wqkv'], 'A_wo': _A_in['wo'], 'B_x': _B_in['x'], 'B_w_in': _B_in['w_in'], 'B_w_sp': _B_in['w_sp'], 'B_b_sp': _B_in['b_sp'], 'B_w_out': _B_in['w_out'], 'c': _w((lambda *s: torch.randn(*s, dtype=torch.bfloat16) * 0.1)(1, 576) * 8.0), 'w_mod': _w((lambda *s: torch.randn(*s, dtype=torch.bfloat16) * 0.1)(576, 6 * 576) * 576 ** (-0.5) * 8.0)}

def reference(A_x, A_wqkv, A_wo, B_x, B_w_in, B_w_sp, B_b_sp, B_w_out, c, w_mod):

    def _A_ref(x, wqkv, wo):
        B, S, D = x.shape
        H = 32
        Dh = D // H
        qkv = (lambda x, *d: x.permute(*d))((x @ wqkv).reshape(B, S, 3, H, Dh), 2, 0, 3, 1, 4)
        q, k, v = (qkv[0], qkv[1], qkv[2])
        scale = Dh ** (-0.5)
        scores = torch.einsum('bhqd,bhkd->bhqk', q, k) * scale
        p = _softmax(scores, axis=-1)
        o = torch.einsum('bhqk,bhkd->bhqd', p, v)
        return (lambda x, *d: x.permute(*d))(o, 0, 2, 1, 3).reshape(B, S, D) @ wo

    def _B_ref(x, w_in, w_sp, b_sp, w_out):
        B, S, D = x.shape
        F = w_in.shape[-1]
        Fh = F // 2
        z = _gelu(torch.einsum('bsd,df->bsf', x, w_in))
        z1 = z[..., :Fh].clone()
        z2 = _layernorm(z[..., Fh:], axis=-1)
        g = torch.einsum('ts,bsf->btf', w_sp, z2) + b_sp[None, :, None]
        return torch.einsum('bsf,fd->bsd', z1 * g, w_out)
    x = A_x
    mod = (_silu(c) @ w_mod).reshape(c.shape[0], 6, 1, -1)
    sa, ca, ga, sb, cb, gb = (mod[:, 0].clone(), mod[:, 1].clone(), mod[:, 2].clone(), mod[:, 3].clone(), mod[:, 4].clone(), mod[:, 5].clone())
    h = _layernorm(x, axis=-1) * (1 + ca) + sa
    x = x + ga * _A_ref(h, A_wqkv, A_wo)
    h = _layernorm(x, axis=-1) * (1 + cb) + sb
    x = x + gb * _B_ref(h, B_w_in, B_w_sp, B_b_sp, B_w_out)
    return x
```

```asm
; @launch grid=(256,1,1) block=(512,1,1) lds=163840
.amdgcn_target "amdgcn-amd-amdhsa--gfx950"
.text
.globl adaLN_cond__softmax_full_mha__mixer_gmlp__prompt_kernel
.p2align 8
.type adaLN_cond__softmax_full_mha__mixer_gmlp__prompt_kernel,@function
adaLN_cond__softmax_full_mha__mixer_gmlp__prompt_kernel:
    s_cmp_ge_u32 s2, 256
    s_cbranch_scc1 L_end
    s_load_dwordx16 s[68:83], s[0:1], 0
    s_load_dwordx8 s[84:91], s[0:1], 64
    s_load_dwordx2 s[92:93], s[0:1], 96
    v_lshrrev_b32 v2, 6, v0
    v_and_b32 v1, 63, v0
    v_readfirstlane_b32 s20, v2
    s_getpc_b64 s[4:5]
    s_and_b32 s4, s4, 0xffffff00
    s_mov_b32 s6, L_end-adaLN_cond__softmax_full_mha__mixer_gmlp__prompt_kernel+4
    s_mov_b32 s7, 0x20000
    s_cmp_eq_u32 s20, 7
    s_cbranch_scc0 L_nocpf
    s_lshr_b32 s10, s2, 3
    s_lshl_b32 s10, s10, 11
    v_lshlrev_b32 v2, 4, v1
    buffer_load_dwordx4 v[240:243], v2, s[4:7], s10 offen
    buffer_load_dwordx4 v[240:243], v2, s[4:7], s10 offen offset:1024
L_nocpf:
    s_waitcnt lgkmcnt(0)
    s_add_u32 s96, s92, 41914368
    s_addc_u32 s97, s93, 0
    s_mov_b32 s98, 262144
    s_mov_b32 s99, 0x20000
    s_sub_u32 s10, s2, 0
    s_cmp_lt_u32 s10, 180
    s_cselect_b32 s64, 1, 0
    s_cmp_ge_u32 s20, 4
    s_cbranch_scc0 L_p0_job
    v_mov_b32 v2, 163776
    v_mov_b32 v4, 0
    v_mov_b32 v5, 0
    v_mov_b32 v6, 0
    v_mov_b32 v7, 0
    ds_write_b128 v2, v[4:7]
    ds_write_b128 v2, v[4:7] offset:16
    ds_write_b128 v2, v[4:7] offset:32
    ds_write_b128 v2, v[4:7] offset:48
    s_mov_b32 s60, s90
    s_mov_b32 s61, s91
    s_mov_b32 s62, 256
    s_mov_b32 s63, 0x20000
    s_cmp_eq_u32 s2, 0
    s_cselect_b32 s10, s20, 0
    s_cmp_eq_u32 s10, 4
    s_cbranch_scc0 L_p0_nt
    s_memrealtime s[10:11]
    s_waitcnt lgkmcnt(0)
    s_or_b32 s10, s10, 1
    v_mov_b32 v6, s10
    s_mov_b64 exec, 1
    buffer_store_dword v6, v4, s[60:63], 0 offen sc1
    s_mov_b64 exec, -1
L_p0_nt:
    s_bfe_u32 s10, s2, 0x20001
    s_lshl_b32 s10, s10, 3
    s_bfe_u32 s11, s2, 0x30003
    s_add_u32 s10, s10, s11
    s_lshl_b32 s10, s10, 2
    s_sub_u32 s11, s20, 4
    s_add_u32 s10, s10, s11
    s_mul_i32 s10, s10, 18432
    s_mul_i32 s11, s11, 18432
    v_lshlrev_b32 v2, 4, v1
    s_mov_b32 s24, s68
    s_mov_b32 s25, s69
    s_mov_b32 s26, 2359296
    s_mov_b32 s27, 0x20000
    s_and_b32 s12, s2, 1
    s_lshl_b32 s12, s12, 2
    s_lshr_b32 s13, s2, 6
    s_add_u32 s12, s12, s13
    s_mul_i32 s12, s12, 9
    s_lshr_b32 s12, s12, 2
    s_lshl_b32 s12, s12, 10
    s_mov_b32 s14, 18
    s_waitcnt lgkmcnt(0)
    s_cmp_eq_u32 s64, 0
    s_cbranch_scc1 L_p0_x1
    s_barrier
L_p0_x1:
    s_add_u32 m0, s11, s12
    s_add_u32 s13, s10, s12
    s_add_u32 s12, s12, 1024
    buffer_load_dwordx4 v2, s[24:27], s13 offen lds
    s_cmp_eq_u32 s12, 18432
    s_cselect_b32 s12, 0, s12
    s_sub_u32 s14, s14, 1
    s_cmp_lg_u32 s14, 0
    s_cbranch_scc1 L_p0_x1
    s_cmp_eq_u32 s64, 0
    s_cbranch_scc0 L_p0_x2
    s_barrier
L_p0_x2:
    s_waitcnt vmcnt(0) lgkmcnt(0)
    s_sub_u32 s65, s2, 148
    s_lshl_b32 s65, s65, 5
    s_cmp_ge_u32 s2, 184
    s_cbranch_scc0 L_p0_xb
    v_and_b32 v2, 255, v0
    v_lshrrev_b32 v3, 2, v2
    v_and_b32 v4, 3, v2
    v_mul_u32_u24 v5, 6912, v3
    v_lshl_add_u32 v5, v4, 4, v5
    v_lshlrev_b32 v3, 1, v3
    s_lshl_b32 s12, s65, 1
    s_mov_b32 s24, s84
    s_mov_b32 s25, s85
    s_mov_b32 s26, 1152
    s_mov_b32 s27, 0x20000
    s_mov_b32 s28, s86
    s_mov_b32 s29, s87
    s_mov_b32 s30, 3981312
    s_mov_b32 s31, 0x20000
    buffer_load_ushort v8, v3, s[24:27], 0 offen offset:0
    buffer_load_ushort v10, v3, s[24:27], 0 offen offset:128
    buffer_load_ushort v12, v3, s[24:27], 0 offen offset:256
    buffer_load_ushort v14, v3, s[24:27], 0 offen offset:384
    buffer_load_ushort v16, v3, s[24:27], 0 offen offset:512
    buffer_load_ushort v18, v3, s[24:27], 0 offen offset:640
    buffer_load_ushort v20, v3, s[24:27], 0 offen offset:768
    buffer_load_ushort v22, v3, s[24:27], 0 offen offset:896
    buffer_load_ushort v24, v3, s[24:27], 0 offen offset:1024
    buffer_load_dwordx4 v[28:31], v5, s[28:31], s12 offen
    s_add_u32 s12, s12, 442368
    buffer_load_dwordx4 v[32:35], v5, s[28:31], s12 offen
    s_add_u32 s12, s12, 442368
    buffer_load_dwordx4 v[36:39], v5, s[28:31], s12 offen
    s_add_u32 s12, s12, 442368
    buffer_load_dwordx4 v[40:43], v5, s[28:31], s12 offen
    s_add_u32 s12, s12, 442368
    buffer_load_dwordx4 v[44:47], v5, s[28:31], s12 offen
    s_add_u32 s12, s12, 442368
    buffer_load_dwordx4 v[48:51], v5, s[28:31], s12 offen
    s_add_u32 s12, s12, 442368
    buffer_load_dwordx4 v[52:55], v5, s[28:31], s12 offen
    s_add_u32 s12, s12, 442368
    buffer_load_dwordx4 v[56:59], v5, s[28:31], s12 offen
    s_add_u32 s12, s12, 442368
    buffer_load_dwordx4 v[60:63], v5, s[28:31], s12 offen
    s_add_u32 s12, s12, 442368
    s_branch L_p0_xb
L_p0_job:
    s_cmp_ge_u32 s2, 180
    s_cbranch_scc0 L_p0_j1
    s_barrier
    s_mov_b32 s60, s90
    s_mov_b32 s61, s91
    s_mov_b32 s62, 256
    s_mov_b32 s63, 0x20000
    s_mov_b32 s11, 131072
    v_mov_b32 v11, 0
L_m_tk1:
    buffer_load_dword v10, v11, s[60:63], 0 offen sc1
    s_sub_u32 s11, s11, 1
    s_waitcnt vmcnt(0)
    v_readfirstlane_b32 s3, v10
    s_cmp_eq_u32 s11, 0
    s_cbranch_scc1 L_m_te2
    s_cmp_eq_u32 s3, 0
    s_cbranch_scc1 L_m_tk1
L_m_te2:
    s_branch L_p0_xb
L_p0_j1:
    s_cmp_ge_u32 s2, 72
    s_cbranch_scc1 L_p0_tr
    s_and_b32 s10, s2, 7
    s_lshl_b32 s10, s10, 1
    s_bfe_u32 s11, s2, 0x10003
    s_add_u32 s10, s10, s11
    s_and_b32 s11, s2, 48
    s_add_u32 s10, s10, s11
    s_cmp_lt_u32 s2, 64
    s_cselect_b32 s10, s10, s2
    s_cmp_ge_u32 s10, 36
    s_cselect_b32 s66, 288, 0
    s_cselect_b32 s11, 36, 0
    s_sub_u32 s65, s10, s11
    s_lshl_b32 s65, s65, 5
    v_and_b32 v2, 255, v0
    v_lshrrev_b32 v3, 2, v2
    v_and_b32 v4, 3, v2
    v_mul_u32_u24 v5, 6912, v3
    v_lshl_add_u32 v5, v4, 4, v5
    v_lshlrev_b32 v3, 1, v3
    s_lshl_b32 s12, s65, 1
    s_lshl_b32 s10, s66, 1
    s_mul_i32 s11, s66, 6912
    s_add_u32 s24, s84, s10
    s_addc_u32 s25, s85, 0
    s_mov_b32 s26, 576
    s_mov_b32 s27, 0x20000
    s_add_u32 s28, s86, s11
    s_addc_u32 s29, s87, 0
    s_mov_b32 s30, 1990656
    s_mov_b32 s31, 0x20000
    buffer_load_ushort v8, v3, s[24:27], 0 offen offset:0
    buffer_load_ushort v10, v3, s[24:27], 0 offen offset:128
    buffer_load_ushort v12, v3, s[24:27], 0 offen offset:256
    buffer_load_ushort v14, v3, s[24:27], 0 offen offset:384
    buffer_load_ushort v16, v3, s[24:27], 0 offen offset:512
    buffer_load_dwordx4 v[28:31], v5, s[28:31], s12 offen
    s_add_u32 s12, s12, 442368
    buffer_load_dwordx4 v[32:35], v5, s[28:31], s12 offen
    s_add_u32 s12, s12, 442368
    buffer_load_dwordx4 v[36:39], v5, s[28:31], s12 offen
    s_add_u32 s12, s12, 442368
    buffer_load_dwordx4 v[40:43], v5, s[28:31], s12 offen
    s_add_u32 s12, s12, 442368
    buffer_load_dwordx4 v[44:47], v5, s[28:31], s12 offen
    s_add_u32 s12, s12, 442368
    s_mov_b32 s60, s90
    s_mov_b32 s61, s91
    s_mov_b32 s62, 256
    s_mov_b32 s63, 0x20000
    v_mov_b32 v6, 0
    buffer_load_dword v25, v6, s[60:63], 0 offen sc1
    s_barrier
    s_add_u32 s24, s92, 438272
    s_addc_u32 s25, s93, 0
    s_mov_b32 s26, 18432
    s_mov_b32 s27, 0x20000
    s_waitcnt vmcnt(6)
    v_lshlrev_b32 v8, 16, v8
    v_lshlrev_b32 v10, 16, v10
    v_lshlrev_b32 v12, 16, v12
    v_lshlrev_b32 v14, 16, v14
    v_lshlrev_b32 v16, 16, v16
    v_mul_f32 v72, 3216550459, v8
    v_mul_f32 v73, 3216550459, v10
    v_mul_f32 v74, 3216550459, v12
    v_mul_f32 v75, 3216550459, v14
    v_mul_f32 v76, 3216550459, v16
    v_exp_f32 v72, v72
    v_exp_f32 v73, v73
    v_exp_f32 v74, v74
    v_exp_f32 v75, v75
    v_exp_f32 v76, v76
    v_add_f32 v72, 1.0, v72
    v_add_f32 v73, 1.0, v73
    v_add_f32 v74, 1.0, v74
    v_add_f32 v75, 1.0, v75
    v_add_f32 v76, 1.0, v76
    v_rcp_f32 v72, v72
    v_rcp_f32 v73, v73
    v_rcp_f32 v74, v74
    v_rcp_f32 v75, v75
    v_rcp_f32 v76, v76
    v_mul_f32 v8, v8, v72
    v_mul_f32 v10, v10, v73
    v_mul_f32 v12, v12, v74
    v_mul_f32 v14, v14, v75
    v_mul_f32 v16, v16, v76
    v_cvt_pk_bf16_f32 v8, v8, v8
    v_cvt_pk_bf16_f32 v10, v10, v10
    v_cvt_pk_bf16_f32 v12, v12, v12
    v_cvt_pk_bf16_f32 v14, v14, v14
    v_cvt_pk_bf16_f32 v16, v16, v16
    v_lshlrev_b32 v8, 16, v8
    v_lshlrev_b32 v10, 16, v10
    v_lshlrev_b32 v12, 16, v12
    v_lshlrev_b32 v14, 16, v14
    v_lshlrev_b32 v16, 16, v16
    s_waitcnt vmcnt(5)
    v_lshlrev_b32 v72, 16, v28
    v_and_b32 v73, 0xffff0000, v28
    v_lshlrev_b32 v74, 16, v29
    v_and_b32 v75, 0xffff0000, v29
    v_lshlrev_b32 v76, 16, v30
    v_and_b32 v77, 0xffff0000, v30
    v_lshlrev_b32 v78, 16, v31
    v_and_b32 v79, 0xffff0000, v31
    v_pk_mul_f32 v[64:65], v[72:73], v[8:9] op_sel_hi:[1,0]
    v_pk_mul_f32 v[66:67], v[74:75], v[8:9] op_sel_hi:[1,0]
    v_pk_mul_f32 v[68:69], v[76:77], v[8:9] op_sel_hi:[1,0]
    v_pk_mul_f32 v[70:71], v[78:79], v[8:9] op_sel_hi:[1,0]
    s_waitcnt vmcnt(4)
    v_lshlrev_b32 v72, 16, v32
    v_and_b32 v73, 0xffff0000, v32
    v_lshlrev_b32 v74, 16, v33
    v_and_b32 v75, 0xffff0000, v33
    v_lshlrev_b32 v76, 16, v34
    v_and_b32 v77, 0xffff0000, v34
    v_lshlrev_b32 v78, 16, v35
    v_and_b32 v79, 0xffff0000, v35
    v_pk_fma_f32 v[64:65], v[72:73], v[10:11], v[64:65] op_sel_hi:[1,0,1]
    v_pk_fma_f32 v[66:67], v[74:75], v[10:11], v[66:67] op_sel_hi:[1,0,1]
    v_pk_fma_f32 v[68:69], v[76:77], v[10:11], v[68:69] op_sel_hi:[1,0,1]
    v_pk_fma_f32 v[70:71], v[78:79], v[10:11], v[70:71] op_sel_hi:[1,0,1]
    s_waitcnt vmcnt(3)
    v_lshlrev_b32 v72, 16, v36
    v_and_b32 v73, 0xffff0000, v36
    v_lshlrev_b32 v74, 16, v37
    v_and_b32 v75, 0xffff0000, v37
    v_lshlrev_b32 v76, 16, v38
    v_and_b32 v77, 0xffff0000, v38
    v_lshlrev_b32 v78, 16, v39
    v_and_b32 v79, 0xffff0000, v39
    v_pk_fma_f32 v[64:65], v[72:73], v[12:13], v[64:65] op_sel_hi:[1,0,1]
    v_pk_fma_f32 v[66:67], v[74:75], v[12:13], v[66:67] op_sel_hi:[1,0,1]
    v_pk_fma_f32 v[68:69], v[76:77], v[12:13], v[68:69] op_sel_hi:[1,0,1]
    v_pk_fma_f32 v[70:71], v[78:79], v[12:13], v[70:71] op_sel_hi:[1,0,1]
    s_waitcnt vmcnt(2)
    v_lshlrev_b32 v72, 16, v40
    v_and_b32 v73, 0xffff0000, v40
    v_lshlrev_b32 v74, 16, v41
    v_and_b32 v75, 0xffff0000, v41
    v_lshlrev_b32 v76, 16, v42
    v_and_b32 v77, 0xffff0000, v42
    v_lshlrev_b32 v78, 16, v43
    v_and_b32 v79, 0xffff0000, v43
    v_pk_fma_f32 v[64:65], v[72:73], v[14:15], v[64:65] op_sel_hi:[1,0,1]
    v_pk_fma_f32 v[66:67], v[74:75], v[14:15], v[66:67] op_sel_hi:[1,0,1]
    v_pk_fma_f32 v[68:69], v[76:77], v[14:15], v[68:69] op_sel_hi:[1,0,1]
    v_pk_fma_f32 v[70:71], v[78:79], v[14:15], v[70:71] op_sel_hi:[1,0,1]
    s_waitcnt vmcnt(1)
    v_lshlrev_b32 v72, 16, v44
    v_and_b32 v73, 0xffff0000, v44
    v_lshlrev_b32 v74, 16, v45
    v_and_b32 v75, 0xffff0000, v45
    v_lshlrev_b32 v76, 16, v46
    v_and_b32 v77, 0xffff0000, v46
    v_lshlrev_b32 v78, 16, v47
    v_and_b32 v79, 0xffff0000, v47
    v_pk_fma_f32 v[64:65], v[72:73], v[16:17], v[64:65] op_sel_hi:[1,0,1]
    v_pk_fma_f32 v[66:67], v[74:75], v[16:17], v[66:67] op_sel_hi:[1,0,1]
    v_pk_fma_f32 v[68:69], v[76:77], v[16:17], v[68:69] op_sel_hi:[1,0,1]
    v_pk_fma_f32 v[70:71], v[78:79], v[16:17], v[70:71] op_sel_hi:[1,0,1]
    s_waitcnt vmcnt(0)
    v_readfirstlane_b32 s3, v25
    s_cmp_eq_u32 s3, 0
    s_cbranch_scc0 L_p0_ht
    s_mov_b32 s60, s90
    s_mov_b32 s61, s91
    s_mov_b32 s62, 256
    s_mov_b32 s63, 0x20000
    s_mov_b32 s11, 131072
    v_mov_b32 v73, 0
L_m_tk3:
    buffer_load_dword v72, v73, s[60:63], 0 offen sc1
    s_sub_u32 s11, s11, 1
    s_waitcnt vmcnt(0)
    v_readfirstlane_b32 s3, v72
    s_cmp_eq_u32 s11, 0
    s_cbranch_scc1 L_m_te4
    s_cmp_eq_u32 s3, 0
    s_cbranch_scc1 L_m_tk3
L_m_te4:
L_p0_ht:
    v_add_f32 v72, v70, v71
    v_and_b32 v2, 255, v0
    v_and_b32 v4, 3, v2
    v_add_f32_dpp v64, v64, v64 row_ror:4 row_mask:0xf bank_mask:0xf
    v_add_f32_dpp v65, v65, v65 row_ror:4 row_mask:0xf bank_mask:0xf
    v_add_f32_dpp v66, v66, v66 row_ror:4 row_mask:0xf bank_mask:0xf
    v_add_f32_dpp v67, v67, v67 row_ror:4 row_mask:0xf bank_mask:0xf
    v_add_f32_dpp v68, v68, v68 row_ror:4 row_mask:0xf bank_mask:0xf
    v_add_f32_dpp v69, v69, v69 row_ror:4 row_mask:0xf bank_mask:0xf
    v_add_f32_dpp v70, v70, v70 row_ror:4 row_mask:0xf bank_mask:0xf
    v_add_f32_dpp v71, v71, v71 row_ror:4 row_mask:0xf bank_mask:0xf
    v_add_f32_dpp v64, v64, v64 row_ror:8 row_mask:0xf bank_mask:0xf
    v_add_f32_dpp v65, v65, v65 row_ror:8 row_mask:0xf bank_mask:0xf
    v_add_f32_dpp v66, v66, v66 row_ror:8 row_mask:0xf bank_mask:0xf
    v_add_f32_dpp v67, v67, v67 row_ror:8 row_mask:0xf bank_mask:0xf
    v_add_f32_dpp v68, v68, v68 row_ror:8 row_mask:0xf bank_mask:0xf
    v_add_f32_dpp v69, v69, v69 row_ror:8 row_mask:0xf bank_mask:0xf
    v_add_f32_dpp v70, v70, v70 row_ror:8 row_mask:0xf bank_mask:0xf
    v_add_f32_dpp v71, v71, v71 row_ror:8 row_mask:0xf bank_mask:0xf
    v_lshrrev_b32 v3, 4, v2
    v_mul_u32_u24 v3, 128, v3
    v_lshl_add_u32 v3, v4, 5, v3
    v_add_u32 v3, 73728, v3
    s_mov_b32 exec_lo, 983055
    s_mov_b32 exec_hi, 983055
    ds_write_b128 v3, v[64:67]
    ds_write_b128 v3, v[68:71] offset:16
    s_mov_b64 exec, -1
    v_mov_b32 v6, 163788
    v_mov_b32 v7, 1
    s_waitcnt lgkmcnt(0)
    s_mov_b64 exec, 1
    ds_add_rtn_u32 v7, v6, v7
    s_mov_b64 exec, -1
    v_and_b32 v3, 31, v1
    v_lshrrev_b32 v5, 5, v1
    v_lshlrev_b32 v4, 2, v3
    v_lshl_add_u32 v5, v5, 10, v4
    v_add_u32 v5, 73728, v5
    s_waitcnt lgkmcnt(0)
    v_readfirstlane_b32 s10, v7
    s_cmp_eq_u32 s10, 3
    s_cbranch_scc0 L_p0_sg
    ds_read_b32 v8, v5 offset:0
    ds_read_b32 v9, v5 offset:128
    ds_read_b32 v10, v5 offset:256
    ds_read_b32 v11, v5 offset:384
    ds_read_b32 v12, v5 offset:512
    ds_read_b32 v13, v5 offset:640
    ds_read_b32 v14, v5 offset:768
    ds_read_b32 v15, v5 offset:896
    s_mul_i32 s12, s65, 3641
    s_lshr_b32 s12, s12, 21
    s_cmp_eq_u32 s12, 1
    s_cselect_b32 s13, 1.0, 0
    s_cmp_eq_u32 s12, 4
    s_cselect_b32 s13, 1.0, s13
    s_lshl_b32 s14, s65, 2
    s_waitcnt lgkmcnt(0)
    v_pk_add_f32 v[8:9], v[8:9], v[10:11]
    v_pk_add_f32 v[12:13], v[12:13], v[14:15]
    v_pk_add_f32 v[8:9], v[8:9], v[12:13]
    v_add_f32 v8, v8, v9
    v_mov_b32 v9, v8
    s_nop 1
    v_permlane32_swap_b32 v8, v9
    v_add_f32 v8, v8, v9
    v_mov_b32 v9, s3
    v_lshlrev_b32 v4, 1, v4
    s_lshl_b32 s14, s14, 1
    s_mul_i32 s10, s66, 32
    s_add_u32 s14, s14, s10
    s_mov_b32 exec_hi, 0
    buffer_store_dwordx2 v[8:9], v4, s[24:27], s14 offen sc1
    s_mov_b32 exec_hi, -1
    s_branch L_p0_sg
L_p0_tr:
    s_mul_i32 s42, s20, 6144
    s_add_u32 s42, s42, 73728
    v_and_b32 v10, 63, v1
    v_lshrrev_b32 v3, 3, v1
    v_and_b32 v5, 7, v1
    v_and_b32 v6, 2, v3
    v_lshlrev_b32 v6, 1, v6
    v_xor_b32 v5, v5, v6
    v_lshlrev_b32 v5, 4, v5
    s_cmp_ge_u32 s2, 153
    s_cbranch_scc1 L_p0_wo
    s_sub_u32 s10, s2, 72
    s_mul_i32 s21, s10, 21846
    s_lshr_b32 s21, s21, 16
    s_mul_i32 s11, s21, 3
    s_sub_u32 s22, s10, s11
    s_mul_i32 s14, s22, 24
    s_mul_i32 s11, s20, 6
    s_add_u32 s14, s14, s11
    v_mul_u32_u24 v2, 3456, v3
    v_add_u32 v2, v2, v5
    s_mul_i32 s12, s14, 27648
    s_lshl_b32 s10, s21, 7
    s_add_u32 s12, s12, s10
    s_mov_b32 s24, s70
    s_mov_b32 s25, s71
    s_mov_b32 s26, 1990656
    s_mov_b32 s27, 0x20000
    s_add_u32 m0, s42, 0
    s_nop 0
    buffer_load_dwordx4 v2, s[24:27], s12 offen lds
    s_add_u32 s12, s12, 27648
    s_add_u32 m0, s42, 1024
    s_nop 0
    buffer_load_dwordx4 v2, s[24:27], s12 offen lds
    s_add_u32 s12, s12, 27648
    s_add_u32 m0, s42, 2048
    s_nop 0
    buffer_load_dwordx4 v2, s[24:27], s12 offen lds
    s_add_u32 s12, s12, 27648
    s_add_u32 m0, s42, 3072
    s_nop 0
    buffer_load_dwordx4 v2, s[24:27], s12 offen lds
    s_add_u32 s12, s12, 27648
    s_add_u32 m0, s42, 4096
    s_nop 0
    buffer_load_dwordx4 v2, s[24:27], s12 offen lds
    s_add_u32 s12, s12, 27648
    s_add_u32 m0, s42, 5120
    s_nop 0
    buffer_load_dwordx4 v2, s[24:27], s12 offen lds
    s_add_u32 s12, s12, 27648
    s_barrier
    s_lshl_b32 s10, s21, 6
    v_add_u32 v10, s10, v10
    v_mul_u32_u24 v11, 1821, v10
    v_lshrrev_b32 v11, 20, v11
    v_mul_u32_u24 v12, 576, v11
    v_sub_u32 v12, v10, v12
    v_mul_u32_u24 v13, 3641, v12
    v_lshrrev_b32 v13, 16, v13
    v_mul_u32_u24 v14, 18, v13
    v_sub_u32 v14, v12, v14
    v_and_b32 v15, 1, v13
    v_lshl_add_u32 v15, v11, 1, v15
    v_cmp_gt_u32 vcc, 16, v14
    v_lshl_add_u32 v16, v15, 1, v14
    v_add_u32 v16, 752, v16
    v_lshl_add_u32 v17, v15, 7, v14
    v_cndmask_b32 v16, v16, v17, vcc
    v_lshlrev_b32 v16, 4, v16
    v_lshrrev_b32 v13, 1, v13
    s_mov_b32 s12, 129024
    v_mad_u32_u24 v16, v13, s12, v16
    v_mov_b32 v15, 256
    s_movk_i32 s15, 14336
    s_add_u32 s28, s92, 458752
    s_addc_u32 s29, s93, 0
    s_mov_b32 s30, 2064384
    s_mov_b32 s31, 0x20000
    s_branch L_p0_t3
L_p0_wo:
    s_sub_u32 s10, s2, 153
    s_mul_i32 s21, s10, 21846
    s_lshr_b32 s21, s21, 16
    s_mul_i32 s11, s21, 3
    s_sub_u32 s22, s10, s11
    s_mul_i32 s14, s22, 24
    s_mul_i32 s11, s20, 6
    s_add_u32 s14, s14, s11
    v_lshrrev_b32 v6, 2, v3
    v_and_b32 v7, 3, v3
    v_lshl_add_u32 v6, v6, 3, v7
    v_lshrrev_b32 v7, 1, v3
    v_mul_u32_u24 v7, 18, v7
    v_and_b32 v4, 1, v3
    v_add_u32 v7, v7, v4
    s_movk_i32 s13, 1152
    v_mad_u32_u24 v6, v6, s13, v5
    v_mad_u32_u24 v7, v7, s13, v5
    s_lshl_b32 s15, s21, 7
    s_mov_b32 s24, s72
    s_mov_b32 s25, s73
    s_mov_b32 s26, 663552
    s_mov_b32 s27, 0x20000
    s_add_u32 s10, s14, 0
    s_lshr_b32 s11, s10, 1
    s_mul_i32 s11, s11, 18
    s_and_b32 s12, s10, 1
    s_lshl_b32 s12, s12, 2
    s_add_u32 s11, s11, s12
    s_cmp_lt_u32 s10, 64
    s_cbranch_scc1 L_m_wt5
    s_mul_i32 s11, s10, 72
    s_sub_u32 s11, s11, 4592
    v_mov_b32 v6, v7
L_m_wt5:
    s_mul_i32 s11, s11, 1152
    s_add_u32 m0, s42, 0
    s_add_u32 s11, s11, s15
    buffer_load_dwordx4 v6, s[24:27], s11 offen lds
    s_add_u32 s10, s14, 1
    s_lshr_b32 s11, s10, 1
    s_mul_i32 s11, s11, 18
    s_and_b32 s12, s10, 1
    s_lshl_b32 s12, s12, 2
    s_add_u32 s11, s11, s12
    s_cmp_lt_u32 s10, 64
    s_cbranch_scc1 L_m_wt6
    s_mul_i32 s11, s10, 72
    s_sub_u32 s11, s11, 4592
    v_mov_b32 v6, v7
L_m_wt6:
    s_mul_i32 s11, s11, 1152
    s_add_u32 m0, s42, 1024
    s_add_u32 s11, s11, s15
    buffer_load_dwordx4 v6, s[24:27], s11 offen lds
    s_add_u32 s10, s14, 2
    s_lshr_b32 s11, s10, 1
    s_mul_i32 s11, s11, 18
    s_and_b32 s12, s10, 1
    s_lshl_b32 s12, s12, 2
    s_add_u32 s11, s11, s12
    s_cmp_lt_u32 s10, 64
    s_cbranch_scc1 L_m_wt7
    s_mul_i32 s11, s10, 72
    s_sub_u32 s11, s11, 4592
    v_mov_b32 v6, v7
L_m_wt7:
    s_mul_i32 s11, s11, 1152
    s_add_u32 m0, s42, 2048
    s_add_u32 s11, s11, s15
    buffer_load_dwordx4 v6, s[24:27], s11 offen lds
    s_add_u32 s10, s14, 3
    s_lshr_b32 s11, s10, 1
    s_mul_i32 s11, s11, 18
    s_and_b32 s12, s10, 1
    s_lshl_b32 s12, s12, 2
    s_add_u32 s11, s11, s12
    s_cmp_lt_u32 s10, 64
    s_cbranch_scc1 L_m_wt8
    s_mul_i32 s11, s10, 72
    s_sub_u32 s11, s11, 4592
    v_mov_b32 v6, v7
L_m_wt8:
    s_mul_i32 s11, s11, 1152
    s_add_u32 m0, s42, 3072
    s_add_u32 s11, s11, s15
    buffer_load_dwordx4 v6, s[24:27], s11 offen lds
    s_add_u32 s10, s14, 4
    s_lshr_b32 s11, s10, 1
    s_mul_i32 s11, s11, 18
    s_and_b32 s12, s10, 1
    s_lshl_b32 s12, s12, 2
    s_add_u32 s11, s11, s12
    s_cmp_lt_u32 s10, 64
    s_cbranch_scc1 L_m_wt9
    s_mul_i32 s11, s10, 72
    s_sub_u32 s11, s11, 4592
    v_mov_b32 v6, v7
L_m_wt9:
    s_mul_i32 s11, s11, 1152
    s_add_u32 m0, s42, 4096
    s_add_u32 s11, s11, s15
    buffer_load_dwordx4 v6, s[24:27], s11 offen lds
    s_add_u32 s10, s14, 5
    s_lshr_b32 s11, s10, 1
    s_mul_i32 s11, s11, 18
    s_and_b32 s12, s10, 1
    s_lshl_b32 s12, s12, 2
    s_add_u32 s11, s11, s12
    s_cmp_lt_u32 s10, 64
    s_cbranch_scc1 L_m_wt10
    s_mul_i32 s11, s10, 72
    s_sub_u32 s11, s11, 4592
    v_mov_b32 v6, v7
L_m_wt10:
    s_mul_i32 s11, s11, 1152
    s_add_u32 m0, s42, 5120
    s_add_u32 s11, s11, s15
    buffer_load_dwordx4 v6, s[24:27], s11 offen lds
    s_barrier
    s_lshl_b32 s10, s21, 6
    v_add_u32 v10, s10, v10
    s_mov_b32 s13, 82944
    v_mul_u32_u24 v11, 911, v10
    v_lshrrev_b32 v11, 16, v11
    v_mul_u32_u24 v12, 72, v11
    v_sub_u32 v12, v10, v12
    v_cmp_gt_u32 vcc, 64, v12
    v_lshrrev_b32 v13, 4, v12
    v_and_b32 v14, 15, v12
    v_lshl_add_u32 v13, v13, 7, v14
    v_lshlrev_b32 v16, 4, v13
    v_mad_u32_u24 v16, v11, s13, v16
    v_mov_b32 v15, 128
    v_mov_b32 v14, 256
    v_cndmask_b32 v15, v15, v14, vcc
    s_movk_i32 s15, 9216
    s_add_u32 s28, s92, 33193984
    s_addc_u32 s29, s93, 0
    s_mov_b32 s30, 663552
    s_mov_b32 s31, 0x20000
L_p0_t3:
    v_bfe_u32 v3, v1, 2, 2
    v_lshrrev_b32 v8, 4, v1
    v_and_b32 v4, 2, v3
    v_xor_b32 v4, v4, v8
    v_lshlrev_b32 v4, 5, v4
    v_lshl_add_u32 v4, v3, 7, v4
    v_and_b32 v5, 3, v1
    v_lshl_add_u32 v4, v5, 3, v4
    v_add_u32 v4, s42, v4
    s_add_u32 s10, s14, 0
    s_and_b32 s11, s10, 7
    s_lshr_b32 s10, s10, 3
    s_mul_i32 s32, s10, s15
    v_mad_u32_u24 v60, s11, v15, v16
    s_add_u32 s10, s14, 1
    s_and_b32 s11, s10, 7
    s_lshr_b32 s10, s10, 3
    s_mul_i32 s33, s10, s15
    v_mad_u32_u24 v61, s11, v15, v16
    s_add_u32 s10, s14, 2
    s_and_b32 s11, s10, 7
    s_lshr_b32 s10, s10, 3
    s_mul_i32 s34, s10, s15
    v_mad_u32_u24 v62, s11, v15, v16
    s_add_u32 s10, s14, 3
    s_and_b32 s11, s10, 7
    s_lshr_b32 s10, s10, 3
    s_mul_i32 s35, s10, s15
    v_mad_u32_u24 v63, s11, v15, v16
    s_add_u32 s10, s14, 4
    s_and_b32 s11, s10, 7
    s_lshr_b32 s10, s10, 3
    s_mul_i32 s36, s10, s15
    v_mad_u32_u24 v64, s11, v15, v16
    s_add_u32 s10, s14, 5
    s_and_b32 s11, s10, 7
    s_lshr_b32 s10, s10, 3
    s_mul_i32 s37, s10, s15
    v_mad_u32_u24 v65, s11, v15, v16
    s_waitcnt vmcnt(0)
    ds_read_b64_tr_b16 v[20:21], v4 offset:0
    ds_read_b64_tr_b16 v[22:23], v4 offset:512
    ds_read_b64_tr_b16 v[24:25], v4 offset:1024
    ds_read_b64_tr_b16 v[26:27], v4 offset:1536
    ds_read_b64_tr_b16 v[28:29], v4 offset:2048
    ds_read_b64_tr_b16 v[30:31], v4 offset:2560
    ds_read_b64_tr_b16 v[32:33], v4 offset:3072
    ds_read_b64_tr_b16 v[34:35], v4 offset:3584
    ds_read_b64_tr_b16 v[36:37], v4 offset:4096
    ds_read_b64_tr_b16 v[38:39], v4 offset:4608
    ds_read_b64_tr_b16 v[40:41], v4 offset:5120
    ds_read_b64_tr_b16 v[42:43], v4 offset:5632
    s_waitcnt lgkmcnt(10)
    buffer_store_dwordx4 v[20:23], v60, s[28:31], s32 offen sc1
    s_waitcnt lgkmcnt(8)
    buffer_store_dwordx4 v[24:27], v61, s[28:31], s33 offen sc1
    s_waitcnt lgkmcnt(6)
    buffer_store_dwordx4 v[28:31], v62, s[28:31], s34 offen sc1
    s_waitcnt lgkmcnt(4)
    buffer_store_dwordx4 v[32:35], v63, s[28:31], s35 offen sc1
    s_waitcnt lgkmcnt(2)
    buffer_store_dwordx4 v[36:39], v64, s[28:31], s36 offen sc1
    s_waitcnt lgkmcnt(0)
    buffer_store_dwordx4 v[40:43], v65, s[28:31], s37 offen sc1
L_p0_cnt:
    s_mov_b32 s60, s90
    s_mov_b32 s61, s91
    s_mov_b32 s62, 256
    s_mov_b32 s63, 0x20000
    s_mov_b32 s11, 131072
    v_mov_b32 v11, 0
L_m_tk11:
    buffer_load_dword v10, v11, s[60:63], 0 offen sc1
    s_sub_u32 s11, s11, 1
    s_waitcnt vmcnt(0)
    v_readfirstlane_b32 s3, v10
    s_cmp_eq_u32 s11, 0
    s_cbranch_scc1 L_m_te12
    s_cmp_eq_u32 s3, 0
    s_cbranch_scc1 L_m_tk11
L_m_te12:
    v_mov_b32 v2, 163776
    v_mov_b32 v3, 1
    s_mov_b64 exec, 1
    ds_add_rtn_u32 v3, v2, v3
    s_mov_b64 exec, -1
    s_waitcnt lgkmcnt(0)
    v_readfirstlane_b32 s10, v3
    s_cmp_eq_u32 s10, 3
    s_cbranch_scc0 L_p0_sg
    s_lshl_b32 s10, s2, 7
    s_add_u32 s10, s10, 0
    v_mov_b32 v2, s3
    v_mov_b32 v3, 0
    s_mov_b64 exec, 1
    buffer_store_dword v2, v3, s[96:99], s10 offen sc1
    s_mov_b64 exec, -1
L_p0_sg:
L_p0_xb:
    v_lshrrev_b32 v98, 3, v1
    v_mul_u32_u24 v98, 1152, v98
    v_and_b32 v99, 7, v1
    v_lshl_add_u32 v98, v99, 4, v98
    s_and_b32 s10, s20, 3
    s_lshl_b32 s10, s10, 1
    s_lshr_b32 s11, s20, 2
    s_add_u32 s10, s10, s11
    s_mul_i32 s10, s10, 9216
    v_add_u32 v94, s10, v98
    s_cmp_ge_u32 s20, 4
    s_cbranch_scc1 L_p0_xc
    s_barrier
L_p0_xc:
    ds_read_b128 v[172:175], v94 offset:0
    ds_read_b128 v[176:179], v94 offset:128
    ds_read_b128 v[180:183], v94 offset:256
    ds_read_b128 v[184:187], v94 offset:384
    ds_read_b128 v[188:191], v94 offset:512
    ds_read_b128 v[192:195], v94 offset:640
    ds_read_b128 v[196:199], v94 offset:768
    ds_read_b128 v[200:203], v94 offset:896
    ds_read_b128 v[204:207], v94 offset:1024
    s_waitcnt lgkmcnt(8)
    v_lshlrev_b32 v100, 16, v172
    v_and_b32 v101, 0xffff0000, v172
    v_lshlrev_b32 v102, 16, v173
    v_and_b32 v103, 0xffff0000, v173
    v_lshlrev_b32 v104, 16, v174
    v_and_b32 v105, 0xffff0000, v174
    v_lshlrev_b32 v106, 16, v175
    v_and_b32 v107, 0xffff0000, v175
    v_pk_mul_f32 v[98:99], v[100:101], v[100:101]
    v_pk_add_f32 v[96:97], v[100:101], v[102:103]
    v_pk_fma_f32 v[98:99], v[102:103], v[102:103], v[98:99]
    v_pk_add_f32 v[96:97], v[96:97], v[104:105]
    v_pk_fma_f32 v[98:99], v[104:105], v[104:105], v[98:99]
    v_pk_add_f32 v[96:97], v[96:97], v[106:107]
    v_pk_fma_f32 v[98:99], v[106:107], v[106:107], v[98:99]
    s_waitcnt lgkmcnt(7)
    v_lshlrev_b32 v108, 16, v176
    v_and_b32 v109, 0xffff0000, v176
    v_lshlrev_b32 v110, 16, v177
    v_and_b32 v111, 0xffff0000, v177
    v_lshlrev_b32 v112, 16, v178
    v_and_b32 v113, 0xffff0000, v178
    v_lshlrev_b32 v114, 16, v179
    v_and_b32 v115, 0xffff0000, v179
    v_pk_add_f32 v[96:97], v[96:97], v[108:109]
    v_pk_fma_f32 v[98:99], v[108:109], v[108:109], v[98:99]
    v_pk_add_f32 v[96:97], v[96:97], v[110:111]
    v_pk_fma_f32 v[98:99], v[110:111], v[110:111], v[98:99]
    v_pk_add_f32 v[96:97], v[96:97], v[112:113]
    v_pk_fma_f32 v[98:99], v[112:113], v[112:113], v[98:99]
    v_pk_add_f32 v[96:97], v[96:97], v[114:115]
    v_pk_fma_f32 v[98:99], v[114:115], v[114:115], v[98:99]
    s_waitcnt lgkmcnt(6)
    v_lshlrev_b32 v116, 16, v180
    v_and_b32 v117, 0xffff0000, v180
    v_lshlrev_b32 v118, 16, v181
    v_and_b32 v119, 0xffff0000, v181
    v_lshlrev_b32 v120, 16, v182
    v_and_b32 v121, 0xffff0000, v182
    v_lshlrev_b32 v122, 16, v183
    v_and_b32 v123, 0xffff0000, v183
    v_pk_add_f32 v[96:97], v[96:97], v[116:117]
    v_pk_fma_f32 v[98:99], v[116:117], v[116:117], v[98:99]
    v_pk_add_f32 v[96:97], v[96:97], v[118:119]
    v_pk_fma_f32 v[98:99], v[118:119], v[118:119], v[98:99]
    v_pk_add_f32 v[96:97], v[96:97], v[120:121]
    v_pk_fma_f32 v[98:99], v[120:121], v[120:121], v[98:99]
    v_pk_add_f32 v[96:97], v[96:97], v[122:123]
    v_pk_fma_f32 v[98:99], v[122:123], v[122:123], v[98:99]
    s_waitcnt lgkmcnt(5)
    v_lshlrev_b32 v124, 16, v184
    v_and_b32 v125, 0xffff0000, v184
    v_lshlrev_b32 v126, 16, v185
    v_and_b32 v127, 0xffff0000, v185
    v_lshlrev_b32 v128, 16, v186
    v_and_b32 v129, 0xffff0000, v186
    v_lshlrev_b32 v130, 16, v187
    v_and_b32 v131, 0xffff0000, v187
    v_pk_add_f32 v[96:97], v[96:97], v[124:125]
    v_pk_fma_f32 v[98:99], v[124:125], v[124:125], v[98:99]
    v_pk_add_f32 v[96:97], v[96:97], v[126:127]
    v_pk_fma_f32 v[98:99], v[126:127], v[126:127], v[98:99]
    v_pk_add_f32 v[96:97], v[96:97], v[128:129]
    v_pk_fma_f32 v[98:99], v[128:129], v[128:129], v[98:99]
    v_pk_add_f32 v[96:97], v[96:97], v[130:131]
    v_pk_fma_f32 v[98:99], v[130:131], v[130:131], v[98:99]
    s_waitcnt lgkmcnt(4)
    v_lshlrev_b32 v132, 16, v188
    v_and_b32 v133, 0xffff0000, v188
    v_lshlrev_b32 v134, 16, v189
    v_and_b32 v135, 0xffff0000, v189
    v_lshlrev_b32 v136, 16, v190
    v_and_b32 v137, 0xffff0000, v190
    v_lshlrev_b32 v138, 16, v191
    v_and_b32 v139, 0xffff0000, v191
    v_pk_add_f32 v[96:97], v[96:97], v[132:133]
    v_pk_fma_f32 v[98:99], v[132:133], v[132:133], v[98:99]
    v_pk_add_f32 v[96:97], v[96:97], v[134:135]
    v_pk_fma_f32 v[98:99], v[134:135], v[134:135], v[98:99]
    v_pk_add_f32 v[96:97], v[96:97], v[136:137]
    v_pk_fma_f32 v[98:99], v[136:137], v[136:137], v[98:99]
    v_pk_add_f32 v[96:97], v[96:97], v[138:139]
    v_pk_fma_f32 v[98:99], v[138:139], v[138:139], v[98:99]
    s_waitcnt lgkmcnt(3)
    v_lshlrev_b32 v140, 16, v192
    v_and_b32 v141, 0xffff0000, v192
    v_lshlrev_b32 v142, 16, v193
    v_and_b32 v143, 0xffff0000, v193
    v_lshlrev_b32 v144, 16, v194
    v_and_b32 v145, 0xffff0000, v194
    v_lshlrev_b32 v146, 16, v195
    v_and_b32 v147, 0xffff0000, v195
    v_pk_add_f32 v[96:97], v[96:97], v[140:141]
    v_pk_fma_f32 v[98:99], v[140:141], v[140:141], v[98:99]
    v_pk_add_f32 v[96:97], v[96:97], v[142:143]
    v_pk_fma_f32 v[98:99], v[142:143], v[142:143], v[98:99]
    v_pk_add_f32 v[96:97], v[96:97], v[144:145]
    v_pk_fma_f32 v[98:99], v[144:145], v[144:145], v[98:99]
    v_pk_add_f32 v[96:97], v[96:97], v[146:147]
    v_pk_fma_f32 v[98:99], v[146:147], v[146:147], v[98:99]
    s_waitcnt lgkmcnt(2)
    v_lshlrev_b32 v148, 16, v196
    v_and_b32 v149, 0xffff0000, v196
    v_lshlrev_b32 v150, 16, v197
    v_and_b32 v151, 0xffff0000, v197
    v_lshlrev_b32 v152, 16, v198
    v_and_b32 v153, 0xffff0000, v198
    v_lshlrev_b32 v154, 16, v199
    v_and_b32 v155, 0xffff0000, v199
    v_pk_add_f32 v[96:97], v[96:97], v[148:149]
    v_pk_fma_f32 v[98:99], v[148:149], v[148:149], v[98:99]
    v_pk_add_f32 v[96:97], v[96:97], v[150:151]
    v_pk_fma_f32 v[98:99], v[150:151], v[150:151], v[98:99]
    v_pk_add_f32 v[96:97], v[96:97], v[152:153]
    v_pk_fma_f32 v[98:99], v[152:153], v[152:153], v[98:99]
    v_pk_add_f32 v[96:97], v[96:97], v[154:155]
    v_pk_fma_f32 v[98:99], v[154:155], v[154:155], v[98:99]
    s_waitcnt lgkmcnt(1)
    v_lshlrev_b32 v156, 16, v200
    v_and_b32 v157, 0xffff0000, v200
    v_lshlrev_b32 v158, 16, v201
    v_and_b32 v159, 0xffff0000, v201
    v_lshlrev_b32 v160, 16, v202
    v_and_b32 v161, 0xffff0000, v202
    v_lshlrev_b32 v162, 16, v203
    v_and_b32 v163, 0xffff0000, v203
    v_pk_add_f32 v[96:97], v[96:97], v[156:157]
    v_pk_fma_f32 v[98:99], v[156:157], v[156:157], v[98:99]
    v_pk_add_f32 v[96:97], v[96:97], v[158:159]
    v_pk_fma_f32 v[98:99], v[158:159], v[158:159], v[98:99]
    v_pk_add_f32 v[96:97], v[96:97], v[160:161]
    v_pk_fma_f32 v[98:99], v[160:161], v[160:161], v[98:99]
    v_pk_add_f32 v[96:97], v[96:97], v[162:163]
    v_pk_fma_f32 v[98:99], v[162:163], v[162:163], v[98:99]
    s_waitcnt lgkmcnt(0)
    v_lshlrev_b32 v164, 16, v204
    v_and_b32 v165, 0xffff0000, v204
    v_lshlrev_b32 v166, 16, v205
    v_and_b32 v167, 0xffff0000, v205
    v_lshlrev_b32 v168, 16, v206
    v_and_b32 v169, 0xffff0000, v206
    v_lshlrev_b32 v170, 16, v207
    v_and_b32 v171, 0xffff0000, v207
    v_pk_add_f32 v[96:97], v[96:97], v[164:165]
    v_pk_fma_f32 v[98:99], v[164:165], v[164:165], v[98:99]
    v_pk_add_f32 v[96:97], v[96:97], v[166:167]
    v_pk_fma_f32 v[98:99], v[166:167], v[166:167], v[98:99]
    v_pk_add_f32 v[96:97], v[96:97], v[168:169]
    v_pk_fma_f32 v[98:99], v[168:169], v[168:169], v[98:99]
    v_pk_add_f32 v[96:97], v[96:97], v[170:171]
    v_pk_fma_f32 v[98:99], v[170:171], v[170:171], v[98:99]
    v_add_f32 v96, v96, v97
    v_add_f32 v97, v98, v99
    s_nop 1
    v_add_f32_dpp v96, v96, v96 row_half_mirror row_mask:0xf bank_mask:0xf
    v_add_f32_dpp v97, v97, v97 row_half_mirror row_mask:0xf bank_mask:0xf
    s_nop 0
    v_add_f32_dpp v96, v96, v96 quad_perm:[1,0,3,2] row_mask:0xf bank_mask:0xf
    v_add_f32_dpp v97, v97, v97 quad_perm:[1,0,3,2] row_mask:0xf bank_mask:0xf
    s_nop 0
    v_add_f32_dpp v96, v96, v96 quad_perm:[2,3,0,1] row_mask:0xf bank_mask:0xf
    v_add_f32_dpp v97, v97, v97 quad_perm:[2,3,0,1] row_mask:0xf bank_mask:0xf
    s_nop 0
    s_mov_b32 s14, 987991609
    v_mov_b32 v98, 925353388
    v_mul_f32 v96, s14, v96
    v_fma_f32 v97, v97, s14, v98
    v_fma_f32 v97, -v96, v96, v97
    v_max_f32 v97, v97, v98
    v_rsq_f32 v98, v97
    s_nop 0
    v_mul_f32 v96, -v96, v98
    v_pk_fma_f32 v[100:101], v[100:101], v[98:99], v[96:97] op_sel_hi:[1,0,0]
    v_pk_fma_f32 v[102:103], v[102:103], v[98:99], v[96:97] op_sel_hi:[1,0,0]
    v_pk_fma_f32 v[104:105], v[104:105], v[98:99], v[96:97] op_sel_hi:[1,0,0]
    v_pk_fma_f32 v[106:107], v[106:107], v[98:99], v[96:97] op_sel_hi:[1,0,0]
    v_pk_fma_f32 v[108:109], v[108:109], v[98:99], v[96:97] op_sel_hi:[1,0,0]
    v_pk_fma_f32 v[110:111], v[110:111], v[98:99], v[96:97] op_sel_hi:[1,0,0]
    v_pk_fma_f32 v[112:113], v[112:113], v[98:99], v[96:97] op_sel_hi:[1,0,0]
    v_pk_fma_f32 v[114:115], v[114:115], v[98:99], v[96:97] op_sel_hi:[1,0,0]
    v_pk_fma_f32 v[116:117], v[116:117], v[98:99], v[96:97] op_sel_hi:[1,0,0]
    v_pk_fma_f32 v[118:119], v[118:119], v[98:99], v[96:97] op_sel_hi:[1,0,0]
    v_pk_fma_f32 v[120:121], v[120:121], v[98:99], v[96:97] op_sel_hi:[1,0,0]
    v_pk_fma_f32 v[122:123], v[122:123], v[98:99], v[96:97] op_sel_hi:[1,0,0]
    v_pk_fma_f32 v[124:125], v[124:125], v[98:99], v[96:97] op_sel_hi:[1,0,0]
    v_pk_fma_f32 v[126:127], v[126:127], v[98:99], v[96:97] op_sel_hi:[1,0,0]
    v_pk_fma_f32 v[128:129], v[128:129], v[98:99], v[96:97] op_sel_hi:[1,0,0]
    v_pk_fma_f32 v[130:131], v[130:131], v[98:99], v[96:97] op_sel_hi:[1,0,0]
    v_pk_fma_f32 v[132:133], v[132:133], v[98:99], v[96:97] op_sel_hi:[1,0,0]
    v_pk_fma_f32 v[134:135], v[134:135], v[98:99], v[96:97] op_sel_hi:[1,0,0]
    v_pk_fma_f32 v[136:137], v[136:137], v[98:99], v[96:97] op_sel_hi:[1,0,0]
    v_pk_fma_f32 v[138:139], v[138:139], v[98:99], v[96:97] op_sel_hi:[1,0,0]
    v_pk_fma_f32 v[140:141], v[140:141], v[98:99], v[96:97] op_sel_hi:[1,0,0]
    v_pk_fma_f32 v[142:143], v[142:143], v[98:99], v[96:97] op_sel_hi:[1,0,0]
    v_pk_fma_f32 v[144:145], v[144:145], v[98:99], v[96:97] op_sel_hi:[1,0,0]
    v_pk_fma_f32 v[146:147], v[146:147], v[98:99], v[96:97] op_sel_hi:[1,0,0]
    v_pk_fma_f32 v[148:149], v[148:149], v[98:99], v[96:97] op_sel_hi:[1,0,0]
    v_pk_fma_f32 v[150:151], v[150:151], v[98:99], v[96:97] op_sel_hi:[1,0,0]
    v_pk_fma_f32 v[152:153], v[152:153], v[98:99], v[96:97] op_sel_hi:[1,0,0]
    v_pk_fma_f32 v[154:155], v[154:155], v[98:99], v[96:97] op_sel_hi:[1,0,0]
    v_pk_fma_f32 v[156:157], v[156:157], v[98:99], v[96:97] op_sel_hi:[1,0,0]
    v_pk_fma_f32 v[158:159], v[158:159], v[98:99], v[96:97] op_sel_hi:[1,0,0]
    v_pk_fma_f32 v[160:161], v[160:161], v[98:99], v[96:97] op_sel_hi:[1,0,0]
    v_pk_fma_f32 v[162:163], v[162:163], v[98:99], v[96:97] op_sel_hi:[1,0,0]
    v_pk_fma_f32 v[164:165], v[164:165], v[98:99], v[96:97] op_sel_hi:[1,0,0]
    v_pk_fma_f32 v[166:167], v[166:167], v[98:99], v[96:97] op_sel_hi:[1,0,0]
    v_pk_fma_f32 v[168:169], v[168:169], v[98:99], v[96:97] op_sel_hi:[1,0,0]
    v_pk_fma_f32 v[170:171], v[170:171], v[98:99], v[96:97] op_sel_hi:[1,0,0]
    s_cmp_ge_u32 s20, 4
    s_cbranch_scc0 L_p0_end
    s_barrier
L_p0_end:
L_ph1:
    s_and_b32 s10, s2, 56
    s_add_u32 s10, s10, s20
    s_cmp_eq_u32 s10, 7
    s_cbranch_scc0 L_ph1n
    v_lshlrev_b32 v250, 7, v1
    s_mov_b32 s10, L_ph1-adaLN_cond__softmax_full_mha__mixer_gmlp__prompt_kernel-0
    buffer_load_dword v251, v250, s[4:7], s10 offen
    s_add_u32 s10, s10, 8192
    buffer_load_dword v251, v250, s[4:7], s10 offen
    s_add_u32 s10, s10, 8192
    buffer_load_dword v251, v250, s[4:7], s10 offen
    s_add_u32 s10, s10, 8192
L_ph1n:
    s_and_b32 s22, s2, 1
    s_lshl_b32 s22, s22, 2
    s_lshr_b32 s10, s2, 6
    s_add_u32 s22, s22, s10
    s_bfe_u32 s21, s2, 0x20001
    s_lshl_b32 s21, s21, 3
    s_bfe_u32 s23, s2, 0x30003
    s_add_u32 s21, s21, s23
    s_and_b32 s19, s20, 3
    s_cmp_eq_u32 s20, 3
    s_cbranch_scc0 L_p1_n3
    v_min_u32 v2, 23, v1
    v_lshrrev_b32 v3, 3, v2
    v_mul_u32_u24 v3, 576, v3
    v_bfe_u32 v4, v2, 2, 1
    v_mul_u32_u24 v4, 71, v4
    s_mul_i32 s10, s22, 72
    v_add3_u32 v3, v3, v4, s10
    v_lshrrev_b32 v3, 6, v3
    v_mul_u32_u24 v3, 3, v3
    v_and_b32 v2, 3, v2
    v_min_u32 v2, 2, v2
    v_add_u32 v2, v2, v3
    v_add_u32 v2, 72, v2
    v_lshlrev_b32 v2, 7, v2
    v_add_u32 v2, 0, v2
    s_mov_b32 s11, 131072
L_m_pl13:
    buffer_load_dword v248, v2, s[96:99], 0 offen sc1
    s_waitcnt vmcnt(0)
    v_cmp_ne_u32 vcc, s3, v248
    s_sub_u32 s11, s11, 1
    s_cmp_eq_u32 s11, 0
    s_cbranch_scc1 L_m_pe14
    s_cbranch_vccnz L_m_pl13
L_m_pe14:
L_p1_n3:
    s_cmp_lt_u32 s20, 3
    s_cbranch_scc0 L_p1_np
    s_add_u32 s24, s92, 438272
    s_addc_u32 s25, s93, 0
    s_mov_b32 s26, 18432
    s_mov_b32 s27, 0x20000
    v_lshlrev_b32 v2, 4, v1
    s_mul_i32 s10, s20, 3072
    s_add_u32 s13, s10, 9216
    s_lshr_b32 s12, s10, 1
    s_add_u32 s12, s12, 131072
    v_lshl_add_u32 v3, v1, 3, s12
    s_mov_b32 s11, 131072
L_p1_g:
    buffer_load_dwordx4 v[16:19], v2, s[24:27], s10 offen offset:0 sc1
    buffer_load_dwordx4 v[20:23], v2, s[24:27], s10 offen offset:1024 sc1
    buffer_load_dwordx4 v[24:27], v2, s[24:27], s10 offen offset:2048 sc1
    buffer_load_dwordx4 v[28:31], v2, s[24:27], s13 offen offset:0 sc1
    buffer_load_dwordx4 v[32:35], v2, s[24:27], s13 offen offset:1024 sc1
    buffer_load_dwordx4 v[36:39], v2, s[24:27], s13 offen offset:2048 sc1
    s_sub_u32 s11, s11, 1
    s_waitcnt vmcnt(0)
    v_xor_b32 v17, s3, v17
    v_xor_b32 v19, s3, v19
    v_xor_b32 v21, s3, v21
    v_xor_b32 v23, s3, v23
    v_xor_b32 v25, s3, v25
    v_xor_b32 v27, s3, v27
    v_xor_b32 v29, s3, v29
    v_xor_b32 v31, s3, v31
    v_xor_b32 v33, s3, v33
    v_xor_b32 v35, s3, v35
    v_xor_b32 v37, s3, v37
    v_xor_b32 v39, s3, v39
    v_or3_b32 v17, v17, v19, v21
    v_or3_b32 v23, v23, v25, v27
    v_or3_b32 v29, v29, v31, v33
    v_or3_b32 v35, v35, v37, v39
    v_or3_b32 v17, v17, v23, v29
    v_or_b32 v17, v17, v35
    v_cmp_ne_u32 vcc, 0, v17
    s_cmp_eq_u32 s11, 0
    s_cbranch_scc1 L_p1_ge
    s_nop 1
    s_cbranch_vccnz L_p1_g
L_p1_ge:
    v_cmp_le_u32 vcc, 133376, v3
    v_add_f32 v16, v16, v28
    v_add_f32 v18, v18, v30
    v_cndmask_b32 v4, 0, 1.0, vcc
    v_cvt_pk_bf16_f32 v5, v16, v18
    v_lshlrev_b32 v16, 16, v5
    v_and_b32 v17, 0xffff0000, v5
    v_add_f32 v16, v16, v4
    v_add_f32 v17, v17, v4
    v_cvt_pk_bf16_f32 v5, v16, v17
    v_lshlrev_b32 v16, 16, v5
    v_and_b32 v17, 0xffff0000, v5
    ds_write_b64 v3, v[16:17] offset:0
    v_cmp_le_u32 vcc, 132864, v3
    v_add_f32 v20, v20, v32
    v_add_f32 v22, v22, v34
    v_cndmask_b32 v4, 0, 1.0, vcc
    v_cvt_pk_bf16_f32 v5, v20, v22
    v_lshlrev_b32 v20, 16, v5
    v_and_b32 v21, 0xffff0000, v5
    v_add_f32 v20, v20, v4
    v_add_f32 v21, v21, v4
    v_cvt_pk_bf16_f32 v5, v20, v21
    v_lshlrev_b32 v20, 16, v5
    v_and_b32 v21, 0xffff0000, v5
    ds_write_b64 v3, v[20:21] offset:512
    v_cmp_le_u32 vcc, 132352, v3
    v_add_f32 v24, v24, v36
    v_add_f32 v26, v26, v38
    v_cndmask_b32 v4, 0, 1.0, vcc
    v_cvt_pk_bf16_f32 v5, v24, v26
    v_lshlrev_b32 v24, 16, v5
    v_and_b32 v25, 0xffff0000, v5
    v_add_f32 v24, v24, v4
    v_add_f32 v25, v25, v4
    v_cvt_pk_bf16_f32 v5, v24, v25
    v_lshlrev_b32 v24, 16, v5
    v_and_b32 v25, 0xffff0000, v5
    ds_write_b64 v3, v[24:25] offset:1024
    s_waitcnt lgkmcnt(0)
L_p1_np:
    s_lshl_b32 s10, s22, 1
    s_lshr_b32 s11, s19, 1
    s_add_u32 s10, s10, s11
    s_mul_i32 s10, s10, 129024
    s_and_b32 s11, s19, 1
    s_mul_i32 s11, s11, 7168
    s_add_u32 s10, s10, s11
    v_lshlrev_b32 v210, 4, v1
    v_add_u32 v211, 4096, v210
    s_mul_i32 s43, s19, 7168
    s_add_u32 s43, s43, 73728
    v_subrev_u32 v214, 9, v1
    v_min_u32 v214, v214, v1
    v_add_u32 v212, s23, v214
    v_subrev_u32 v213, 9, v212
    v_min_u32 v213, v213, v212
    v_cmp_le_u32 vcc, 9, v1
    v_mul_u32_u24 v214, 14336, v213
    s_mov_b32 s46, 0
    s_mul_i32 s41, s19, 0
    s_sub_u32 s30, 129024, s41
    s_add_u32 s41, s41, s10
    s_add_u32 s41, s41, 458752
    s_add_u32 s28, s92, s41
    s_addc_u32 s29, s93, 0
    s_mov_b32 s31, 0x20000
    v_readlane_b32 s46, v214, 0
    s_nop 3
    v_and_b32 v3, 7, v1
    v_lshlrev_b32 v4, 5, v3
    v_add_u32 v4, 131072, v4
    v_lshrrev_b32 v5, 3, v1
    s_lshr_b32 s10, s20, 2
    s_lshl_b32 s10, s10, 3
    v_add_u32 v5, s10, v5
    v_xor_b32 v5, v5, v3
    v_lshlrev_b32 v5, 4, v5
    v_lshl_add_u32 v5, v3, 8, v5
    s_mul_i32 s10, s19, 18432
    v_add_u32 v5, s10, v5
    s_barrier
    s_cmp_ge_u32 s20, 4
    s_cbranch_scc0 L_p1_nl
    s_mov_b32 s40, 1
    s_add_u32 m0, s43, 0
    s_nop 0
    buffer_load_dwordx4 v210, s[28:31], s46 offen sc1 lds
    buffer_load_dwordx4 v210, s[28:31], s46 offen offset:1024 sc1 lds
    buffer_load_dwordx4 v210, s[28:31], s46 offen offset:2048 sc1 lds
    buffer_load_dwordx4 v210, s[28:31], s46 offen offset:3072 sc1 lds
    s_add_u32 m0, s43, 4096
    s_nop 0
    buffer_load_dwordx4 v211, s[28:31], s46 offen sc1 lds
    buffer_load_dwordx4 v211, s[28:31], s46 offen offset:1024 sc1 lds
    buffer_load_dwordx4 v211, s[28:31], s46 offen offset:2048 sc1 lds
    v_readlane_b32 s46, v214, s40
    s_add_u32 s40, s40, 1
    s_nop 3
L_p1_nl:
    ds_read_b128 v[216:219], v4 offset:0
    ds_read_b128 v[220:223], v4 offset:16
    ds_read_b128 v[224:227], v4 offset:2304
    ds_read_b128 v[228:231], v4 offset:2320
    ds_read_b128 v[232:235], v4 offset:256
    ds_read_b128 v[236:239], v4 offset:272
    ds_read_b128 v[240:243], v4 offset:2560
    ds_read_b128 v[244:247], v4 offset:2576
    s_waitcnt lgkmcnt(4)
    v_pk_fma_f32 v[100:101], v[100:101], v[224:225], v[216:217]
    v_pk_fma_f32 v[102:103], v[102:103], v[226:227], v[218:219]
    v_pk_fma_f32 v[104:105], v[104:105], v[228:229], v[220:221]
    v_pk_fma_f32 v[106:107], v[106:107], v[230:231], v[222:223]
    v_cvt_pk_bf16_f32 v172, v100, v101
    v_cvt_pk_bf16_f32 v173, v102, v103
    v_cvt_pk_bf16_f32 v174, v104, v105
    v_cvt_pk_bf16_f32 v175, v106, v107
    ds_write_b128 v5, v[172:175] offset:0
    ds_read_b128 v[216:219], v4 offset:512
    ds_read_b128 v[220:223], v4 offset:528
    ds_read_b128 v[224:227], v4 offset:2816
    ds_read_b128 v[228:231], v4 offset:2832
    s_waitcnt lgkmcnt(4)
    v_pk_fma_f32 v[108:109], v[108:109], v[240:241], v[232:233]
    v_pk_fma_f32 v[110:111], v[110:111], v[242:243], v[234:235]
    v_pk_fma_f32 v[112:113], v[112:113], v[244:245], v[236:237]
    v_pk_fma_f32 v[114:115], v[114:115], v[246:247], v[238:239]
    v_cvt_pk_bf16_f32 v176, v108, v109
    v_cvt_pk_bf16_f32 v177, v110, v111
    v_cvt_pk_bf16_f32 v178, v112, v113
    v_cvt_pk_bf16_f32 v179, v114, v115
    ds_write_b128 v5, v[176:179] offset:2048
    ds_read_b128 v[232:235], v4 offset:768
    ds_read_b128 v[236:239], v4 offset:784
    ds_read_b128 v[240:243], v4 offset:3072
    ds_read_b128 v[244:247], v4 offset:3088
    s_waitcnt lgkmcnt(4)
    v_pk_fma_f32 v[116:117], v[116:117], v[224:225], v[216:217]
    v_pk_fma_f32 v[118:119], v[118:119], v[226:227], v[218:219]
    v_pk_fma_f32 v[120:121], v[120:121], v[228:229], v[220:221]
    v_pk_fma_f32 v[122:123], v[122:123], v[230:231], v[222:223]
    v_cvt_pk_bf16_f32 v180, v116, v117
    v_cvt_pk_bf16_f32 v181, v118, v119
    v_cvt_pk_bf16_f32 v182, v120, v121
    v_cvt_pk_bf16_f32 v183, v122, v123
    ds_write_b128 v5, v[180:183] offset:4096
    ds_read_b128 v[216:219], v4 offset:1024
    ds_read_b128 v[220:223], v4 offset:1040
    ds_read_b128 v[224:227], v4 offset:3328
    ds_read_b128 v[228:231], v4 offset:3344
    s_waitcnt lgkmcnt(4)
    v_pk_fma_f32 v[124:125], v[124:125], v[240:241], v[232:233]
    v_pk_fma_f32 v[126:127], v[126:127], v[242:243], v[234:235]
    v_pk_fma_f32 v[128:129], v[128:129], v[244:245], v[236:237]
    v_pk_fma_f32 v[130:131], v[130:131], v[246:247], v[238:239]
    v_cvt_pk_bf16_f32 v184, v124, v125
    v_cvt_pk_bf16_f32 v185, v126, v127
    v_cvt_pk_bf16_f32 v186, v128, v129
    v_cvt_pk_bf16_f32 v187, v130, v131
    ds_write_b128 v5, v[184:187] offset:6144
    ds_read_b128 v[232:235], v4 offset:1280
    ds_read_b128 v[236:239], v4 offset:1296
    ds_read_b128 v[240:243], v4 offset:3584
    ds_read_b128 v[244:247], v4 offset:3600
    s_waitcnt lgkmcnt(4)
    v_pk_fma_f32 v[132:133], v[132:133], v[224:225], v[216:217]
    v_pk_fma_f32 v[134:135], v[134:135], v[226:227], v[218:219]
    v_pk_fma_f32 v[136:137], v[136:137], v[228:229], v[220:221]
    v_pk_fma_f32 v[138:139], v[138:139], v[230:231], v[222:223]
    v_cvt_pk_bf16_f32 v188, v132, v133
    v_cvt_pk_bf16_f32 v189, v134, v135
    v_cvt_pk_bf16_f32 v190, v136, v137
    v_cvt_pk_bf16_f32 v191, v138, v139
    ds_write_b128 v5, v[188:191] offset:8192
    ds_read_b128 v[216:219], v4 offset:1536
    ds_read_b128 v[220:223], v4 offset:1552
    ds_read_b128 v[224:227], v4 offset:3840
    ds_read_b128 v[228:231], v4 offset:3856
    s_waitcnt lgkmcnt(4)
    v_pk_fma_f32 v[140:141], v[140:141], v[240:241], v[232:233]
    v_pk_fma_f32 v[142:143], v[142:143], v[242:243], v[234:235]
    v_pk_fma_f32 v[144:145], v[144:145], v[244:245], v[236:237]
    v_pk_fma_f32 v[146:147], v[146:147], v[246:247], v[238:239]
    v_cvt_pk_bf16_f32 v192, v140, v141
    v_cvt_pk_bf16_f32 v193, v142, v143
    v_cvt_pk_bf16_f32 v194, v144, v145
    v_cvt_pk_bf16_f32 v195, v146, v147
    ds_write_b128 v5, v[192:195] offset:10240
    ds_read_b128 v[232:235], v4 offset:1792
    ds_read_b128 v[236:239], v4 offset:1808
    ds_read_b128 v[240:243], v4 offset:4096
    ds_read_b128 v[244:247], v4 offset:4112
    s_waitcnt lgkmcnt(4)
    v_pk_fma_f32 v[148:149], v[148:149], v[224:225], v[216:217]
    v_pk_fma_f32 v[150:151], v[150:151], v[226:227], v[218:219]
    v_pk_fma_f32 v[152:153], v[152:153], v[228:229], v[220:221]
    v_pk_fma_f32 v[154:155], v[154:155], v[230:231], v[222:223]
    v_cvt_pk_bf16_f32 v196, v148, v149
    v_cvt_pk_bf16_f32 v197, v150, v151
    v_cvt_pk_bf16_f32 v198, v152, v153
    v_cvt_pk_bf16_f32 v199, v154, v155
    ds_write_b128 v5, v[196:199] offset:12288
    ds_read_b128 v[216:219], v4 offset:2048
    ds_read_b128 v[220:223], v4 offset:2064
    ds_read_b128 v[224:227], v4 offset:4352
    ds_read_b128 v[228:231], v4 offset:4368
    s_waitcnt lgkmcnt(4)
    v_pk_fma_f32 v[156:157], v[156:157], v[240:241], v[232:233]
    v_pk_fma_f32 v[158:159], v[158:159], v[242:243], v[234:235]
    v_pk_fma_f32 v[160:161], v[160:161], v[244:245], v[236:237]
    v_pk_fma_f32 v[162:163], v[162:163], v[246:247], v[238:239]
    v_cvt_pk_bf16_f32 v200, v156, v157
    v_cvt_pk_bf16_f32 v201, v158, v159
    v_cvt_pk_bf16_f32 v202, v160, v161
    v_cvt_pk_bf16_f32 v203, v162, v163
    ds_write_b128 v5, v[200:203] offset:14336
    s_waitcnt lgkmcnt(0)
    v_pk_fma_f32 v[164:165], v[164:165], v[224:225], v[216:217]
    v_pk_fma_f32 v[166:167], v[166:167], v[226:227], v[218:219]
    v_pk_fma_f32 v[168:169], v[168:169], v[228:229], v[220:221]
    v_pk_fma_f32 v[170:171], v[170:171], v[230:231], v[222:223]
    v_cvt_pk_bf16_f32 v204, v164, v165
    v_cvt_pk_bf16_f32 v205, v166, v167
    v_cvt_pk_bf16_f32 v206, v168, v169
    v_cvt_pk_bf16_f32 v207, v170, v171
    ds_write_b128 v5, v[204:207] offset:16384
    s_cmp_ge_u32 s20, 4
    s_cbranch_scc0 L_p1_cons
    s_add_u32 m0, s43, 28672
    s_nop 0
    buffer_load_dwordx4 v210, s[28:31], s46 offen sc1 lds
    buffer_load_dwordx4 v210, s[28:31], s46 offen offset:1024 sc1 lds
    buffer_load_dwordx4 v210, s[28:31], s46 offen offset:2048 sc1 lds
    buffer_load_dwordx4 v210, s[28:31], s46 offen offset:3072 sc1 lds
    s_add_u32 m0, s43, 32768
    s_nop 0
    buffer_load_dwordx4 v211, s[28:31], s46 offen sc1 lds
    buffer_load_dwordx4 v211, s[28:31], s46 offen offset:1024 sc1 lds
    buffer_load_dwordx4 v211, s[28:31], s46 offen offset:2048 sc1 lds
    v_readlane_b32 s46, v214, s40
    s_add_u32 s40, s40, 1
    s_nop 0
    s_waitcnt lgkmcnt(0)
    s_waitcnt vmcnt(7)
    s_barrier
    s_add_u32 m0, s43, 57344
    s_nop 0
    buffer_load_dwordx4 v210, s[28:31], s46 offen sc1 lds
    buffer_load_dwordx4 v210, s[28:31], s46 offen offset:1024 sc1 lds
    buffer_load_dwordx4 v210, s[28:31], s46 offen offset:2048 sc1 lds
    buffer_load_dwordx4 v210, s[28:31], s46 offen offset:3072 sc1 lds
    s_add_u32 m0, s43, 61440
    s_nop 0
    buffer_load_dwordx4 v211, s[28:31], s46 offen sc1 lds
    buffer_load_dwordx4 v211, s[28:31], s46 offen offset:1024 sc1 lds
    buffer_load_dwordx4 v211, s[28:31], s46 offen offset:2048 sc1 lds
    v_readlane_b32 s46, v214, s40
    s_add_u32 s40, s40, 1
    s_nop 0
    s_waitcnt vmcnt(7)
    s_barrier
    s_add_u32 m0, s43, 0
    s_nop 0
    buffer_load_dwordx4 v210, s[28:31], s46 offen sc1 lds
    buffer_load_dwordx4 v210, s[28:31], s46 offen offset:1024 sc1 lds
    buffer_load_dwordx4 v210, s[28:31], s46 offen offset:2048 sc1 lds
    buffer_load_dwordx4 v210, s[28:31], s46 offen offset:3072 sc1 lds
    s_add_u32 m0, s43, 4096
    s_nop 0
    buffer_load_dwordx4 v211, s[28:31], s46 offen sc1 lds
    buffer_load_dwordx4 v211, s[28:31], s46 offen offset:1024 sc1 lds
    buffer_load_dwordx4 v211, s[28:31], s46 offen offset:2048 sc1 lds
    v_readlane_b32 s46, v214, s40
    s_add_u32 s40, s40, 1
    s_nop 0
    s_waitcnt vmcnt(7)
    s_barrier
    s_add_u32 m0, s43, 28672
    s_nop 0
    buffer_load_dwordx4 v210, s[28:31], s46 offen sc1 lds
    buffer_load_dwordx4 v210, s[28:31], s46 offen offset:1024 sc1 lds
    buffer_load_dwordx4 v210, s[28:31], s46 offen offset:2048 sc1 lds
    buffer_load_dwordx4 v210, s[28:31], s46 offen offset:3072 sc1 lds
    s_add_u32 m0, s43, 32768
    s_nop 0
    buffer_load_dwordx4 v211, s[28:31], s46 offen sc1 lds
    buffer_load_dwordx4 v211, s[28:31], s46 offen offset:1024 sc1 lds
    buffer_load_dwordx4 v211, s[28:31], s46 offen offset:2048 sc1 lds
    v_readlane_b32 s46, v214, s40
    s_add_u32 s40, s40, 1
    s_nop 0
    s_waitcnt vmcnt(7)
    s_barrier
    s_add_u32 m0, s43, 57344
    s_nop 0
    buffer_load_dwordx4 v210, s[28:31], s46 offen sc1 lds
    buffer_load_dwordx4 v210, s[28:31], s46 offen offset:1024 sc1 lds
    buffer_load_dwordx4 v210, s[28:31], s46 offen offset:2048 sc1 lds
    buffer_load_dwordx4 v210, s[28:31], s46 offen offset:3072 sc1 lds
    s_add_u32 m0, s43, 61440
    s_nop 0
    buffer_load_dwordx4 v211, s[28:31], s46 offen sc1 lds
    buffer_load_dwordx4 v211, s[28:31], s46 offen offset:1024 sc1 lds
    buffer_load_dwordx4 v211, s[28:31], s46 offen offset:2048 sc1 lds
    v_readlane_b32 s46, v214, s40
    s_add_u32 s40, s40, 1
    s_nop 0
    s_waitcnt vmcnt(7)
    s_barrier
    s_add_u32 m0, s43, 0
    s_nop 0
    buffer_load_dwordx4 v210, s[28:31], s46 offen sc1 lds
    buffer_load_dwordx4 v210, s[28:31], s46 offen offset:1024 sc1 lds
    buffer_load_dwordx4 v210, s[28:31], s46 offen offset:2048 sc1 lds
    buffer_load_dwordx4 v210, s[28:31], s46 offen offset:3072 sc1 lds
    s_add_u32 m0, s43, 4096
    s_nop 0
    buffer_load_dwordx4 v211, s[28:31], s46 offen sc1 lds
    buffer_load_dwordx4 v211, s[28:31], s46 offen offset:1024 sc1 lds
    buffer_load_dwordx4 v211, s[28:31], s46 offen offset:2048 sc1 lds
    v_readlane_b32 s46, v214, s40
    s_add_u32 s40, s40, 1
    s_nop 0
    s_waitcnt vmcnt(7)
    s_barrier
    s_add_u32 m0, s43, 28672
    s_nop 0
    buffer_load_dwordx4 v210, s[28:31], s46 offen sc1 lds
    buffer_load_dwordx4 v210, s[28:31], s46 offen offset:1024 sc1 lds
    buffer_load_dwordx4 v210, s[28:31], s46 offen offset:2048 sc1 lds
    buffer_load_dwordx4 v210, s[28:31], s46 offen offset:3072 sc1 lds
    s_add_u32 m0, s43, 32768
    s_nop 0
    buffer_load_dwordx4 v211, s[28:31], s46 offen sc1 lds
    buffer_load_dwordx4 v211, s[28:31], s46 offen offset:1024 sc1 lds
    buffer_load_dwordx4 v211, s[28:31], s46 offen offset:2048 sc1 lds
    v_readlane_b32 s46, v214, s40
    s_add_u32 s40, s40, 1
    s_nop 0
    s_waitcnt vmcnt(7)
    s_barrier
    s_add_u32 m0, s43, 57344
    s_nop 0
    buffer_load_dwordx4 v210, s[28:31], s46 offen sc1 lds
    buffer_load_dwordx4 v210, s[28:31], s46 offen offset:1024 sc1 lds
    buffer_load_dwordx4 v210, s[28:31], s46 offen offset:2048 sc1 lds
    buffer_load_dwordx4 v210, s[28:31], s46 offen offset:3072 sc1 lds
    s_add_u32 m0, s43, 61440
    s_nop 0
    buffer_load_dwordx4 v211, s[28:31], s46 offen sc1 lds
    buffer_load_dwordx4 v211, s[28:31], s46 offen offset:1024 sc1 lds
    buffer_load_dwordx4 v211, s[28:31], s46 offen offset:2048 sc1 lds
    v_readlane_b32 s46, v214, s40
    s_add_u32 s40, s40, 1
    s_nop 0
    s_waitcnt vmcnt(7)
    s_barrier
    s_add_u32 s24, s92, 176128
    s_addc_u32 s25, s93, 0
    s_mov_b32 s26, 262144
    s_mov_b32 s27, 0x20000
    s_lshl_b32 s10, s2, 10
    s_lshl_b32 s11, s19, 8
    s_add_u32 s10, s10, s11
    v_lshlrev_b32 v94, 2, v1
    v_mov_b32 v95, -1
    buffer_store_dword v95, v94, s[24:27], s10 offen sc1
    s_waitcnt vmcnt(0)
    s_waitcnt vmcnt(0)
    s_barrier
    s_mov_b32 s60, s90
    s_mov_b32 s61, s91
    s_mov_b32 s62, 256
    s_mov_b32 s63, 0x20000
    s_mov_b32 s11, 131072
    v_mov_b32 v95, 0
L_m_tk15:
    buffer_load_dword v94, v95, s[60:63], 0 offen sc1
    s_sub_u32 s11, s11, 1
    s_waitcnt vmcnt(0)
    v_readfirstlane_b32 s3, v94
    s_cmp_eq_u32 s11, 0
    s_cbranch_scc1 L_m_te16
    s_cmp_eq_u32 s3, 0
    s_cbranch_scc1 L_m_tk15
L_m_te16:
    s_cmp_ge_u32 s2, 184
    s_cbranch_scc0 L_p1_end
    s_mov_b32 s24, s92
    s_mov_b32 s25, s93
    s_mov_b32 s26, 13824
    s_mov_b32 s27, 0x20000
    s_waitcnt vmcnt(9)
    v_lshlrev_b32 v8, 16, v8
    v_lshlrev_b32 v10, 16, v10
    v_lshlrev_b32 v12, 16, v12
    v_lshlrev_b32 v14, 16, v14
    v_lshlrev_b32 v16, 16, v16
    v_lshlrev_b32 v18, 16, v18
    v_lshlrev_b32 v20, 16, v20
    v_lshlrev_b32 v22, 16, v22
    v_lshlrev_b32 v24, 16, v24
    v_mul_f32 v72, 3216550459, v8
    v_mul_f32 v73, 3216550459, v10
    v_mul_f32 v74, 3216550459, v12
    v_mul_f32 v75, 3216550459, v14
    v_mul_f32 v76, 3216550459, v16
    v_mul_f32 v77, 3216550459, v18
    v_mul_f32 v78, 3216550459, v20
    v_mul_f32 v79, 3216550459, v22
    v_mul_f32 v80, 3216550459, v24
    v_exp_f32 v72, v72
    v_exp_f32 v73, v73
    v_exp_f32 v74, v74
    v_exp_f32 v75, v75
    v_exp_f32 v76, v76
    v_exp_f32 v77, v77
    v_exp_f32 v78, v78
    v_exp_f32 v79, v79
    v_exp_f32 v80, v80
    v_add_f32 v72, 1.0, v72
    v_add_f32 v73, 1.0, v73
    v_add_f32 v74, 1.0, v74
    v_add_f32 v75, 1.0, v75
    v_add_f32 v76, 1.0, v76
    v_add_f32 v77, 1.0, v77
    v_add_f32 v78, 1.0, v78
    v_add_f32 v79, 1.0, v79
    v_add_f32 v80, 1.0, v80
    v_rcp_f32 v72, v72
    v_rcp_f32 v73, v73
    v_rcp_f32 v74, v74
    v_rcp_f32 v75, v75
    v_rcp_f32 v76, v76
    v_rcp_f32 v77, v77
    v_rcp_f32 v78, v78
    v_rcp_f32 v79, v79
    v_rcp_f32 v80, v80
    v_mul_f32 v8, v8, v72
    v_mul_f32 v10, v10, v73
    v_mul_f32 v12, v12, v74
    v_mul_f32 v14, v14, v75
    v_mul_f32 v16, v16, v76
    v_mul_f32 v18, v18, v77
    v_mul_f32 v20, v20, v78
    v_mul_f32 v22, v22, v79
    v_mul_f32 v24, v24, v80
    v_cvt_pk_bf16_f32 v8, v8, v8
    v_cvt_pk_bf16_f32 v10, v10, v10
    v_cvt_pk_bf16_f32 v12, v12, v12
    v_cvt_pk_bf16_f32 v14, v14, v14
    v_cvt_pk_bf16_f32 v16, v16, v16
    v_cvt_pk_bf16_f32 v18, v18, v18
    v_cvt_pk_bf16_f32 v20, v20, v20
    v_cvt_pk_bf16_f32 v22, v22, v22
    v_cvt_pk_bf16_f32 v24, v24, v24
    v_lshlrev_b32 v8, 16, v8
    v_lshlrev_b32 v10, 16, v10
    v_lshlrev_b32 v12, 16, v12
    v_lshlrev_b32 v14, 16, v14
    v_lshlrev_b32 v16, 16, v16
    v_lshlrev_b32 v18, 16, v18
    v_lshlrev_b32 v20, 16, v20
    v_lshlrev_b32 v22, 16, v22
    v_lshlrev_b32 v24, 16, v24
    s_waitcnt vmcnt(8)
    v_lshlrev_b32 v72, 16, v28
    v_and_b32 v73, 0xffff0000, v28
    v_lshlrev_b32 v74, 16, v29
    v_and_b32 v75, 0xffff0000, v29
    v_lshlrev_b32 v76, 16, v30
    v_and_b32 v77, 0xffff0000, v30
    v_lshlrev_b32 v78, 16, v31
    v_and_b32 v79, 0xffff0000, v31
    v_pk_mul_f32 v[64:65], v[72:73], v[8:9] op_sel_hi:[1,0]
    v_pk_mul_f32 v[66:67], v[74:75], v[8:9] op_sel_hi:[1,0]
    v_pk_mul_f32 v[68:69], v[76:77], v[8:9] op_sel_hi:[1,0]
    v_pk_mul_f32 v[70:71], v[78:79], v[8:9] op_sel_hi:[1,0]
    s_waitcnt vmcnt(7)
    v_lshlrev_b32 v72, 16, v32
    v_and_b32 v73, 0xffff0000, v32
    v_lshlrev_b32 v74, 16, v33
    v_and_b32 v75, 0xffff0000, v33
    v_lshlrev_b32 v76, 16, v34
    v_and_b32 v77, 0xffff0000, v34
    v_lshlrev_b32 v78, 16, v35
    v_and_b32 v79, 0xffff0000, v35
    v_pk_fma_f32 v[64:65], v[72:73], v[10:11], v[64:65] op_sel_hi:[1,0,1]
    v_pk_fma_f32 v[66:67], v[74:75], v[10:11], v[66:67] op_sel_hi:[1,0,1]
    v_pk_fma_f32 v[68:69], v[76:77], v[10:11], v[68:69] op_sel_hi:[1,0,1]
    v_pk_fma_f32 v[70:71], v[78:79], v[10:11], v[70:71] op_sel_hi:[1,0,1]
    s_waitcnt vmcnt(6)
    v_lshlrev_b32 v72, 16, v36
    v_and_b32 v73, 0xffff0000, v36
    v_lshlrev_b32 v74, 16, v37
    v_and_b32 v75, 0xffff0000, v37
    v_lshlrev_b32 v76, 16, v38
    v_and_b32 v77, 0xffff0000, v38
    v_lshlrev_b32 v78, 16, v39
    v_and_b32 v79, 0xffff0000, v39
    v_pk_fma_f32 v[64:65], v[72:73], v[12:13], v[64:65] op_sel_hi:[1,0,1]
    v_pk_fma_f32 v[66:67], v[74:75], v[12:13], v[66:67] op_sel_hi:[1,0,1]
    v_pk_fma_f32 v[68:69], v[76:77], v[12:13], v[68:69] op_sel_hi:[1,0,1]
    v_pk_fma_f32 v[70:71], v[78:79], v[12:13], v[70:71] op_sel_hi:[1,0,1]
    s_waitcnt vmcnt(5)
    v_lshlrev_b32 v72, 16, v40
    v_and_b32 v73, 0xffff0000, v40
    v_lshlrev_b32 v74, 16, v41
    v_and_b32 v75, 0xffff0000, v41
    v_lshlrev_b32 v76, 16, v42
    v_and_b32 v77, 0xffff0000, v42
    v_lshlrev_b32 v78, 16, v43
    v_and_b32 v79, 0xffff0000, v43
    v_pk_fma_f32 v[64:65], v[72:73], v[14:15], v[64:65] op_sel_hi:[1,0,1]
    v_pk_fma_f32 v[66:67], v[74:75], v[14:15], v[66:67] op_sel_hi:[1,0,1]
    v_pk_fma_f32 v[68:69], v[76:77], v[14:15], v[68:69] op_sel_hi:[1,0,1]
    v_pk_fma_f32 v[70:71], v[78:79], v[14:15], v[70:71] op_sel_hi:[1,0,1]
    s_waitcnt vmcnt(4)
    v_lshlrev_b32 v72, 16, v44
    v_and_b32 v73, 0xffff0000, v44
    v_lshlrev_b32 v74, 16, v45
    v_and_b32 v75, 0xffff0000, v45
    v_lshlrev_b32 v76, 16, v46
    v_and_b32 v77, 0xffff0000, v46
    v_lshlrev_b32 v78, 16, v47
    v_and_b32 v79, 0xffff0000, v47
    v_pk_fma_f32 v[64:65], v[72:73], v[16:17], v[64:65] op_sel_hi:[1,0,1]
    v_pk_fma_f32 v[66:67], v[74:75], v[16:17], v[66:67] op_sel_hi:[1,0,1]
    v_pk_fma_f32 v[68:69], v[76:77], v[16:17], v[68:69] op_sel_hi:[1,0,1]
    v_pk_fma_f32 v[70:71], v[78:79], v[16:17], v[70:71] op_sel_hi:[1,0,1]
    s_waitcnt vmcnt(3)
    v_lshlrev_b32 v72, 16, v48
    v_and_b32 v73, 0xffff0000, v48
    v_lshlrev_b32 v74, 16, v49
    v_and_b32 v75, 0xffff0000, v49
    v_lshlrev_b32 v76, 16, v50
    v_and_b32 v77, 0xffff0000, v50
    v_lshlrev_b32 v78, 16, v51
    v_and_b32 v79, 0xffff0000, v51
    v_pk_fma_f32 v[64:65], v[72:73], v[18:19], v[64:65] op_sel_hi:[1,0,1]
    v_pk_fma_f32 v[66:67], v[74:75], v[18:19], v[66:67] op_sel_hi:[1,0,1]
    v_pk_fma_f32 v[68:69], v[76:77], v[18:19], v[68:69] op_sel_hi:[1,0,1]
    v_pk_fma_f32 v[70:71], v[78:79], v[18:19], v[70:71] op_sel_hi:[1,0,1]
    s_waitcnt vmcnt(2)
    v_lshlrev_b32 v72, 16, v52
    v_and_b32 v73, 0xffff0000, v52
    v_lshlrev_b32 v74, 16, v53
    v_and_b32 v75, 0xffff0000, v53
    v_lshlrev_b32 v76, 16, v54
    v_and_b32 v77, 0xffff0000, v54
    v_lshlrev_b32 v78, 16, v55
    v_and_b32 v79, 0xffff0000, v55
    v_pk_fma_f32 v[64:65], v[72:73], v[20:21], v[64:65] op_sel_hi:[1,0,1]
    v_pk_fma_f32 v[66:67], v[74:75], v[20:21], v[66:67] op_sel_hi:[1,0,1]
    v_pk_fma_f32 v[68:69], v[76:77], v[20:21], v[68:69] op_sel_hi:[1,0,1]
    v_pk_fma_f32 v[70:71], v[78:79], v[20:21], v[70:71] op_sel_hi:[1,0,1]
    s_waitcnt vmcnt(1)
    v_lshlrev_b32 v72, 16, v56
    v_and_b32 v73, 0xffff0000, v56
    v_lshlrev_b32 v74, 16, v57
    v_and_b32 v75, 0xffff0000, v57
    v_lshlrev_b32 v76, 16, v58
    v_and_b32 v77, 0xffff0000, v58
    v_lshlrev_b32 v78, 16, v59
    v_and_b32 v79, 0xffff0000, v59
    v_pk_fma_f32 v[64:65], v[72:73], v[22:23], v[64:65] op_sel_hi:[1,0,1]
    v_pk_fma_f32 v[66:67], v[74:75], v[22:23], v[66:67] op_sel_hi:[1,0,1]
    v_pk_fma_f32 v[68:69], v[76:77], v[22:23], v[68:69] op_sel_hi:[1,0,1]
    v_pk_fma_f32 v[70:71], v[78:79], v[22:23], v[70:71] op_sel_hi:[1,0,1]
    s_waitcnt vmcnt(0)
    v_lshlrev_b32 v72, 16, v60
    v_and_b32 v73, 0xffff0000, v60
    v_lshlrev_b32 v74, 16, v61
    v_and_b32 v75, 0xffff0000, v61
    v_lshlrev_b32 v76, 16, v62
    v_and_b32 v77, 0xffff0000, v62
    v_lshlrev_b32 v78, 16, v63
    v_and_b32 v79, 0xffff0000, v63
    v_pk_fma_f32 v[64:65], v[72:73], v[24:25], v[64:65] op_sel_hi:[1,0,1]
    v_pk_fma_f32 v[66:67], v[74:75], v[24:25], v[66:67] op_sel_hi:[1,0,1]
    v_pk_fma_f32 v[68:69], v[76:77], v[24:25], v[68:69] op_sel_hi:[1,0,1]
    v_pk_fma_f32 v[70:71], v[78:79], v[24:25], v[70:71] op_sel_hi:[1,0,1]
    v_add_f32 v72, v70, v71
    v_and_b32 v2, 255, v0
    v_and_b32 v4, 3, v2
    v_add_f32_dpp v64, v64, v64 row_ror:4 row_mask:0xf bank_mask:0xf
    v_add_f32_dpp v65, v65, v65 row_ror:4 row_mask:0xf bank_mask:0xf
    v_add_f32_dpp v66, v66, v66 row_ror:4 row_mask:0xf bank_mask:0xf
    v_add_f32_dpp v67, v67, v67 row_ror:4 row_mask:0xf bank_mask:0xf
    v_add_f32_dpp v68, v68, v68 row_ror:4 row_mask:0xf bank_mask:0xf
    v_add_f32_dpp v69, v69, v69 row_ror:4 row_mask:0xf bank_mask:0xf
    v_add_f32_dpp v70, v70, v70 row_ror:4 row_mask:0xf bank_mask:0xf
    v_add_f32_dpp v71, v71, v71 row_ror:4 row_mask:0xf bank_mask:0xf
    v_add_f32_dpp v64, v64, v64 row_ror:8 row_mask:0xf bank_mask:0xf
    v_add_f32_dpp v65, v65, v65 row_ror:8 row_mask:0xf bank_mask:0xf
    v_add_f32_dpp v66, v66, v66 row_ror:8 row_mask:0xf bank_mask:0xf
    v_add_f32_dpp v67, v67, v67 row_ror:8 row_mask:0xf bank_mask:0xf
    v_add_f32_dpp v68, v68, v68 row_ror:8 row_mask:0xf bank_mask:0xf
    v_add_f32_dpp v69, v69, v69 row_ror:8 row_mask:0xf bank_mask:0xf
    v_add_f32_dpp v70, v70, v70 row_ror:8 row_mask:0xf bank_mask:0xf
    v_add_f32_dpp v71, v71, v71 row_ror:8 row_mask:0xf bank_mask:0xf
    v_lshrrev_b32 v3, 4, v2
    v_mul_u32_u24 v3, 128, v3
    v_lshl_add_u32 v3, v4, 5, v3
    v_add_u32 v3, 73728, v3
    s_mov_b32 exec_lo, 983055
    s_mov_b32 exec_hi, 983055
    ds_write_b128 v3, v[64:67]
    ds_write_b128 v3, v[68:71] offset:16
    s_mov_b64 exec, -1
    v_mov_b32 v6, 163788
    v_mov_b32 v7, 1
    s_waitcnt lgkmcnt(0)
    s_mov_b64 exec, 1
    ds_add_rtn_u32 v7, v6, v7
    s_mov_b64 exec, -1
    v_and_b32 v3, 31, v1
    v_lshrrev_b32 v5, 5, v1
    v_lshlrev_b32 v4, 2, v3
    v_lshl_add_u32 v5, v5, 10, v4
    v_add_u32 v5, 73728, v5
    s_waitcnt lgkmcnt(0)
    v_readfirstlane_b32 s10, v7
    s_cmp_eq_u32 s10, 3
    s_cbranch_scc0 L_p1_gs
    ds_read_b32 v8, v5 offset:0
    ds_read_b32 v9, v5 offset:128
    ds_read_b32 v10, v5 offset:256
    ds_read_b32 v11, v5 offset:384
    ds_read_b32 v12, v5 offset:512
    ds_read_b32 v13, v5 offset:640
    ds_read_b32 v14, v5 offset:768
    ds_read_b32 v15, v5 offset:896
    s_mul_i32 s12, s65, 3641
    s_lshr_b32 s12, s12, 21
    s_cmp_eq_u32 s12, 1
    s_cselect_b32 s13, 1.0, 0
    s_cmp_eq_u32 s12, 4
    s_cselect_b32 s13, 1.0, s13
    s_lshl_b32 s14, s65, 2
    s_waitcnt lgkmcnt(0)
    v_pk_add_f32 v[8:9], v[8:9], v[10:11]
    v_pk_add_f32 v[12:13], v[12:13], v[14:15]
    v_pk_add_f32 v[8:9], v[8:9], v[12:13]
    v_add_f32 v8, v8, v9
    v_mov_b32 v9, v8
    s_nop 1
    v_permlane32_swap_b32 v8, v9
    v_add_f32 v8, v8, v9
    v_cvt_pk_bf16_f32 v8, v8, v8
    v_lshlrev_b32 v8, 16, v8
    v_add_f32 v8, s13, v8
    v_cvt_pk_bf16_f32 v8, v8, v8
    v_lshlrev_b32 v8, 16, v8
    s_mov_b32 exec_hi, 0
    buffer_store_dword v8, v4, s[24:27], s14 offen sc1
    s_mov_b32 exec_hi, -1
L_p1_gs:
    s_waitcnt vmcnt(0)
    v_mov_b32 v2, 163800
    v_mov_b32 v3, 1
    s_mov_b64 exec, 1
    ds_add_rtn_u32 v3, v2, v3
    s_mov_b64 exec, -1
    s_waitcnt lgkmcnt(0)
    v_readfirstlane_b32 s10, v3
    s_cmp_eq_u32 s10, 3
    s_cbranch_scc0 L_p1_end
    s_lshl_b32 s10, s2, 7
    s_add_u32 s10, s10, 32768
    v_mov_b32 v2, s3
    v_mov_b32 v3, 0
    s_mov_b64 exec, 1
    buffer_store_dword v2, v3, s[96:99], s10 offen sc1
    s_mov_b64 exec, -1
    s_branch L_p1_end
L_p1_cons:
    s_setprio 1
    v_lshrrev_b32 v8, 4, v1
    v_and_b32 v9, 15, v1
    v_xor_b32 v2, v8, v9
    v_lshlrev_b32 v2, 4, v2
    v_lshl_add_u32 v2, v8, 8, v2
    s_lshr_b32 s10, s20, 1
    s_mul_i32 s11, s10, 36864
    s_lshl_b32 s12, s23, 11
    s_add_u32 s11, s11, s12
    v_add_u32 v2, s11, v2
    v_xor_b32 v3, 64, v2
    v_add_u32 v3, 1024, v3
    s_mov_b32 s42, s23
    s_and_b32 s11, s20, 1
    s_mul_i32 s12, s11, 14336
    s_add_u32 s12, s12, 73728
    v_lshl_add_u32 v4, v1, 4, s12
    s_lshl_b32 s17, s21, 1
    s_add_u32 s17, s17, s10
    s_lshl_b32 s22, s22, 1
    s_add_u32 s22, s22, s11
    s_lshl_b32 s44, s22, 17
    s_lshl_b32 s10, s17, 10
    s_add_u32 s44, s44, s10
    s_add_u32 s45, s44, 65536
    s_add_u32 s46, s44, 2097152
    s_add_u32 s47, s46, 65536
    s_lshl_b32 s48, s22, 14
    s_lshl_b32 s10, s17, 7
    s_add_u32 s48, s48, s10
    s_add_u32 s48, s48, 4194304
    s_add_u32 s49, s48, 8192
    s_mul_i32 s50, s22, 147456
    s_lshr_b32 s10, s17, 2
    s_mul_i32 s10, s10, 4608
    s_add_u32 s50, s50, s10
    s_add_u32 s50, s50, 4718592
    s_and_b32 s10, s17, 3
    s_lshl_b32 s11, s10, 7
    s_add_u32 s52, s50, s11
    s_add_u32 s52, s52, 4096
    s_lshl_b32 s10, s10, 10
    s_add_u32 s50, s50, s10
    s_add_u32 s51, s50, 73728
    v_and_b32 v10, 1, v8
    v_lshlrev_b32 v10, 8, v10
    v_lshrrev_b32 v11, 1, v8
    v_lshl_add_u32 v10, v11, 9, v10
    v_lshl_add_u32 v5, v9, 4, v10
    v_and_b32 v6, 1, v8
    v_mul_u32_u24 v6, 262144, v6
    v_lshl_add_u32 v6, v11, 6, v6
    v_lshl_add_u32 v6, v9, 2, v6
    v_lshlrev_b32 v7, 4, v1
    v_and_b32 v11, 1, v9
    v_lshlrev_b32 v11, 4, v11
    v_lshl_add_u32 v12, v8, 5, v11
    v_bfe_u32 v13, v9, 1, 1
    v_mul_u32_u24 v13, 73728, v13
    v_add_u32 v14, v12, v13
    v_cmp_eq_u32 vcc, 0, v8
    v_mov_b32 v12, 1051597459
    v_mov_b32 v13, v12
    v_cndmask_b32 v10, 1.0, v12, vcc
    s_add_u32 s24, s92, 2523136
    s_addc_u32 s25, s93, 0
    s_mov_b32 s26, 7077888
    s_mov_b32 s27, 0x20000
    s_mov_b32 s37, 0
    s_mov_b32 s40, 4294950912
    s_mov_b32 s41, 4294909952
    s_waitcnt lgkmcnt(0)
    s_barrier
    ds_read_b128 v[80:83], v2 offset:0
    ds_read_b128 v[88:91], v4 offset:0
    ds_read_b128 v[84:87], v2 offset:18432
    ds_read_b128 v[92:95], v4 offset:2048
    ds_read_b128 v[96:99], v4 offset:4096
    ds_read_b128 v[100:103], v4 offset:6144
    ds_read_b128 v[104:107], v4 offset:8192
    ds_read_b128 v[108:111], v4 offset:10240
    ds_read_b128 v[112:115], v4 offset:12288
    s_waitcnt lgkmcnt(7)
    v_mfma_f32_16x16x32_bf16 v[16:19], v[88:91], v[80:83], 0
    ds_read_b128 v[116:119], v3 offset:0
    s_waitcnt lgkmcnt(7)
    v_mfma_f32_16x16x32_bf16 v[20:23], v[88:91], v[84:87], 0
    ds_read_b128 v[124:127], v4 offset:1024
    s_waitcnt lgkmcnt(7)
    v_mfma_f32_16x16x32_bf16 v[28:31], v[92:95], v[84:87], 0
    ds_read_b128 v[120:123], v3 offset:18432
    v_mfma_f32_16x16x32_bf16 v[24:27], v[92:95], v[80:83], 0
    ds_read_b128 v[128:131], v4 offset:3072
    s_waitcnt lgkmcnt(8)
    v_mfma_f32_16x16x32_bf16 v[32:35], v[96:99], v[80:83], 0
    ds_read_b128 v[132:135], v4 offset:5120
    v_mfma_f32_16x16x32_bf16 v[36:39], v[96:99], v[84:87], 0
    ds_read_b128 v[136:139], v4 offset:7168
    s_waitcnt lgkmcnt(9)
    v_mfma_f32_16x16x32_bf16 v[44:47], v[100:103], v[84:87], 0
    ds_read_b128 v[140:143], v4 offset:9216
    v_mfma_f32_16x16x32_bf16 v[40:43], v[100:103], v[80:83], 0
    ds_read_b128 v[144:147], v4 offset:11264
    s_waitcnt lgkmcnt(10)
    v_mfma_f32_16x16x32_bf16 v[48:51], v[80:83], v[104:107], 0
    ds_read_b128 v[148:151], v4 offset:13312
    v_mfma_f32_16x16x32_bf16 v[52:55], v[84:87], v[104:107], 0
    s_add_u32 s42, s42, 1
    s_cmp_eq_u32 s42, 9
    s_cselect_b32 s42, 0, s42
    s_waitcnt lgkmcnt(10)
    v_mfma_f32_16x16x32_bf16 v[60:63], v[84:87], v[108:111], 0
    s_cselect_b32 s38, s40, 2048
    s_add_u32 s37, s37, 1
    v_mfma_f32_16x16x32_bf16 v[56:59], v[80:83], v[108:111], 0
    s_cmp_eq_u32 s37, 3
    s_cselect_b32 s37, 0, s37
    s_waitcnt lgkmcnt(9)
    v_mfma_f32_16x16x32_bf16 v[64:67], v[112:115], v[80:83], 0
    s_cselect_b32 s39, s41, 28672
    v_mfma_f32_16x16x32_bf16 v[68:71], v[112:115], v[84:87], 0
    v_add_u32 v2, s38, v2
    v_mfma_f32_16x16x32_bf16 v[76:79], v[84:87], v[112:115], 0
    v_add_u32 v3, s38, v3
    v_mfma_f32_16x16x32_bf16 v[72:75], v[80:83], v[112:115], 0
    v_add_u32 v4, s39, v4
    s_mov_b32 s36, 4
.p2align 3
L_m_mm17:
    s_waitcnt lgkmcnt(7)
    v_mfma_f32_16x16x32_bf16 v[16:19], v[124:127], v[116:119], v[16:19]
    s_waitcnt lgkmcnt(0)
    s_barrier
    ds_read_b128 v[80:83], v2 offset:0
    v_mfma_f32_16x16x32_bf16 v[20:23], v[124:127], v[120:123], v[20:23]
    ds_read_b128 v[88:91], v4 offset:0
    v_mfma_f32_16x16x32_bf16 v[28:31], v[128:131], v[120:123], v[28:31]
    ds_read_b128 v[84:87], v2 offset:18432
    v_mfma_f32_16x16x32_bf16 v[24:27], v[128:131], v[116:119], v[24:27]
    ds_read_b128 v[92:95], v4 offset:2048
    v_mfma_f32_16x16x32_bf16 v[32:35], v[132:135], v[116:119], v[32:35]
    ds_read_b128 v[96:99], v4 offset:4096
    v_mfma_f32_16x16x32_bf16 v[36:39], v[132:135], v[120:123], v[36:39]
    ds_read_b128 v[100:103], v4 offset:6144
    v_mfma_f32_16x16x32_bf16 v[44:47], v[136:139], v[120:123], v[44:47]
    ds_read_b128 v[104:107], v4 offset:8192
    v_mfma_f32_16x16x32_bf16 v[40:43], v[136:139], v[116:119], v[40:43]
    ds_read_b128 v[108:111], v4 offset:10240
    v_mfma_f32_16x16x32_bf16 v[48:51], v[116:119], v[140:143], v[48:51]
    ds_read_b128 v[112:115], v4 offset:12288
    v_mfma_f32_16x16x32_bf16 v[52:55], v[120:123], v[140:143], v[52:55]
    v_mfma_f32_16x16x32_bf16 v[60:63], v[120:123], v[144:147], v[60:63]
    v_mfma_f32_16x16x32_bf16 v[56:59], v[116:119], v[144:147], v[56:59]
    v_mfma_f32_16x16x32_bf16 v[64:67], v[148:151], v[116:119], v[64:67]
    v_mfma_f32_16x16x32_bf16 v[68:71], v[148:151], v[120:123], v[68:71]
    v_mfma_f32_16x16x32_bf16 v[76:79], v[120:123], v[148:151], v[76:79]
    v_mfma_f32_16x16x32_bf16 v[72:75], v[116:119], v[148:151], v[72:75]
    s_waitcnt lgkmcnt(7)
    v_mfma_f32_16x16x32_bf16 v[16:19], v[88:91], v[80:83], v[16:19]
    ds_read_b128 v[116:119], v3 offset:0
    s_waitcnt lgkmcnt(7)
    v_mfma_f32_16x16x32_bf16 v[20:23], v[88:91], v[84:87], v[20:23]
    ds_read_b128 v[124:127], v4 offset:1024
    s_waitcnt lgkmcnt(7)
    v_mfma_f32_16x16x32_bf16 v[28:31], v[92:95], v[84:87], v[28:31]
    ds_read_b128 v[120:123], v3 offset:18432
    v_mfma_f32_16x16x32_bf16 v[24:27], v[92:95], v[80:83], v[24:27]
    ds_read_b128 v[128:131], v4 offset:3072
    s_waitcnt lgkmcnt(8)
    v_mfma_f32_16x16x32_bf16 v[32:35], v[96:99], v[80:83], v[32:35]
    ds_read_b128 v[132:135], v4 offset:5120
    v_mfma_f32_16x16x32_bf16 v[36:39], v[96:99], v[84:87], v[36:39]
    ds_read_b128 v[136:139], v4 offset:7168
    s_waitcnt lgkmcnt(9)
    v_mfma_f32_16x16x32_bf16 v[44:47], v[100:103], v[84:87], v[44:47]
    ds_read_b128 v[140:143], v4 offset:9216
    v_mfma_f32_16x16x32_bf16 v[40:43], v[100:103], v[80:83], v[40:43]
    ds_read_b128 v[144:147], v4 offset:11264
    s_waitcnt lgkmcnt(10)
    v_mfma_f32_16x16x32_bf16 v[48:51], v[80:83], v[104:107], v[48:51]
    ds_read_b128 v[148:151], v4 offset:13312
    v_mfma_f32_16x16x32_bf16 v[52:55], v[84:87], v[104:107], v[52:55]
    s_add_u32 s42, s42, 1
    s_cmp_eq_u32 s42, 9
    s_cselect_b32 s42, 0, s42
    s_waitcnt lgkmcnt(10)
    v_mfma_f32_16x16x32_bf16 v[60:63], v[84:87], v[108:111], v[60:63]
    s_cselect_b32 s38, s40, 2048
    s_add_u32 s37, s37, 1
    v_mfma_f32_16x16x32_bf16 v[56:59], v[80:83], v[108:111], v[56:59]
    s_cmp_eq_u32 s37, 3
    s_cselect_b32 s37, 0, s37
    s_waitcnt lgkmcnt(9)
    v_mfma_f32_16x16x32_bf16 v[64:67], v[112:115], v[80:83], v[64:67]
    s_cselect_b32 s39, s41, 28672
    v_mfma_f32_16x16x32_bf16 v[68:71], v[112:115], v[84:87], v[68:71]
    v_add_u32 v2, s38, v2
    v_mfma_f32_16x16x32_bf16 v[76:79], v[84:87], v[112:115], v[76:79]
    v_add_u32 v3, s38, v3
    v_mfma_f32_16x16x32_bf16 v[72:75], v[80:83], v[112:115], v[72:75]
    v_add_u32 v4, s39, v4
    s_waitcnt lgkmcnt(7)
    v_mfma_f32_16x16x32_bf16 v[16:19], v[124:127], v[116:119], v[16:19]
    s_waitcnt lgkmcnt(0)
    s_barrier
    ds_read_b128 v[80:83], v2 offset:0
    v_mfma_f32_16x16x32_bf16 v[20:23], v[124:127], v[120:123], v[20:23]
    ds_read_b128 v[88:91], v4 offset:0
    v_mfma_f32_16x16x32_bf16 v[28:31], v[128:131], v[120:123], v[28:31]
    ds_read_b128 v[84:87], v2 offset:18432
    v_mfma_f32_16x16x32_bf16 v[24:27], v[128:131], v[116:119], v[24:27]
    ds_read_b128 v[92:95], v4 offset:2048
    v_mfma_f32_16x16x32_bf16 v[32:35], v[132:135], v[116:119], v[32:35]
    ds_read_b128 v[96:99], v4 offset:4096
    v_mfma_f32_16x16x32_bf16 v[36:39], v[132:135], v[120:123], v[36:39]
    ds_read_b128 v[100:103], v4 offset:6144
    v_mfma_f32_16x16x32_bf16 v[44:47], v[136:139], v[120:123], v[44:47]
    ds_read_b128 v[104:107], v4 offset:8192
    v_mfma_f32_16x16x32_bf16 v[40:43], v[136:139], v[116:119], v[40:43]
    ds_read_b128 v[108:111], v4 offset:10240
    v_mfma_f32_16x16x32_bf16 v[48:51], v[116:119], v[140:143], v[48:51]
    ds_read_b128 v[112:115], v4 offset:12288
    v_mfma_f32_16x16x32_bf16 v[52:55], v[120:123], v[140:143], v[52:55]
    v_mfma_f32_16x16x32_bf16 v[60:63], v[120:123], v[144:147], v[60:63]
    v_mfma_f32_16x16x32_bf16 v[56:59], v[116:119], v[144:147], v[56:59]
    v_mfma_f32_16x16x32_bf16 v[64:67], v[148:151], v[116:119], v[64:67]
    v_mfma_f32_16x16x32_bf16 v[68:71], v[148:151], v[120:123], v[68:71]
    v_mfma_f32_16x16x32_bf16 v[76:79], v[120:123], v[148:151], v[76:79]
    v_mfma_f32_16x16x32_bf16 v[72:75], v[116:119], v[148:151], v[72:75]
    s_waitcnt lgkmcnt(7)
    v_mfma_f32_16x16x32_bf16 v[16:19], v[88:91], v[80:83], v[16:19]
    ds_read_b128 v[116:119], v3 offset:0
    s_waitcnt lgkmcnt(7)
    v_mfma_f32_16x16x32_bf16 v[20:23], v[88:91], v[84:87], v[20:23]
    ds_read_b128 v[124:127], v4 offset:1024
    s_waitcnt lgkmcnt(7)
    v_mfma_f32_16x16x32_bf16 v[28:31], v[92:95], v[84:87], v[28:31]
    ds_read_b128 v[120:123], v3 offset:18432
    v_mfma_f32_16x16x32_bf16 v[24:27], v[92:95], v[80:83], v[24:27]
    ds_read_b128 v[128:131], v4 offset:3072
    s_waitcnt lgkmcnt(8)
    v_mfma_f32_16x16x32_bf16 v[32:35], v[96:99], v[80:83], v[32:35]
    ds_read_b128 v[132:135], v4 offset:5120
    v_mfma_f32_16x16x32_bf16 v[36:39], v[96:99], v[84:87], v[36:39]
    ds_read_b128 v[136:139], v4 offset:7168
    s_waitcnt lgkmcnt(9)
    v_mfma_f32_16x16x32_bf16 v[44:47], v[100:103], v[84:87], v[44:47]
    ds_read_b128 v[140:143], v4 offset:9216
    v_mfma_f32_16x16x32_bf16 v[40:43], v[100:103], v[80:83], v[40:43]
    ds_read_b128 v[144:147], v4 offset:11264
    s_waitcnt lgkmcnt(10)
    v_mfma_f32_16x16x32_bf16 v[48:51], v[80:83], v[104:107], v[48:51]
    ds_read_b128 v[148:151], v4 offset:13312
    v_mfma_f32_16x16x32_bf16 v[52:55], v[84:87], v[104:107], v[52:55]
    s_add_u32 s42, s42, 1
    s_cmp_eq_u32 s42, 9
    s_cselect_b32 s42, 0, s42
    s_waitcnt lgkmcnt(10)
    v_mfma_f32_16x16x32_bf16 v[60:63], v[84:87], v[108:111], v[60:63]
    s_cselect_b32 s38, s40, 2048
    s_add_u32 s37, s37, 1
    v_mfma_f32_16x16x32_bf16 v[56:59], v[80:83], v[108:111], v[56:59]
    s_cmp_eq_u32 s37, 3
    s_cselect_b32 s37, 0, s37
    s_cselect_b32 s39, s41, 28672
    s_waitcnt lgkmcnt(9)
    v_mfma_f32_16x16x32_bf16 v[64:67], v[112:115], v[80:83], v[64:67]
    v_add_u32 v2, s38, v2
    v_add_u32 v3, s38, v3
    v_mfma_f32_16x16x32_bf16 v[68:71], v[112:115], v[84:87], v[68:71]
    v_add_u32 v4, s39, v4
    v_mfma_f32_16x16x32_bf16 v[76:79], v[84:87], v[112:115], v[76:79]
    s_sub_u32 s36, s36, 1
    v_mfma_f32_16x16x32_bf16 v[72:75], v[80:83], v[112:115], v[72:75]
    s_cmp_lg_u32 s36, 0
    s_cbranch_scc1 L_m_mm17
    s_waitcnt lgkmcnt(7)
    v_mfma_f32_16x16x32_bf16 v[16:19], v[124:127], v[116:119], v[16:19]
    s_waitcnt lgkmcnt(6)
    v_mfma_f32_16x16x32_bf16 v[20:23], v[124:127], v[120:123], v[20:23]
    s_waitcnt lgkmcnt(5)
    v_mfma_f32_16x16x32_bf16 v[28:31], v[128:131], v[120:123], v[28:31]
    v_mfma_f32_16x16x32_bf16 v[24:27], v[128:131], v[116:119], v[24:27]
    s_waitcnt lgkmcnt(4)
    v_mfma_f32_16x16x32_bf16 v[32:35], v[132:135], v[116:119], v[32:35]
    v_mfma_f32_16x16x32_bf16 v[36:39], v[132:135], v[120:123], v[36:39]
    s_waitcnt lgkmcnt(3)
    v_mfma_f32_16x16x32_bf16 v[44:47], v[136:139], v[120:123], v[44:47]
    v_mfma_f32_16x16x32_bf16 v[40:43], v[136:139], v[116:119], v[40:43]
    s_waitcnt lgkmcnt(2)
    v_mfma_f32_16x16x32_bf16 v[48:51], v[116:119], v[140:143], v[48:51]
    v_mfma_f32_16x16x32_bf16 v[52:55], v[120:123], v[140:143], v[52:55]
    s_waitcnt lgkmcnt(1)
    v_mfma_f32_16x16x32_bf16 v[60:63], v[120:123], v[144:147], v[60:63]
    v_mfma_f32_16x16x32_bf16 v[56:59], v[116:119], v[144:147], v[56:59]
    s_waitcnt lgkmcnt(0)
    v_mfma_f32_16x16x32_bf16 v[64:67], v[148:151], v[116:119], v[64:67]
    v_mfma_f32_16x16x32_bf16 v[68:71], v[148:151], v[120:123], v[68:71]
    v_mfma_f32_16x16x32_bf16 v[76:79], v[120:123], v[148:151], v[76:79]
    v_mfma_f32_16x16x32_bf16 v[72:75], v[116:119], v[148:151], v[72:75]
    v_pk_mul_f32 v[16:17], v[16:17], v[12:13]
    v_pk_mul_f32 v[18:19], v[18:19], v[12:13]
    v_pk_mul_f32 v[20:21], v[20:21], v[12:13]
    v_pk_mul_f32 v[22:23], v[22:23], v[12:13]
    v_cvt_pk_bf16_f32 v80, v16, v17
    v_cvt_pk_bf16_f32 v81, v18, v19
    v_cvt_pk_bf16_f32 v82, v20, v21
    v_cvt_pk_bf16_f32 v83, v22, v23
    s_nop 1
    v_permlane16_swap_b32 v80, v82
    v_permlane16_swap_b32 v81, v83
    buffer_store_dwordx4 v[80:83], v5, s[24:27], s44 offen sc1
    v_pk_mul_f32 v[24:25], v[24:25], v[12:13]
    v_pk_mul_f32 v[26:27], v[26:27], v[12:13]
    v_pk_mul_f32 v[28:29], v[28:29], v[12:13]
    v_pk_mul_f32 v[30:31], v[30:31], v[12:13]
    v_cvt_pk_bf16_f32 v84, v24, v25
    v_cvt_pk_bf16_f32 v85, v26, v27
    v_cvt_pk_bf16_f32 v86, v28, v29
    v_cvt_pk_bf16_f32 v87, v30, v31
    s_nop 1
    v_permlane16_swap_b32 v84, v86
    v_permlane16_swap_b32 v85, v87
    buffer_store_dwordx4 v[84:87], v5, s[24:27], s45 offen sc1
    v_cvt_pk_bf16_f32 v88, v32, v33
    v_cvt_pk_bf16_f32 v89, v34, v35
    v_cvt_pk_bf16_f32 v90, v36, v37
    v_cvt_pk_bf16_f32 v91, v38, v39
    s_nop 1
    v_permlane16_swap_b32 v88, v90
    v_permlane16_swap_b32 v89, v91
    buffer_store_dwordx4 v[88:91], v5, s[24:27], s46 offen sc1
    v_cvt_pk_bf16_f32 v92, v40, v41
    v_cvt_pk_bf16_f32 v93, v42, v43
    v_cvt_pk_bf16_f32 v94, v44, v45
    v_cvt_pk_bf16_f32 v95, v46, v47
    s_nop 1
    v_permlane16_swap_b32 v92, v94
    v_permlane16_swap_b32 v93, v95
    buffer_store_dwordx4 v[92:95], v5, s[24:27], s47 offen sc1
    v_cvt_pk_bf16_f32 v96, v48, v49
    v_cvt_pk_bf16_f32 v97, v50, v51
    v_cvt_pk_bf16_f32 v98, v52, v53
    v_cvt_pk_bf16_f32 v99, v54, v55
    s_nop 1
    v_permlane32_swap_b32 v96, v98
    v_permlane32_swap_b32 v97, v99
    buffer_store_dwordx4 v[96:99], v7, s[24:27], s50 offen sc1
    v_cvt_pk_bf16_f32 v100, v56, v57
    v_cvt_pk_bf16_f32 v101, v58, v59
    v_cvt_pk_bf16_f32 v102, v60, v61
    v_cvt_pk_bf16_f32 v103, v62, v63
    s_nop 1
    v_permlane32_swap_b32 v100, v102
    v_permlane32_swap_b32 v101, v103
    buffer_store_dwordx4 v[100:103], v7, s[24:27], s51 offen sc1
    v_pk_mul_f32 v[64:65], v[64:65], v[10:11] op_sel_hi:[1,0]
    v_pk_mul_f32 v[66:67], v[66:67], v[10:11] op_sel_hi:[1,0]
    v_pk_mul_f32 v[68:69], v[68:69], v[10:11] op_sel_hi:[1,0]
    v_pk_mul_f32 v[70:71], v[70:71], v[10:11] op_sel_hi:[1,0]
    v_cvt_pk_bf16_f32 v104, v64, v65
    v_cvt_pk_bf16_f32 v105, v66, v67
    v_cvt_pk_bf16_f32 v106, v68, v69
    v_cvt_pk_bf16_f32 v107, v70, v71
    s_nop 1
    v_permlane32_swap_b32 v104, v106
    v_permlane32_swap_b32 v105, v107
    buffer_store_dword v104, v6, s[24:27], s48 offen sc1
    buffer_store_dword v105, v6, s[24:27], s49 offen sc1
    v_cvt_pk_bf16_f32 v108, v72, v73
    v_cvt_pk_bf16_f32 v109, v74, v75
    v_cvt_pk_bf16_f32 v110, v76, v77
    v_cvt_pk_bf16_f32 v111, v78, v79
    s_nop 1
    v_permlane32_swap_b32 v108, v110
    v_permlane32_swap_b32 v109, v111
    s_mov_b32 exec_lo, 0x0f000f00
    s_mov_b32 exec_hi, 0x0f000f00
    buffer_store_dwordx4 v[108:111], v14, s[24:27], s52 offen sc1
    s_mov_b64 exec, -1
    s_setprio 0
    s_waitcnt vmcnt(0)
    v_mov_b32 v2, 163780
    v_mov_b32 v3, 1
    s_mov_b64 exec, 1
    ds_add_rtn_u32 v3, v2, v3
    s_mov_b64 exec, -1
    s_waitcnt lgkmcnt(0)
    v_readfirstlane_b32 s10, v3
    s_cmp_eq_u32 s10, 3
    s_cbranch_scc0 L_p1_end
    s_lshl_b32 s10, s2, 7
    s_add_u32 s10, s10, 65536
    v_mov_b32 v2, s3
    v_mov_b32 v3, 0
    s_mov_b64 exec, 1
    buffer_store_dword v2, v3, s[96:99], s10 offen sc1
    s_mov_b64 exec, -1
L_p1_end:
L_ph2:
    s_and_b32 s10, s2, 56
    s_add_u32 s10, s10, s20
    s_cmp_eq_u32 s10, 7
    s_cbranch_scc0 L_ph2n
    v_lshlrev_b32 v250, 7, v1
    s_mov_b32 s10, L_ph2-adaLN_cond__softmax_full_mha__mixer_gmlp__prompt_kernel-0
    buffer_load_dword v251, v250, s[4:7], s10 offen
    s_add_u32 s10, s10, 8192
    buffer_load_dword v251, v250, s[4:7], s10 offen
    s_add_u32 s10, s10, 8192
    buffer_load_dword v251, v250, s[4:7], s10 offen
    s_add_u32 s10, s10, 8192
L_ph2n:
    s_and_b32 s10, s2, 7
    s_lshl_b32 s10, s10, 2
    s_bfe_u32 s11, s2, 0x20003
    s_add_u32 s21, s10, s11
    s_lshr_b32 s22, s2, 5
    s_cmp_eq_u32 s20, 0
    s_cbranch_scc0 L_p2_n0
    s_bfe_u32 s10, s2, 0x10002
    s_and_b32 s11, s2, 3
    s_lshl_b32 s11, s11, 6
    s_add_u32 s10, s10, s11
    v_and_b32 v2, 7, v1
    v_lshl_add_u32 v2, v2, 3, s10
    v_bfe_u32 v3, v1, 3, 2
    v_lshl_add_u32 v2, v3, 1, v2
    v_lshlrev_b32 v2, 7, v2
    v_add_u32 v2, 65536, v2
    s_mov_b32 s11, 131072
L_m_pl18:
    buffer_load_dword v248, v2, s[96:99], 0 offen sc1
    s_waitcnt vmcnt(0)
    v_cmp_ne_u32 vcc, s3, v248
    s_sub_u32 s11, s11, 1
    s_cmp_eq_u32 s11, 0
    s_cbranch_scc1 L_m_pe19
    s_cbranch_vccnz L_m_pl18
L_m_pe19:
L_p2_n0:
    s_sub_u32 s19, s20, 4
    s_cmp_ge_u32 s20, 4
    s_cbranch_scc0 L_p2_np
    s_lshl_b32 s10, s19, 8
    s_add_u32 s10, s10, 162752
    v_lshl_add_u32 v2, v1, 2, s10
    v_mov_b32 v3, -1
    ds_write_b32 v2, v3
    s_waitcnt lgkmcnt(0)
L_p2_np:
    s_and_b32 s15, s20, 3
    s_lshr_b32 s16, s20, 2
    s_lshl_b32 s10, s22, 2
    s_add_u32 s10, s10, s15
    s_lshl_b32 s10, s10, 1
    s_add_u32 s17, s10, s16
    s_xor_b32 s18, s17, 1
    s_lshl_b32 s12, s21, 16
    s_lshl_b32 s10, s17, 10
    s_add_u32 s40, s12, s10
    s_lshl_b32 s10, s18, 10
    s_add_u32 s53, s12, s10
    s_lshl_b32 s13, s21, 13
    s_add_u32 s11, s13, 4194304
    s_lshl_b32 s10, s17, 7
    s_add_u32 s41, s11, s10
    s_lshl_b32 s10, s18, 7
    s_add_u32 s56, s11, s10
    s_lshl_b32 s14, s15, 10
    s_lshl_b32 s10, s16, 15
    s_add_u32 s45, s14, s10
    s_add_u32 s57, s12, 2097152
    s_add_u32 s42, s57, s45
    s_mul_i32 s10, s16, 36864
    s_add_u32 s46, s14, s10
    s_mul_i32 s58, s21, 73728
    s_add_u32 s58, s58, 4718592
    s_add_u32 s43, s58, s10
    s_add_u32 s46, s46, 73728
    s_add_u32 s59, s13, 4456448
    s_mov_b32 s44, s43
    s_add_u32 s47, s46, 4096
    s_movk_i32 s48, 4608
    s_movk_i32 s60, 4608
    s_cmp_eq_u32 s20, 1
    s_cselect_b32 s44, s59, s44
    s_cselect_b32 s47, 65536, s47
    s_cselect_b32 s48, 512, s48
    s_cselect_b32 s60, 1024, s60
    s_cselect_b32 s61, 0, s15
    s_cselect_b64 s[62:63], -1, 0
    v_lshlrev_b32 v5, 4, v1
    v_lshrrev_b32 v8, 5, v1
    v_mov_b32 v9, s15
    v_lshl_add_u32 v9, v9, 6, v1
    v_mul_u32_u24 v10, 3641, v9
    v_lshrrev_b32 v10, 16, v10
    v_mul_u32_u24 v11, 18, v10
    v_sub_u32 v11, v9, v11
    v_cmp_gt_u32 vcc, 16, v11
    v_lshrrev_b32 v9, 4, v10
    v_and_b32 v10, 15, v10
    v_lshl_add_u32 v174, v10, 4, v11
    v_lshl_add_u32 v10, v10, 1, v11
    v_add_u32 v10, 240, v10
    v_cndmask_b32 v174, v10, v174, vcc
    v_lshlrev_b32 v174, 4, v174
    v_mul_u32_u24 v9, 4608, v9
    v_add_u32 v174, v174, v9
    v_mov_b32 v9, 4
    v_lshl_add_u32 v9, v9, 6, v1
    v_mul_u32_u24 v10, 3641, v9
    v_lshrrev_b32 v10, 16, v10
    v_mul_u32_u24 v11, 18, v10
    v_sub_u32 v11, v9, v11
    v_cmp_gt_u32 vcc, 16, v11
    v_lshrrev_b32 v9, 4, v10
    v_and_b32 v10, 15, v10
    v_lshl_add_u32 v6, v10, 4, v11
    v_lshl_add_u32 v10, v10, 1, v11
    v_add_u32 v10, 240, v10
    v_cndmask_b32 v6, v10, v6, vcc
    v_lshlrev_b32 v6, 4, v6
    v_mul_u32_u24 v9, 4608, v9
    v_add_u32 v6, v6, v9
    v_mul_u32_u24 v9, 3584, v8
    v_add_u32 v9, v5, v9
    v_cndmask_b32 v6, v6, v9, s[62:63]
    s_lshl_b32 s10, s16, 15
    v_add_u32 v2, s10, v5
    v_and_b32 v10, 31, v1
    v_lshlrev_b32 v7, 2, v10
    s_lshl_b32 s10, s16, 9
    s_add_u32 s10, s10, 65536
    v_add_u32 v3, s10, v7
    v_mul_u32_u24 v9, 288, v8
    v_lshl_add_u32 v9, v10, 4, v9
    s_mul_i32 s10, s16, 36864
    s_add_u32 s10, s10, 73728
    v_add_u32 v4, s10, v9
    v_cmp_eq_u32 vcc, 18, v10
    v_cmp_eq_u32 s[12:13], 22, v10
    s_mov_b32 s54, 0x3ffff
    s_mov_b32 s55, 0x3ffff
    s_or_b64 vcc, vcc, s[12:13]
    v_mov_b32 v11, 0x3f803f80
    v_cndmask_b32 v11, 0, v11, vcc
    s_add_u32 s24, s92, 2523136
    s_addc_u32 s25, s93, 0
    s_mov_b32 s26, 7077888
    s_mov_b32 s27, 0x20000
    s_mov_b32 s64, s78
    s_mov_b32 s65, s79
    s_mov_b32 s66, 8388608
    s_mov_b32 s67, 0x20000
    v_lshlrev_b32 v171, 4, v1
    s_lshl_b32 s36, s2, 2
    s_add_u32 s36, s36, s20
    s_lshl_b32 s36, s36, 13
    s_mov_b32 s37, 148480
    s_movk_i32 s38, 1024
    s_mov_b32 s39, 0
    s_barrier
    s_mov_b32 m0, s45
    s_add_u32 s45, s45, 4096
    buffer_load_dwordx4 v5, s[24:27], s42 offen sc1 lds
    s_mov_b32 m0, s46
    s_add_u32 s46, s46, 4608
    buffer_load_dwordx4 v174, s[24:27], s43 offen sc1 lds
    s_add_u32 s42, s42, 4096
    s_add_u32 s43, s43, 4608
    s_cmp_eq_u32 s61, 0
    s_cbranch_scc0 L_m_x20
    s_mov_b32 m0, s47
    s_add_u32 s47, s47, s60
    buffer_load_dwordx4 v6, s[24:27], s44 offen sc1 lds
    s_add_u32 s44, s44, s48
L_m_x20:
    buffer_load_dwordx4 v[12:15], v5, s[24:27], s40 offen sc1
    buffer_load_dwordx4 v[20:23], v5, s[24:27], s53 offen sc1
    buffer_load_dword v16, v7, s[24:27], s41 offen sc1
    buffer_load_dword v24, v7, s[24:27], s56 offen sc1
    v_mov_b32 v17, 0
    v_mov_b32 v18, 0
    v_mov_b32 v19, 0
    v_mov_b32 v25, 0
    v_mov_b32 v26, 0
    v_mov_b32 v27, 0
    v_mov_b32 v33, 0
    v_mov_b32 v34, 0
    v_mov_b32 v35, 0
    v_mov_b32 v56, 0
    v_mov_b32 v57, 0
    v_mov_b32 v120, 0
    v_mov_b32 v121, 0
    v_mov_b32 v122, 0
    v_mov_b32 v123, 0
    v_mov_b32 v36, v11
    v_mov_b32 v37, v11
    v_mov_b32 v38, v11
    v_mov_b32 v39, v11
    v_mov_b32 v40, v11
    v_mov_b32 v41, v11
    v_mov_b32 v42, v11
    v_mov_b32 v43, v11
    v_mov_b32 v156, v11
    v_mov_b32 v157, v11
    v_mov_b32 v158, v11
    v_mov_b32 v159, v11
    v_mov_b32 v124, 0
    v_mov_b32 v125, 0
    v_mov_b32 v126, 0
    v_mov_b32 v127, 0
    v_mov_b32 v128, 0
    v_mov_b32 v129, 0
    v_mov_b32 v130, 0
    v_mov_b32 v131, 0
    v_mov_b32 v132, 0
    v_mov_b32 v133, 0
    v_mov_b32 v134, 0
    v_mov_b32 v135, 0
    v_mov_b32 v136, 0
    v_mov_b32 v137, 0
    v_mov_b32 v138, 0
    v_mov_b32 v139, 0
    v_mov_b32 v140, 0
    v_mov_b32 v141, 0
    v_mov_b32 v142, 0
    v_mov_b32 v143, 0
    v_mov_b32 v144, 0
    v_mov_b32 v145, 0
    v_mov_b32 v146, 0
    v_mov_b32 v147, 0
    v_mov_b32 v148, 0
    v_mov_b32 v149, 0
    v_mov_b32 v150, 0
    v_mov_b32 v151, 0
    v_mov_b32 v152, 0
    v_mov_b32 v153, 0
    v_mov_b32 v154, 0
    v_mov_b32 v155, 0
    s_add_u32 s28, s92, 9601024
    s_addc_u32 s29, s93, 0
    s_mov_b32 s30, 2359296
    s_mov_b32 s31, 0x20000
    s_lshl_b32 s10, s17, 1
    s_mul_i32 s50, s10, 18432
    s_lshr_b32 s11, s21, 2
    s_lshl_b32 s11, s11, 8
    s_and_b32 s12, s21, 3
    s_lshl_b32 s12, s12, 2
    s_add_u32 s51, s50, s11
    s_add_u32 s51, s51, s12
    s_add_u32 s51, s51, 16384
    s_lshl_b32 s11, s21, 9
    s_add_u32 s50, s50, s11
    s_waitcnt vmcnt(0)
    s_barrier
    s_mov_b32 m0, s45
    s_add_u32 s45, s45, 4096
    buffer_load_dwordx4 v5, s[24:27], s42 offen sc1 lds
    s_mov_b32 m0, s46
    s_add_u32 s46, s46, 4608
    buffer_load_dwordx4 v174, s[24:27], s43 offen sc1 lds
    s_add_u32 s42, s42, 4096
    s_add_u32 s43, s43, 4608
    s_cmp_eq_u32 s61, 0
    s_cbranch_scc0 L_m_x21
    s_mov_b32 m0, s47
    s_add_u32 s47, s47, s60
    buffer_load_dwordx4 v6, s[24:27], s44 offen sc1 lds
    s_add_u32 s44, s44, s48
L_m_x21:
    ds_read_b128 v[28:31], v2
    ds_read_b32 v32, v3
    s_mov_b32 exec_lo, 0
    v_mov_b32 v16, 0
    v_mov_b32 v24, 0
    s_mov_b32 exec_lo, -1
    s_waitcnt lgkmcnt(0)
    v_mfma_f32_32x32x16_bf16 v[60:75], v[28:31], v[12:15], 0
    v_mfma_f32_32x32x16_bf16 v[92:107], v[28:31], v[20:23], 0
    v_mfma_f32_32x32x16_bf16 v[60:75], v[32:35], v[16:19], v[60:75]
    v_mfma_f32_32x32x16_bf16 v[92:107], v[32:35], v[24:27], v[92:107]
    ds_read_b128 v[28:31], v2 offset:1024
    ds_read_b32 v32, v3 offset:128
    s_mov_b64 exec, s[54:55]
    ds_read_b128 v[36:39], v4 offset:0
    ds_read_b128 v[40:43], v4 offset:576
    s_mov_b64 exec, -1
    s_nop 7
    s_cmp_eq_u32 s16, 0
    s_cbranch_scc1 L_m_lp23
    s_setprio 1
L_m_lp23:
    s_mov_b32 m0, s45
    s_add_u32 s45, s45, 4096
    buffer_load_dwordx4 v5, s[24:27], s42 offen sc1 lds
    s_mov_b32 m0, s46
    s_add_u32 s46, s46, 4608
    buffer_load_dwordx4 v174, s[24:27], s43 offen sc1 lds
    s_add_u32 s42, s42, 4096
    s_add_u32 s43, s43, 4608
    s_cmp_eq_u32 s61, 0
    s_cbranch_scc0 L_m_x24
    s_mov_b32 m0, s47
    s_add_u32 s47, s47, s60
    buffer_load_dwordx4 v6, s[24:27], s44 offen sc1 lds
    s_add_u32 s44, s44, s48
L_m_x24:
    s_waitcnt lgkmcnt(3)
    v_mfma_f32_32x32x16_bf16 v[76:91], v[28:31], v[12:15], 0
    v_cvt_pk_bf16_f32 v58, v120, v121
    v_cvt_pk_bf16_f32 v59, v122, v123
    v_exp_f32 v60, v60
    v_exp_f32 v61, v61
    v_exp_f32 v62, v62
    v_exp_f32 v63, v63
    v_mfma_f32_32x32x16_bf16 v[140:155], v[156:159], v[56:59], v[140:155]
    v_exp_f32 v64, v64
    v_exp_f32 v65, v65
    v_exp_f32 v66, v66
    v_exp_f32 v67, v67
    v_cvt_pk_bf16_f32 v44, v60, v61
    v_cvt_pk_bf16_f32 v45, v62, v63
    s_waitcnt lgkmcnt(0)
    v_mfma_f32_32x32x16_bf16 v[76:91], v[32:35], v[16:19], v[76:91]
    v_cvt_pk_bf16_f32 v46, v64, v65
    v_cvt_pk_bf16_f32 v47, v66, v67
    v_exp_f32 v68, v68
    v_exp_f32 v69, v69
    v_exp_f32 v70, v70
    v_exp_f32 v71, v71
    v_mfma_f32_32x32x16_bf16 v[124:139], v[36:39], v[44:47], v[124:139]
    v_exp_f32 v72, v72
    v_exp_f32 v73, v73
    v_cvt_pk_bf16_f32 v48, v68, v69
    v_cvt_pk_bf16_f32 v49, v70, v71
    v_exp_f32 v74, v74
    v_exp_f32 v75, v75
    v_mfma_f32_32x32x16_bf16 v[108:123], v[28:31], v[20:23], 0
    ds_read_b128 v[28:31], v2 offset:2048
    v_cvt_pk_bf16_f32 v50, v72, v73
    v_cvt_pk_bf16_f32 v51, v74, v75
    v_exp_f32 v92, v92
    v_exp_f32 v93, v93
    v_exp_f32 v94, v94
    v_exp_f32 v95, v95
    v_mfma_f32_32x32x16_bf16 v[124:139], v[40:43], v[48:51], v[124:139]
    v_exp_f32 v96, v96
    v_exp_f32 v97, v97
    v_exp_f32 v98, v98
    v_exp_f32 v99, v99
    v_cvt_pk_bf16_f32 v52, v92, v93
    v_cvt_pk_bf16_f32 v53, v94, v95
    v_mfma_f32_32x32x16_bf16 v[108:123], v[32:35], v[24:27], v[108:123]
    ds_read_b32 v32, v3 offset:256
    v_cvt_pk_bf16_f32 v54, v96, v97
    v_cvt_pk_bf16_f32 v55, v98, v99
    v_exp_f32 v100, v100
    v_exp_f32 v101, v101
    v_exp_f32 v102, v102
    v_exp_f32 v103, v103
    v_mfma_f32_32x32x16_bf16 v[140:155], v[36:39], v[52:55], v[140:155]
    s_mov_b64 exec, s[54:55]
    ds_read_b128 v[36:39], v4 offset:1152
    ds_read_b128 v[156:159], v4 offset:1728
    s_mov_b64 exec, -1
    v_exp_f32 v104, v104
    v_exp_f32 v105, v105
    v_cvt_pk_bf16_f32 v56, v100, v101
    v_cvt_pk_bf16_f32 v57, v102, v103
    v_exp_f32 v106, v106
    v_exp_f32 v107, v107
    s_waitcnt lgkmcnt(3)
    v_mfma_f32_32x32x16_bf16 v[60:75], v[28:31], v[12:15], 0
    s_mov_b32 m0, s45
    s_add_u32 s45, s45, 4096
    buffer_load_dwordx4 v5, s[24:27], s42 offen sc1 lds
    s_mov_b32 m0, s46
    s_add_u32 s46, s46, 4608
    buffer_load_dwordx4 v174, s[24:27], s43 offen sc1 lds
    s_add_u32 s42, s42, 4096
    s_add_u32 s43, s43, 4608
    s_cmp_eq_u32 s61, 0
    s_cbranch_scc0 L_m_x25
    s_mov_b32 m0, s47
    s_add_u32 s47, s47, s60
    buffer_load_dwordx4 v6, s[24:27], s44 offen sc1 lds
    s_add_u32 s44, s44, s48
L_m_x25:
    v_cvt_pk_bf16_f32 v58, v104, v105
    v_cvt_pk_bf16_f32 v59, v106, v107
    v_exp_f32 v76, v76
    v_exp_f32 v77, v77
    v_exp_f32 v78, v78
    v_exp_f32 v79, v79
    v_mfma_f32_32x32x16_bf16 v[140:155], v[40:43], v[56:59], v[140:155]
    v_exp_f32 v80, v80
    v_exp_f32 v81, v81
    v_exp_f32 v82, v82
    v_exp_f32 v83, v83
    v_cvt_pk_bf16_f32 v44, v76, v77
    v_cvt_pk_bf16_f32 v45, v78, v79
    s_waitcnt lgkmcnt(0)
    v_mfma_f32_32x32x16_bf16 v[60:75], v[32:35], v[16:19], v[60:75]
    v_cvt_pk_bf16_f32 v46, v80, v81
    v_cvt_pk_bf16_f32 v47, v82, v83
    v_exp_f32 v84, v84
    v_exp_f32 v85, v85
    v_exp_f32 v86, v86
    v_exp_f32 v87, v87
    v_mfma_f32_32x32x16_bf16 v[124:139], v[36:39], v[44:47], v[124:139]
    v_exp_f32 v88, v88
    v_exp_f32 v89, v89
    v_cvt_pk_bf16_f32 v48, v84, v85
    v_cvt_pk_bf16_f32 v49, v86, v87
    v_exp_f32 v90, v90
    v_exp_f32 v91, v91
    v_mfma_f32_32x32x16_bf16 v[92:107], v[28:31], v[20:23], 0
    ds_read_b128 v[28:31], v2 offset:3072
    v_cvt_pk_bf16_f32 v50, v88, v89
    v_cvt_pk_bf16_f32 v51, v90, v91
    v_exp_f32 v108, v108
    v_exp_f32 v109, v109
    v_exp_f32 v110, v110
    v_exp_f32 v111, v111
    v_mfma_f32_32x32x16_bf16 v[124:139], v[156:159], v[48:51], v[124:139]
    v_exp_f32 v112, v112
    v_exp_f32 v113, v113
    v_exp_f32 v114, v114
    v_exp_f32 v115, v115
    v_cvt_pk_bf16_f32 v52, v108, v109
    v_cvt_pk_bf16_f32 v53, v110, v111
    v_mfma_f32_32x32x16_bf16 v[92:107], v[32:35], v[24:27], v[92:107]
    ds_read_b32 v32, v3 offset:384
    v_cvt_pk_bf16_f32 v54, v112, v113
    v_cvt_pk_bf16_f32 v55, v114, v115
    v_exp_f32 v116, v116
    v_exp_f32 v117, v117
    v_exp_f32 v118, v118
    v_exp_f32 v119, v119
    v_mfma_f32_32x32x16_bf16 v[140:155], v[36:39], v[52:55], v[140:155]
    s_mov_b64 exec, s[54:55]
    ds_read_b128 v[36:39], v4 offset:2304
    ds_read_b128 v[40:43], v4 offset:2880
    s_mov_b64 exec, -1
    v_exp_f32 v120, v120
    v_exp_f32 v121, v121
    v_cvt_pk_bf16_f32 v56, v116, v117
    v_cvt_pk_bf16_f32 v57, v118, v119
    v_exp_f32 v122, v122
    v_exp_f32 v123, v123
    s_waitcnt vmcnt(2)
    s_barrier
    s_waitcnt lgkmcnt(3)
    v_mfma_f32_32x32x16_bf16 v[76:91], v[28:31], v[12:15], 0
    s_mov_b32 m0, s45
    s_add_u32 s45, s45, 4096
    buffer_load_dwordx4 v5, s[24:27], s42 offen sc1 lds
    s_mov_b32 m0, s46
    s_add_u32 s46, s46, 4608
    buffer_load_dwordx4 v174, s[24:27], s43 offen sc1 lds
    s_add_u32 s42, s42, 4096
    s_add_u32 s43, s43, 4608
    s_cmp_eq_u32 s61, 0
    s_cbranch_scc0 L_m_x26
    s_mov_b32 m0, s47
    s_add_u32 s47, s47, s60
    buffer_load_dwordx4 v6, s[24:27], s44 offen sc1 lds
    s_add_u32 s44, s44, s48
L_m_x26:
    v_cvt_pk_bf16_f32 v58, v120, v121
    v_cvt_pk_bf16_f32 v59, v122, v123
    v_exp_f32 v60, v60
    v_exp_f32 v61, v61
    v_exp_f32 v62, v62
    v_exp_f32 v63, v63
    v_mfma_f32_32x32x16_bf16 v[140:155], v[156:159], v[56:59], v[140:155]
    v_exp_f32 v64, v64
    v_exp_f32 v65, v65
    v_exp_f32 v66, v66
    v_exp_f32 v67, v67
    v_cvt_pk_bf16_f32 v44, v60, v61
    v_cvt_pk_bf16_f32 v45, v62, v63
    s_waitcnt lgkmcnt(0)
    v_mfma_f32_32x32x16_bf16 v[76:91], v[32:35], v[16:19], v[76:91]
    v_cvt_pk_bf16_f32 v46, v64, v65
    v_cvt_pk_bf16_f32 v47, v66, v67
    v_exp_f32 v68, v68
    v_exp_f32 v69, v69
    v_exp_f32 v70, v70
    v_exp_f32 v71, v71
    v_mfma_f32_32x32x16_bf16 v[124:139], v[36:39], v[44:47], v[124:139]
    v_exp_f32 v72, v72
    v_exp_f32 v73, v73
    v_cvt_pk_bf16_f32 v48, v68, v69
    v_cvt_pk_bf16_f32 v49, v70, v71
    v_exp_f32 v74, v74
    v_exp_f32 v75, v75
    v_mfma_f32_32x32x16_bf16 v[108:123], v[28:31], v[20:23], 0
    ds_read_b128 v[28:31], v2 offset:4096
    v_cvt_pk_bf16_f32 v50, v72, v73
    v_cvt_pk_bf16_f32 v51, v74, v75
    v_exp_f32 v92, v92
    v_exp_f32 v93, v93
    v_exp_f32 v94, v94
    v_exp_f32 v95, v95
    v_mfma_f32_32x32x16_bf16 v[124:139], v[40:43], v[48:51], v[124:139]
    v_exp_f32 v96, v96
    v_exp_f32 v97, v97
    v_exp_f32 v98, v98
    v_exp_f32 v99, v99
    v_cvt_pk_bf16_f32 v52, v92, v93
    v_cvt_pk_bf16_f32 v53, v94, v95
    v_mfma_f32_32x32x16_bf16 v[108:123], v[32:35], v[24:27], v[108:123]
    ds_read_b32 v32, v3 offset:1024
    v_cvt_pk_bf16_f32 v54, v96, v97
    v_cvt_pk_bf16_f32 v55, v98, v99
    v_exp_f32 v100, v100
    v_exp_f32 v101, v101
    v_exp_f32 v102, v102
    v_exp_f32 v103, v103
    v_mfma_f32_32x32x16_bf16 v[140:155], v[36:39], v[52:55], v[140:155]
    s_mov_b64 exec, s[54:55]
    ds_read_b128 v[36:39], v4 offset:3456
    ds_read_b128 v[156:159], v4 offset:4032
    s_mov_b64 exec, -1
    v_exp_f32 v104, v104
    v_exp_f32 v105, v105
    v_cvt_pk_bf16_f32 v56, v100, v101
    v_cvt_pk_bf16_f32 v57, v102, v103
    v_exp_f32 v106, v106
    v_exp_f32 v107, v107
    s_waitcnt lgkmcnt(3)
    v_mfma_f32_32x32x16_bf16 v[60:75], v[28:31], v[12:15], 0
    s_mov_b32 m0, s45
    s_add_u32 s45, s45, 4096
    buffer_load_dwordx4 v5, s[24:27], s42 offen sc1 lds
    s_mov_b32 m0, s46
    s_add_u32 s46, s46, 4608
    buffer_load_dwordx4 v174, s[24:27], s43 offen sc1 lds
    s_add_u32 s42, s42, 4096
    s_add_u32 s43, s43, 4608
    s_cmp_eq_u32 s61, 0
    s_cbranch_scc0 L_m_x27
    s_mov_b32 m0, s47
    s_add_u32 s47, s47, s60
    buffer_load_dwordx4 v6, s[24:27], s44 offen sc1 lds
    s_add_u32 s44, s44, s48
L_m_x27:
    v_cvt_pk_bf16_f32 v58, v104, v105
    v_cvt_pk_bf16_f32 v59, v106, v107
    v_exp_f32 v76, v76
    v_exp_f32 v77, v77
    v_exp_f32 v78, v78
    v_exp_f32 v79, v79
    v_mfma_f32_32x32x16_bf16 v[140:155], v[40:43], v[56:59], v[140:155]
    v_exp_f32 v80, v80
    v_exp_f32 v81, v81
    v_exp_f32 v82, v82
    v_exp_f32 v83, v83
    v_cvt_pk_bf16_f32 v44, v76, v77
    v_cvt_pk_bf16_f32 v45, v78, v79
    s_waitcnt lgkmcnt(0)
    v_mfma_f32_32x32x16_bf16 v[60:75], v[32:35], v[16:19], v[60:75]
    v_cvt_pk_bf16_f32 v46, v80, v81
    v_cvt_pk_bf16_f32 v47, v82, v83
    v_exp_f32 v84, v84
    v_exp_f32 v85, v85
    v_exp_f32 v86, v86
    v_exp_f32 v87, v87
    v_mfma_f32_32x32x16_bf16 v[124:139], v[36:39], v[44:47], v[124:139]
    v_exp_f32 v88, v88
    v_exp_f32 v89, v89
    v_cvt_pk_bf16_f32 v48, v84, v85
    v_cvt_pk_bf16_f32 v49, v86, v87
    v_exp_f32 v90, v90
    v_exp_f32 v91, v91
    s_setprio 0
    v_mfma_f32_32x32x16_bf16 v[92:107], v[28:31], v[20:23], 0
    ds_read_b128 v[28:31], v2 offset:5120
    v_cvt_pk_bf16_f32 v50, v88, v89
    v_cvt_pk_bf16_f32 v51, v90, v91
    v_exp_f32 v108, v108
    v_exp_f32 v109, v109
    v_exp_f32 v110, v110
    v_exp_f32 v111, v111
    v_mfma_f32_32x32x16_bf16 v[124:139], v[156:159], v[48:51], v[124:139]
    v_exp_f32 v112, v112
    v_exp_f32 v113, v113
    v_exp_f32 v114, v114
    v_exp_f32 v115, v115
    v_cvt_pk_bf16_f32 v52, v108, v109
    v_cvt_pk_bf16_f32 v53, v110, v111
    v_mfma_f32_32x32x16_bf16 v[92:107], v[32:35], v[24:27], v[92:107]
    ds_read_b32 v32, v3 offset:1152
    v_cvt_pk_bf16_f32 v54, v112, v113
    v_cvt_pk_bf16_f32 v55, v114, v115
    v_exp_f32 v116, v116
    v_exp_f32 v117, v117
    v_exp_f32 v118, v118
    v_exp_f32 v119, v119
    v_mfma_f32_32x32x16_bf16 v[140:155], v[36:39], v[52:55], v[140:155]
    s_mov_b64 exec, s[54:55]
    ds_read_b128 v[36:39], v4 offset:4608
    ds_read_b128 v[40:43], v4 offset:5184
    s_mov_b64 exec, -1
    v_exp_f32 v120, v120
    v_exp_f32 v121, v121
    v_cvt_pk_bf16_f32 v56, v116, v117
    v_cvt_pk_bf16_f32 v57, v118, v119
    v_exp_f32 v122, v122
    v_exp_f32 v123, v123
    v_add_u32 v2, 4096, v2
    v_add_u32 v3, 1024, v3
    v_add_u32 v4, 4608, v4
    s_cmp_eq_u32 s16, 0
    s_cbranch_scc1 L_m_lp29
    s_setprio 1
L_m_lp29:
    s_waitcnt lgkmcnt(3)
    v_mfma_f32_32x32x16_bf16 v[76:91], v[28:31], v[12:15], 0
    s_mov_b32 m0, s45
    s_add_u32 s45, s45, 4096
    buffer_load_dwordx4 v5, s[24:27], s42 offen sc1 lds
    s_mov_b32 m0, s46
    s_add_u32 s46, s46, 4608
    buffer_load_dwordx4 v174, s[24:27], s43 offen sc1 lds
    s_add_u32 s42, s42, 4096
    s_add_u32 s43, s43, 4608
    s_cmp_eq_u32 s61, 0
    s_cbranch_scc0 L_m_x30
    s_mov_b32 m0, s47
    s_add_u32 s47, s47, s60
    buffer_load_dwordx4 v6, s[24:27], s44 offen sc1 lds
    s_add_u32 s44, s44, s48
L_m_x30:
    v_cvt_pk_bf16_f32 v58, v120, v121
    v_cvt_pk_bf16_f32 v59, v122, v123
    v_exp_f32 v60, v60
    v_exp_f32 v61, v61
    v_exp_f32 v62, v62
    v_exp_f32 v63, v63
    v_mfma_f32_32x32x16_bf16 v[140:155], v[156:159], v[56:59], v[140:155]
    v_exp_f32 v64, v64
    v_exp_f32 v65, v65
    v_exp_f32 v66, v66
    v_exp_f32 v67, v67
    v_cvt_pk_bf16_f32 v44, v60, v61
    v_cvt_pk_bf16_f32 v45, v62, v63
    s_waitcnt lgkmcnt(0)
    v_mfma_f32_32x32x16_bf16 v[76:91], v[32:35], v[16:19], v[76:91]
    v_cvt_pk_bf16_f32 v46, v64, v65
    v_cvt_pk_bf16_f32 v47, v66, v67
    v_exp_f32 v68, v68
    v_exp_f32 v69, v69
    v_exp_f32 v70, v70
    v_exp_f32 v71, v71
    v_mfma_f32_32x32x16_bf16 v[124:139], v[36:39], v[44:47], v[124:139]
    v_exp_f32 v72, v72
    v_exp_f32 v73, v73
    v_cvt_pk_bf16_f32 v48, v68, v69
    v_cvt_pk_bf16_f32 v49, v70, v71
    v_exp_f32 v74, v74
    v_exp_f32 v75, v75
    v_mfma_f32_32x32x16_bf16 v[108:123], v[28:31], v[20:23], 0
    ds_read_b128 v[28:31], v2 offset:2048
    v_cvt_pk_bf16_f32 v50, v72, v73
    v_cvt_pk_bf16_f32 v51, v74, v75
    v_exp_f32 v92, v92
    v_exp_f32 v93, v93
    v_exp_f32 v94, v94
    v_exp_f32 v95, v95
    v_mfma_f32_32x32x16_bf16 v[124:139], v[40:43], v[48:51], v[124:139]
    v_exp_f32 v96, v96
    v_exp_f32 v97, v97
    v_exp_f32 v98, v98
    v_exp_f32 v99, v99
    v_cvt_pk_bf16_f32 v52, v92, v93
    v_cvt_pk_bf16_f32 v53, v94, v95
    v_mfma_f32_32x32x16_bf16 v[108:123], v[32:35], v[24:27], v[108:123]
    ds_read_b32 v32, v3 offset:256
    v_cvt_pk_bf16_f32 v54, v96, v97
    v_cvt_pk_bf16_f32 v55, v98, v99
    v_exp_f32 v100, v100
    v_exp_f32 v101, v101
    v_exp_f32 v102, v102
    v_exp_f32 v103, v103
    v_mfma_f32_32x32x16_bf16 v[140:155], v[36:39], v[52:55], v[140:155]
    s_mov_b64 exec, s[54:55]
    ds_read_b128 v[36:39], v4 offset:1152
    ds_read_b128 v[156:159], v4 offset:1728
    s_mov_b64 exec, -1
    v_exp_f32 v104, v104
    v_exp_f32 v105, v105
    v_cvt_pk_bf16_f32 v56, v100, v101
    v_cvt_pk_bf16_f32 v57, v102, v103
    v_exp_f32 v106, v106
    v_exp_f32 v107, v107
    s_waitcnt lgkmcnt(3)
    v_mfma_f32_32x32x16_bf16 v[60:75], v[28:31], v[12:15], 0
    s_mov_b32 m0, s45
    s_add_u32 s45, s45, 4096
    buffer_load_dwordx4 v5, s[24:27], s42 offen sc1 lds
    s_mov_b32 m0, s46
    s_add_u32 s46, s46, 4608
    buffer_load_dwordx4 v174, s[24:27], s43 offen sc1 lds
    s_add_u32 s42, s42, 4096
    s_add_u32 s43, s43, 4608
    s_cmp_eq_u32 s61, 0
    s_cbranch_scc0 L_m_x31
    s_mov_b32 m0, s47
    s_add_u32 s47, s47, s60
    buffer_load_dwordx4 v6, s[24:27], s44 offen sc1 lds
    s_add_u32 s44, s44, s48
L_m_x31:
    v_cvt_pk_bf16_f32 v58, v104, v105
    v_cvt_pk_bf16_f32 v59, v106, v107
    v_exp_f32 v76, v76
    v_exp_f32 v77, v77
    v_exp_f32 v78, v78
    v_exp_f32 v79, v79
    v_mfma_f32_32x32x16_bf16 v[140:155], v[40:43], v[56:59], v[140:155]
    v_exp_f32 v80, v80
    v_exp_f32 v81, v81
    v_exp_f32 v82, v82
    v_exp_f32 v83, v83
    v_cvt_pk_bf16_f32 v44, v76, v77
    v_cvt_pk_bf16_f32 v45, v78, v79
    s_waitcnt lgkmcnt(0)
    v_mfma_f32_32x32x16_bf16 v[60:75], v[32:35], v[16:19], v[60:75]
    v_cvt_pk_bf16_f32 v46, v80, v81
    v_cvt_pk_bf16_f32 v47, v82, v83
    v_exp_f32 v84, v84
    v_exp_f32 v85, v85
    v_exp_f32 v86, v86
    v_exp_f32 v87, v87
    v_mfma_f32_32x32x16_bf16 v[124:139], v[36:39], v[44:47], v[124:139]
    v_exp_f32 v88, v88
    v_exp_f32 v89, v89
    v_cvt_pk_bf16_f32 v48, v84, v85
    v_cvt_pk_bf16_f32 v49, v86, v87
    v_exp_f32 v90, v90
    v_exp_f32 v91, v91
    v_mfma_f32_32x32x16_bf16 v[92:107], v[28:31], v[20:23], 0
    ds_read_b128 v[28:31], v2 offset:3072
    v_cvt_pk_bf16_f32 v50, v88, v89
    v_cvt_pk_bf16_f32 v51, v90, v91
    v_exp_f32 v108, v108
    v_exp_f32 v109, v109
    v_exp_f32 v110, v110
    v_exp_f32 v111, v111
    v_mfma_f32_32x32x16_bf16 v[124:139], v[156:159], v[48:51], v[124:139]
    v_exp_f32 v112, v112
    v_exp_f32 v113, v113
    v_exp_f32 v114, v114
    v_exp_f32 v115, v115
    v_cvt_pk_bf16_f32 v52, v108, v109
    v_cvt_pk_bf16_f32 v53, v110, v111
    v_mfma_f32_32x32x16_bf16 v[92:107], v[32:35], v[24:27], v[92:107]
    ds_read_b32 v32, v3 offset:384
    v_cvt_pk_bf16_f32 v54, v112, v113
    v_cvt_pk_bf16_f32 v55, v114, v115
    v_exp_f32 v116, v116
    v_exp_f32 v117, v117
    v_exp_f32 v118, v118
    v_exp_f32 v119, v119
    v_mfma_f32_32x32x16_bf16 v[140:155], v[36:39], v[52:55], v[140:155]
    s_mov_b64 exec, s[54:55]
    ds_read_b128 v[36:39], v4 offset:2304
    ds_read_b128 v[40:43], v4 offset:2880
    s_mov_b64 exec, -1
    v_exp_f32 v120, v120
    v_exp_f32 v121, v121
    v_cvt_pk_bf16_f32 v56, v116, v117
    v_cvt_pk_bf16_f32 v57, v118, v119
    v_exp_f32 v122, v122
    v_exp_f32 v123, v123
    s_waitcnt lgkmcnt(3)
    v_mfma_f32_32x32x16_bf16 v[76:91], v[28:31], v[12:15], 0
    v_cvt_pk_bf16_f32 v58, v120, v121
    v_cvt_pk_bf16_f32 v59, v122, v123
    v_exp_f32 v60, v60
    v_exp_f32 v61, v61
    v_exp_f32 v62, v62
    v_exp_f32 v63, v63
    v_mfma_f32_32x32x16_bf16 v[140:155], v[156:159], v[56:59], v[140:155]
    v_exp_f32 v64, v64
    v_exp_f32 v65, v65
    v_exp_f32 v66, v66
    v_exp_f32 v67, v67
    v_cvt_pk_bf16_f32 v44, v60, v61
    v_cvt_pk_bf16_f32 v45, v62, v63
    s_waitcnt lgkmcnt(0)
    v_mfma_f32_32x32x16_bf16 v[76:91], v[32:35], v[16:19], v[76:91]
    v_cvt_pk_bf16_f32 v46, v64, v65
    v_cvt_pk_bf16_f32 v47, v66, v67
    v_exp_f32 v68, v68
    v_exp_f32 v69, v69
    v_exp_f32 v70, v70
    v_exp_f32 v71, v71
    v_mfma_f32_32x32x16_bf16 v[124:139], v[36:39], v[44:47], v[124:139]
    v_exp_f32 v72, v72
    v_exp_f32 v73, v73
    v_cvt_pk_bf16_f32 v48, v68, v69
    v_cvt_pk_bf16_f32 v49, v70, v71
    v_exp_f32 v74, v74
    v_exp_f32 v75, v75
    v_mfma_f32_32x32x16_bf16 v[108:123], v[28:31], v[20:23], 0
    ds_read_b128 v[28:31], v2 offset:4096
    v_cvt_pk_bf16_f32 v50, v72, v73
    v_cvt_pk_bf16_f32 v51, v74, v75
    v_exp_f32 v92, v92
    v_exp_f32 v93, v93
    v_exp_f32 v94, v94
    v_exp_f32 v95, v95
    v_mfma_f32_32x32x16_bf16 v[124:139], v[40:43], v[48:51], v[124:139]
    v_exp_f32 v96, v96
    v_exp_f32 v97, v97
    v_exp_f32 v98, v98
    v_exp_f32 v99, v99
    v_cvt_pk_bf16_f32 v52, v92, v93
    v_cvt_pk_bf16_f32 v53, v94, v95
    v_mfma_f32_32x32x16_bf16 v[108:123], v[32:35], v[24:27], v[108:123]
    ds_read_b32 v32, v3 offset:1024
    v_cvt_pk_bf16_f32 v54, v96, v97
    v_cvt_pk_bf16_f32 v55, v98, v99
    v_exp_f32 v100, v100
    v_exp_f32 v101, v101
    v_exp_f32 v102, v102
    v_exp_f32 v103, v103
    v_mfma_f32_32x32x16_bf16 v[140:155], v[36:39], v[52:55], v[140:155]
    s_mov_b64 exec, s[54:55]
    ds_read_b128 v[36:39], v4 offset:3456
    ds_read_b128 v[156:159], v4 offset:4032
    s_mov_b64 exec, -1
    v_exp_f32 v104, v104
    v_exp_f32 v105, v105
    v_cvt_pk_bf16_f32 v56, v100, v101
    v_cvt_pk_bf16_f32 v57, v102, v103
    v_exp_f32 v106, v106
    v_exp_f32 v107, v107
    s_waitcnt lgkmcnt(3)
    v_mfma_f32_32x32x16_bf16 v[60:75], v[28:31], v[12:15], 0
    v_cvt_pk_bf16_f32 v58, v104, v105
    v_cvt_pk_bf16_f32 v59, v106, v107
    v_exp_f32 v76, v76
    v_exp_f32 v77, v77
    v_exp_f32 v78, v78
    v_exp_f32 v79, v79
    v_mfma_f32_32x32x16_bf16 v[140:155], v[40:43], v[56:59], v[140:155]
    v_exp_f32 v80, v80
    v_exp_f32 v81, v81
    v_exp_f32 v82, v82
    v_exp_f32 v83, v83
    v_cvt_pk_bf16_f32 v44, v76, v77
    v_cvt_pk_bf16_f32 v45, v78, v79
    s_waitcnt lgkmcnt(0)
    v_mfma_f32_32x32x16_bf16 v[60:75], v[32:35], v[16:19], v[60:75]
    v_cvt_pk_bf16_f32 v46, v80, v81
    v_cvt_pk_bf16_f32 v47, v82, v83
    v_exp_f32 v84, v84
    v_exp_f32 v85, v85
    v_exp_f32 v86, v86
    v_exp_f32 v87, v87
    v_mfma_f32_32x32x16_bf16 v[124:139], v[36:39], v[44:47], v[124:139]
    v_exp_f32 v88, v88
    v_exp_f32 v89, v89
    v_cvt_pk_bf16_f32 v48, v84, v85
    v_cvt_pk_bf16_f32 v49, v86, v87
    v_exp_f32 v90, v90
    v_exp_f32 v91, v91
    s_setprio 0
    v_mfma_f32_32x32x16_bf16 v[92:107], v[28:31], v[20:23], 0
    ds_read_b128 v[28:31], v2 offset:5120
    v_cvt_pk_bf16_f32 v50, v88, v89
    v_cvt_pk_bf16_f32 v51, v90, v91
    v_exp_f32 v108, v108
    v_exp_f32 v109, v109
    v_exp_f32 v110, v110
    v_exp_f32 v111, v111
    v_mfma_f32_32x32x16_bf16 v[124:139], v[156:159], v[48:51], v[124:139]
    v_exp_f32 v112, v112
    v_exp_f32 v113, v113
    v_exp_f32 v114, v114
    v_exp_f32 v115, v115
    v_cvt_pk_bf16_f32 v52, v108, v109
    v_cvt_pk_bf16_f32 v53, v110, v111
    v_mfma_f32_32x32x16_bf16 v[92:107], v[32:35], v[24:27], v[92:107]
    ds_read_b32 v32, v3 offset:1152
    v_cvt_pk_bf16_f32 v54, v112, v113
    v_cvt_pk_bf16_f32 v55, v114, v115
    v_exp_f32 v116, v116
    v_exp_f32 v117, v117
    v_exp_f32 v118, v118
    v_exp_f32 v119, v119
    v_mfma_f32_32x32x16_bf16 v[140:155], v[36:39], v[52:55], v[140:155]
    s_mov_b64 exec, s[54:55]
    ds_read_b128 v[36:39], v4 offset:4608
    ds_read_b128 v[40:43], v4 offset:5184
    s_mov_b64 exec, -1
    v_exp_f32 v120, v120
    v_exp_f32 v121, v121
    v_cvt_pk_bf16_f32 v56, v116, v117
    v_cvt_pk_bf16_f32 v57, v118, v119
    v_exp_f32 v122, v122
    v_exp_f32 v123, v123
    v_add_u32 v2, 4096, v2
    v_add_u32 v3, 1024, v3
    v_add_u32 v4, 4608, v4
    s_cmp_eq_u32 s16, 0
    s_cbranch_scc1 L_m_lp33
    s_setprio 1
L_m_lp33:
    s_cmp_lt_u32 s19, 2
    s_cbranch_scc0 L_p2_hb
    s_mul_i32 s10, s19, 64
    v_add_u32 v172, s10, v1
    v_min_u32 v172, 98, v172
    v_cmp_lt_u32 vcc, 26, v172
    v_add_u32 v172, 153, v172
    v_add_u32 v173, 260, v172
    v_cndmask_b32 v172, v172, v173, vcc
    v_lshlrev_b32 v172, 7, v172
    v_add_u32 v172, 0, v172
    s_mov_b32 s11, 131072
L_m_pl34:
    buffer_load_dword v248, v172, s[96:99], 0 offen sc1
    s_waitcnt vmcnt(0)
    v_cmp_ne_u32 vcc, s3, v248
    s_sub_u32 s11, s11, 1
    s_cmp_eq_u32 s11, 0
    s_cbranch_scc1 L_m_pe35
    s_cbranch_vccnz L_m_pl34
L_m_pe35:
L_p2_hb:
    s_mov_b32 s8, s92
    s_mov_b32 s9, s93
    s_mov_b32 s10, 44273664
    s_mov_b32 s11, 0x20000
    s_cmp_eq_u32 s20, 7
    s_cbranch_scc0 L_p2_ht
    v_and_b32 v172, 7, v1
    v_lshlrev_b32 v172, 15, v172
    s_lshl_b32 s12, s2, 7
    s_add_u32 s12, s12, 41914368
    buffer_load_dword v173, v172, s[8:11], s12 offen sc1
    v_lshlrev_b32 v172, 20, v1
    s_lshr_b32 s12, s2, 3
    s_lshl_b32 s12, s12, 15
    buffer_load_dword v173, v172, s[8:11], s12 offen sc1
    s_mov_b32 s8, s88
    s_mov_b32 s9, s89
    s_mov_b32 s10, 2359296
    s_mov_b32 s11, 0x20000
    v_lshlrev_b32 v172, 16, v1
    buffer_load_dword v173, v172, s[8:11], 0 offen sc1
L_p2_ht:
    s_waitcnt lgkmcnt(3)
    v_mfma_f32_32x32x16_bf16 v[76:91], v[28:31], v[12:15], 0
    v_cvt_pk_bf16_f32 v58, v120, v121
    v_cvt_pk_bf16_f32 v59, v122, v123
    v_exp_f32 v60, v60
    v_exp_f32 v61, v61
    v_exp_f32 v62, v62
    v_exp_f32 v63, v63
    v_mfma_f32_32x32x16_bf16 v[140:155], v[156:159], v[56:59], v[140:155]
    v_exp_f32 v64, v64
    v_exp_f32 v65, v65
    v_exp_f32 v66, v66
    v_exp_f32 v67, v67
    v_cvt_pk_bf16_f32 v44, v60, v61
    v_cvt_pk_bf16_f32 v45, v62, v63
    s_waitcnt lgkmcnt(0)
    v_mfma_f32_32x32x16_bf16 v[76:91], v[32:35], v[16:19], v[76:91]
    v_cvt_pk_bf16_f32 v46, v64, v65
    v_cvt_pk_bf16_f32 v47, v66, v67
    v_exp_f32 v68, v68
    v_exp_f32 v69, v69
    v_exp_f32 v70, v70
    v_exp_f32 v71, v71
    v_mfma_f32_32x32x16_bf16 v[124:139], v[36:39], v[44:47], v[124:139]
    v_exp_f32 v72, v72
    v_exp_f32 v73, v73
    v_cvt_pk_bf16_f32 v48, v68, v69
    v_cvt_pk_bf16_f32 v49, v70, v71
    v_exp_f32 v74, v74
    v_exp_f32 v75, v75
    v_mfma_f32_32x32x16_bf16 v[108:123], v[28:31], v[20:23], 0
    ds_read_b128 v[28:31], v2 offset:2048
    v_cvt_pk_bf16_f32 v50, v72, v73
    v_cvt_pk_bf16_f32 v51, v74, v75
    v_exp_f32 v92, v92
    v_exp_f32 v93, v93
    v_exp_f32 v94, v94
    v_exp_f32 v95, v95
    v_mfma_f32_32x32x16_bf16 v[124:139], v[40:43], v[48:51], v[124:139]
    v_exp_f32 v96, v96
    v_exp_f32 v97, v97
    v_exp_f32 v98, v98
    v_exp_f32 v99, v99
    v_cvt_pk_bf16_f32 v52, v92, v93
    v_cvt_pk_bf16_f32 v53, v94, v95
    v_mfma_f32_32x32x16_bf16 v[108:123], v[32:35], v[24:27], v[108:123]
    ds_read_b32 v32, v3 offset:256
    v_cvt_pk_bf16_f32 v54, v96, v97
    v_cvt_pk_bf16_f32 v55, v98, v99
    v_exp_f32 v100, v100
    v_exp_f32 v101, v101
    v_exp_f32 v102, v102
    v_exp_f32 v103, v103
    v_mfma_f32_32x32x16_bf16 v[140:155], v[36:39], v[52:55], v[140:155]
    s_mov_b64 exec, s[54:55]
    ds_read_b128 v[36:39], v4 offset:1152
    ds_read_b128 v[156:159], v4 offset:1728
    s_mov_b64 exec, -1
    v_exp_f32 v104, v104
    v_exp_f32 v105, v105
    v_cvt_pk_bf16_f32 v56, v100, v101
    v_cvt_pk_bf16_f32 v57, v102, v103
    v_exp_f32 v106, v106
    v_exp_f32 v107, v107
    s_waitcnt lgkmcnt(3)
    v_mfma_f32_32x32x16_bf16 v[60:75], v[28:31], v[12:15], 0
    v_cvt_pk_bf16_f32 v58, v104, v105
    v_cvt_pk_bf16_f32 v59, v106, v107
    v_exp_f32 v76, v76
    v_exp_f32 v77, v77
    v_exp_f32 v78, v78
    v_exp_f32 v79, v79
    v_mfma_f32_32x32x16_bf16 v[140:155], v[40:43], v[56:59], v[140:155]
    v_exp_f32 v80, v80
    v_exp_f32 v81, v81
    v_exp_f32 v82, v82
    v_exp_f32 v83, v83
    v_cvt_pk_bf16_f32 v44, v76, v77
    v_cvt_pk_bf16_f32 v45, v78, v79
    s_waitcnt lgkmcnt(0)
    v_mfma_f32_32x32x16_bf16 v[60:75], v[32:35], v[16:19], v[60:75]
    v_cvt_pk_bf16_f32 v46, v80, v81
    v_cvt_pk_bf16_f32 v47, v82, v83
    v_exp_f32 v84, v84
    v_exp_f32 v85, v85
    v_exp_f32 v86, v86
    v_exp_f32 v87, v87
    v_mfma_f32_32x32x16_bf16 v[124:139], v[36:39], v[44:47], v[124:139]
    v_exp_f32 v88, v88
    v_exp_f32 v89, v89
    v_cvt_pk_bf16_f32 v48, v84, v85
    v_cvt_pk_bf16_f32 v49, v86, v87
    v_exp_f32 v90, v90
    v_exp_f32 v91, v91
    v_mfma_f32_32x32x16_bf16 v[92:107], v[28:31], v[20:23], 0
    ds_read_b128 v[28:31], v2 offset:3072
    v_cvt_pk_bf16_f32 v50, v88, v89
    v_cvt_pk_bf16_f32 v51, v90, v91
    v_exp_f32 v108, v108
    v_exp_f32 v109, v109
    v_exp_f32 v110, v110
    v_exp_f32 v111, v111
    v_mfma_f32_32x32x16_bf16 v[124:139], v[156:159], v[48:51], v[124:139]
    v_exp_f32 v112, v112
    v_exp_f32 v113, v113
    v_exp_f32 v114, v114
    v_exp_f32 v115, v115
    v_cvt_pk_bf16_f32 v52, v108, v109
    v_cvt_pk_bf16_f32 v53, v110, v111
    v_mfma_f32_32x32x16_bf16 v[92:107], v[32:35], v[24:27], v[92:107]
    ds_read_b32 v32, v3 offset:384
    v_cvt_pk_bf16_f32 v54, v112, v113
    v_cvt_pk_bf16_f32 v55, v114, v115
    v_exp_f32 v116, v116
    v_exp_f32 v117, v117
    v_exp_f32 v118, v118
    v_exp_f32 v119, v119
    v_mfma_f32_32x32x16_bf16 v[140:155], v[36:39], v[52:55], v[140:155]
    s_mov_b64 exec, s[54:55]
    ds_read_b128 v[36:39], v4 offset:2304
    ds_read_b128 v[40:43], v4 offset:2880
    s_mov_b64 exec, -1
    v_exp_f32 v120, v120
    v_exp_f32 v121, v121
    v_cvt_pk_bf16_f32 v56, v116, v117
    v_cvt_pk_bf16_f32 v57, v118, v119
    v_exp_f32 v122, v122
    v_exp_f32 v123, v123
    s_waitcnt vmcnt(0) lgkmcnt(0)
    s_barrier
    s_cmp_ge_u32 s20, 4
    s_cbranch_scc0 L_p2_hc
    s_mov_b32 s66, 0
    s_cmp_lt_u32 s2, 216
    s_cbranch_scc0 L_p2_hc
    s_and_b32 s11, s19, 1
    s_mul_i32 s37, s11, 36864
    s_add_u32 s37, s37, 73728
    s_lshl_b32 s11, s11, 15
    s_cmp_lt_u32 s19, 2
    s_cselect_b32 s37, s37, s11
    s_movk_i32 s39, 1024
    v_lshrrev_b32 v172, 1, v1
    v_and_b32 v173, 1, v1
    v_lshlrev_b32 v173, 4, v173
    s_cmp_lt_u32 s2, 144
    s_cbranch_scc0 L_wo_load
    s_add_u32 s64, s92, 6912
    s_addc_u32 s65, s93, 0
    s_mov_b32 s66, 6912
    s_mov_b32 s67, 0x20000
    s_lshr_b32 s10, s19, 1
    s_mul_i32 s12, s10, 1152
    s_add_u32 m0, s37, 9216
    s_add_u32 s13, s12, 2304
    buffer_load_dwordx4 v171, s[64:67], s12 offen sc1 lds
    s_add_u32 m0, s37, 10368
    s_mul_i32 s36, s10, 2654208
    buffer_load_dwordx4 v171, s[64:67], s13 offen sc1 lds
    s_mov_b64 exec, 0xff
    s_add_u32 m0, s37, 9216
    s_lshl_b32 s10, s2, 1
    buffer_load_dwordx4 v171, s[64:67], s12 offen offset:1024 sc1 lds
    s_add_u32 m0, s37, 10368
    s_and_b32 s11, s19, 1
    buffer_load_dwordx4 v171, s[64:67], s13 offen offset:1024 sc1 lds
    s_mov_b64 exec, -1
    s_add_u32 s10, s10, s11
    s_lshl_b32 s10, s10, 5
    s_add_u32 s36, s36, s10
    s_mov_b32 s38, 294912
    v_mul_u32_u24 v172, 9216, v172
    v_add_u32 v171, v172, v173
    s_mov_b32 s64, s76
    s_mov_b32 s65, s77
    s_mov_b32 s66, 5308416
    s_mov_b32 s67, 0x20000
    s_branch L_p2_hc
L_wo_load:
    s_mov_b32 s64, s82
    s_mov_b32 s65, s83
    s_mov_b32 s66, 2654208
    s_mov_b32 s67, 0x20000
    v_mul_u32_u24 v172, 1152, v172
    v_add_u32 v171, v172, v173
    s_sub_u32 s10, s2, 144
    s_and_b32 s36, s10, 7
    s_mul_i32 s36, s36, 331776
    s_lshr_b32 s10, s10, 3
    s_lshl_b32 s10, s10, 2
    s_add_u32 s10, s10, s19
    s_lshl_b32 s10, s10, 5
    s_add_u32 s36, s36, s10
    s_mov_b32 s38, 36864
L_p2_hc:
    s_waitcnt lgkmcnt(3)
    v_mfma_f32_32x32x16_bf16 v[76:91], v[28:31], v[12:15], 0
    v_cvt_pk_bf16_f32 v58, v120, v121
    v_cvt_pk_bf16_f32 v59, v122, v123
    v_exp_f32 v60, v60
    v_exp_f32 v61, v61
    v_exp_f32 v62, v62
    v_exp_f32 v63, v63
    v_mfma_f32_32x32x16_bf16 v[140:155], v[156:159], v[56:59], v[140:155]
    v_exp_f32 v64, v64
    v_exp_f32 v65, v65
    v_exp_f32 v66, v66
    v_exp_f32 v67, v67
    v_cvt_pk_bf16_f32 v44, v60, v61
    v_cvt_pk_bf16_f32 v45, v62, v63
    s_waitcnt lgkmcnt(0)
    v_mfma_f32_32x32x16_bf16 v[76:91], v[32:35], v[16:19], v[76:91]
    v_cvt_pk_bf16_f32 v46, v64, v65
    v_cvt_pk_bf16_f32 v47, v66, v67
    v_exp_f32 v68, v68
    v_exp_f32 v69, v69
    v_exp_f32 v70, v70
    v_exp_f32 v71, v71
    v_mfma_f32_32x32x16_bf16 v[124:139], v[36:39], v[44:47], v[124:139]
    v_exp_f32 v72, v72
    v_exp_f32 v73, v73
    v_cvt_pk_bf16_f32 v48, v68, v69
    v_cvt_pk_bf16_f32 v49, v70, v71
    v_exp_f32 v74, v74
    v_exp_f32 v75, v75
    v_mfma_f32_32x32x16_bf16 v[108:123], v[28:31], v[20:23], 0
    ds_read_b128 v[28:31], v2 offset:4096
    v_cvt_pk_bf16_f32 v50, v72, v73
    v_cvt_pk_bf16_f32 v51, v74, v75
    v_exp_f32 v92, v92
    v_exp_f32 v93, v93
    v_exp_f32 v94, v94
    v_exp_f32 v95, v95
    v_mfma_f32_32x32x16_bf16 v[124:139], v[40:43], v[48:51], v[124:139]
    v_exp_f32 v96, v96
    v_exp_f32 v97, v97
    v_exp_f32 v98, v98
    v_exp_f32 v99, v99
    v_cvt_pk_bf16_f32 v52, v92, v93
    v_cvt_pk_bf16_f32 v53, v94, v95
    v_mfma_f32_32x32x16_bf16 v[108:123], v[32:35], v[24:27], v[108:123]
    ds_read_b32 v32, v3 offset:1024
    v_cvt_pk_bf16_f32 v54, v96, v97
    v_cvt_pk_bf16_f32 v55, v98, v99
    v_exp_f32 v100, v100
    v_exp_f32 v101, v101
    v_exp_f32 v102, v102
    v_exp_f32 v103, v103
    v_mfma_f32_32x32x16_bf16 v[140:155], v[36:39], v[52:55], v[140:155]
    s_mov_b64 exec, s[54:55]
    ds_read_b128 v[36:39], v4 offset:3456
    ds_read_b128 v[156:159], v4 offset:4032
    s_mov_b64 exec, -1
    v_exp_f32 v104, v104
    v_exp_f32 v105, v105
    v_cvt_pk_bf16_f32 v56, v100, v101
    v_cvt_pk_bf16_f32 v57, v102, v103
    v_exp_f32 v106, v106
    v_exp_f32 v107, v107
    s_waitcnt lgkmcnt(3)
    v_mfma_f32_32x32x16_bf16 v[60:75], v[28:31], v[12:15], 0
    s_mov_b32 m0, s37
    s_add_u32 s37, s37, s39
    buffer_load_dwordx4 v171, s[64:67], s36 offen lds
    s_add_u32 s36, s36, s38
    v_cvt_pk_bf16_f32 v58, v104, v105
    v_cvt_pk_bf16_f32 v59, v106, v107
    v_exp_f32 v76, v76
    v_exp_f32 v77, v77
    v_exp_f32 v78, v78
    v_exp_f32 v79, v79
    v_mfma_f32_32x32x16_bf16 v[140:155], v[40:43], v[56:59], v[140:155]
    v_exp_f32 v80, v80
    v_exp_f32 v81, v81
    v_exp_f32 v82, v82
    v_exp_f32 v83, v83
    v_cvt_pk_bf16_f32 v44, v76, v77
    v_cvt_pk_bf16_f32 v45, v78, v79
    s_waitcnt lgkmcnt(0)
    v_mfma_f32_32x32x16_bf16 v[60:75], v[32:35], v[16:19], v[60:75]
    v_cvt_pk_bf16_f32 v46, v80, v81
    v_cvt_pk_bf16_f32 v47, v82, v83
    v_exp_f32 v84, v84
    v_exp_f32 v85, v85
    v_exp_f32 v86, v86
    v_exp_f32 v87, v87
    v_mfma_f32_32x32x16_bf16 v[124:139], v[36:39], v[44:47], v[124:139]
    v_exp_f32 v88, v88
    v_exp_f32 v89, v89
    v_cvt_pk_bf16_f32 v48, v84, v85
    v_cvt_pk_bf16_f32 v49, v86, v87
    v_exp_f32 v90, v90
    v_exp_f32 v91, v91
    s_setprio 0
    v_mfma_f32_32x32x16_bf16 v[92:107], v[28:31], v[20:23], 0
    ds_read_b128 v[28:31], v2 offset:5120
    v_cvt_pk_bf16_f32 v50, v88, v89
    v_cvt_pk_bf16_f32 v51, v90, v91
    v_exp_f32 v108, v108
    v_exp_f32 v109, v109
    v_exp_f32 v110, v110
    v_exp_f32 v111, v111
    v_mfma_f32_32x32x16_bf16 v[124:139], v[156:159], v[48:51], v[124:139]
    v_exp_f32 v112, v112
    v_exp_f32 v113, v113
    v_exp_f32 v114, v114
    v_exp_f32 v115, v115
    v_cvt_pk_bf16_f32 v52, v108, v109
    v_cvt_pk_bf16_f32 v53, v110, v111
    v_mfma_f32_32x32x16_bf16 v[92:107], v[32:35], v[24:27], v[92:107]
    ds_read_b32 v32, v3 offset:1152
    v_cvt_pk_bf16_f32 v54, v112, v113
    v_cvt_pk_bf16_f32 v55, v114, v115
    v_exp_f32 v116, v116
    v_exp_f32 v117, v117
    v_exp_f32 v118, v118
    v_exp_f32 v119, v119
    v_mfma_f32_32x32x16_bf16 v[140:155], v[36:39], v[52:55], v[140:155]
    s_mov_b64 exec, s[54:55]
    ds_read_b128 v[36:39], v4 offset:4608
    ds_read_b128 v[40:43], v4 offset:5184
    s_mov_b64 exec, -1
    v_exp_f32 v120, v120
    v_exp_f32 v121, v121
    v_cvt_pk_bf16_f32 v56, v116, v117
    v_cvt_pk_bf16_f32 v57, v118, v119
    v_exp_f32 v122, v122
    v_exp_f32 v123, v123
    v_add_u32 v2, 4096, v2
    v_add_u32 v3, 1024, v3
    v_add_u32 v4, 4608, v4
    s_mov_b32 s52, 2
.p2align 3
L_m_at36:
    s_cmp_eq_u32 s16, 0
    s_cbranch_scc1 L_m_lp37
    s_setprio 1
L_m_lp37:
    s_waitcnt lgkmcnt(3)
    v_mfma_f32_32x32x16_bf16 v[76:91], v[28:31], v[12:15], 0
    s_mov_b32 m0, s37
    s_add_u32 s37, s37, s39
    buffer_load_dwordx4 v171, s[64:67], s36 offen lds
    s_add_u32 s36, s36, s38
    v_cvt_pk_bf16_f32 v58, v120, v121
    v_cvt_pk_bf16_f32 v59, v122, v123
    v_exp_f32 v60, v60
    v_exp_f32 v61, v61
    v_exp_f32 v62, v62
    v_exp_f32 v63, v63
    v_mfma_f32_32x32x16_bf16 v[140:155], v[156:159], v[56:59], v[140:155]
    v_exp_f32 v64, v64
    v_exp_f32 v65, v65
    v_exp_f32 v66, v66
    v_exp_f32 v67, v67
    v_cvt_pk_bf16_f32 v44, v60, v61
    v_cvt_pk_bf16_f32 v45, v62, v63
    s_waitcnt lgkmcnt(0)
    v_mfma_f32_32x32x16_bf16 v[76:91], v[32:35], v[16:19], v[76:91]
    v_cvt_pk_bf16_f32 v46, v64, v65
    v_cvt_pk_bf16_f32 v47, v66, v67
    v_exp_f32 v68, v68
    v_exp_f32 v69, v69
    v_exp_f32 v70, v70
    v_exp_f32 v71, v71
    v_mfma_f32_32x32x16_bf16 v[124:139], v[36:39], v[44:47], v[124:139]
    v_exp_f32 v72, v72
    v_exp_f32 v73, v73
    v_cvt_pk_bf16_f32 v48, v68, v69
    v_cvt_pk_bf16_f32 v49, v70, v71
    v_exp_f32 v74, v74
    v_exp_f32 v75, v75
    v_mfma_f32_32x32x16_bf16 v[108:123], v[28:31], v[20:23], 0
    ds_read_b128 v[28:31], v2 offset:2048
    v_cvt_pk_bf16_f32 v50, v72, v73
    v_cvt_pk_bf16_f32 v51, v74, v75
    v_exp_f32 v92, v92
    v_exp_f32 v93, v93
    v_exp_f32 v94, v94
    v_exp_f32 v95, v95
    v_mfma_f32_32x32x16_bf16 v[124:139], v[40:43], v[48:51], v[124:139]
    v_exp_f32 v96, v96
    v_exp_f32 v97, v97
    v_exp_f32 v98, v98
    v_exp_f32 v99, v99
    v_cvt_pk_bf16_f32 v52, v92, v93
    v_cvt_pk_bf16_f32 v53, v94, v95
    v_mfma_f32_32x32x16_bf16 v[108:123], v[32:35], v[24:27], v[108:123]
    ds_read_b32 v32, v3 offset:256
    v_cvt_pk_bf16_f32 v54, v96, v97
    v_cvt_pk_bf16_f32 v55, v98, v99
    v_exp_f32 v100, v100
    v_exp_f32 v101, v101
    v_exp_f32 v102, v102
    v_exp_f32 v103, v103
    v_mfma_f32_32x32x16_bf16 v[140:155], v[36:39], v[52:55], v[140:155]
    s_mov_b64 exec, s[54:55]
    ds_read_b128 v[36:39], v4 offset:1152
    ds_read_b128 v[156:159], v4 offset:1728
    s_mov_b64 exec, -1
    v_exp_f32 v104, v104
    v_exp_f32 v105, v105
    v_cvt_pk_bf16_f32 v56, v100, v101
    v_cvt_pk_bf16_f32 v57, v102, v103
    v_exp_f32 v106, v106
    v_exp_f32 v107, v107
    s_waitcnt lgkmcnt(3)
    v_mfma_f32_32x32x16_bf16 v[60:75], v[28:31], v[12:15], 0
    s_mov_b32 m0, s37
    s_add_u32 s37, s37, s39
    buffer_load_dwordx4 v171, s[64:67], s36 offen lds
    s_add_u32 s36, s36, s38
    v_cvt_pk_bf16_f32 v58, v104, v105
    v_cvt_pk_bf16_f32 v59, v106, v107
    v_exp_f32 v76, v76
    v_exp_f32 v77, v77
    v_exp_f32 v78, v78
    v_exp_f32 v79, v79
    v_mfma_f32_32x32x16_bf16 v[140:155], v[40:43], v[56:59], v[140:155]
    v_exp_f32 v80, v80
    v_exp_f32 v81, v81
    v_exp_f32 v82, v82
    v_exp_f32 v83, v83
    v_cvt_pk_bf16_f32 v44, v76, v77
    v_cvt_pk_bf16_f32 v45, v78, v79
    s_waitcnt lgkmcnt(0)
    v_mfma_f32_32x32x16_bf16 v[60:75], v[32:35], v[16:19], v[60:75]
    v_cvt_pk_bf16_f32 v46, v80, v81
    v_cvt_pk_bf16_f32 v47, v82, v83
    v_exp_f32 v84, v84
    v_exp_f32 v85, v85
    v_exp_f32 v86, v86
    v_exp_f32 v87, v87
    v_mfma_f32_32x32x16_bf16 v[124:139], v[36:39], v[44:47], v[124:139]
    v_exp_f32 v88, v88
    v_exp_f32 v89, v89
    v_cvt_pk_bf16_f32 v48, v84, v85
    v_cvt_pk_bf16_f32 v49, v86, v87
    v_exp_f32 v90, v90
    v_exp_f32 v91, v91
    v_mfma_f32_32x32x16_bf16 v[92:107], v[28:31], v[20:23], 0
    ds_read_b128 v[28:31], v2 offset:3072
    v_cvt_pk_bf16_f32 v50, v88, v89
    v_cvt_pk_bf16_f32 v51, v90, v91
    v_exp_f32 v108, v108
    v_exp_f32 v109, v109
    v_exp_f32 v110, v110
    v_exp_f32 v111, v111
    v_mfma_f32_32x32x16_bf16 v[124:139], v[156:159], v[48:51], v[124:139]
    v_exp_f32 v112, v112
    v_exp_f32 v113, v113
    v_exp_f32 v114, v114
    v_exp_f32 v115, v115
    v_cvt_pk_bf16_f32 v52, v108, v109
    v_cvt_pk_bf16_f32 v53, v110, v111
    v_mfma_f32_32x32x16_bf16 v[92:107], v[32:35], v[24:27], v[92:107]
    ds_read_b32 v32, v3 offset:384
    v_cvt_pk_bf16_f32 v54, v112, v113
    v_cvt_pk_bf16_f32 v55, v114, v115
    v_exp_f32 v116, v116
    v_exp_f32 v117, v117
    v_exp_f32 v118, v118
    v_exp_f32 v119, v119
    v_mfma_f32_32x32x16_bf16 v[140:155], v[36:39], v[52:55], v[140:155]
    s_mov_b64 exec, s[54:55]
    ds_read_b128 v[36:39], v4 offset:2304
    ds_read_b128 v[40:43], v4 offset:2880
    s_mov_b64 exec, -1
    v_exp_f32 v120, v120
    v_exp_f32 v121, v121
    v_cvt_pk_bf16_f32 v56, v116, v117
    v_cvt_pk_bf16_f32 v57, v118, v119
    v_exp_f32 v122, v122
    v_exp_f32 v123, v123
    s_waitcnt lgkmcnt(3)
    v_mfma_f32_32x32x16_bf16 v[76:91], v[28:31], v[12:15], 0
    s_mov_b32 m0, s37
    s_add_u32 s37, s37, s39
    buffer_load_dwordx4 v171, s[64:67], s36 offen lds
    s_add_u32 s36, s36, s38
    v_cvt_pk_bf16_f32 v58, v120, v121
    v_cvt_pk_bf16_f32 v59, v122, v123
    v_exp_f32 v60, v60
    v_exp_f32 v61, v61
    v_exp_f32 v62, v62
    v_exp_f32 v63, v63
    v_mfma_f32_32x32x16_bf16 v[140:155], v[156:159], v[56:59], v[140:155]
    v_exp_f32 v64, v64
    v_exp_f32 v65, v65
    v_exp_f32 v66, v66
    v_exp_f32 v67, v67
    v_cvt_pk_bf16_f32 v44, v60, v61
    v_cvt_pk_bf16_f32 v45, v62, v63
    s_waitcnt lgkmcnt(0)
    v_mfma_f32_32x32x16_bf16 v[76:91], v[32:35], v[16:19], v[76:91]
    v_cvt_pk_bf16_f32 v46, v64, v65
    v_cvt_pk_bf16_f32 v47, v66, v67
    v_exp_f32 v68, v68
    v_exp_f32 v69, v69
    v_exp_f32 v70, v70
    v_exp_f32 v71, v71
    v_mfma_f32_32x32x16_bf16 v[124:139], v[36:39], v[44:47], v[124:139]
    v_exp_f32 v72, v72
    v_exp_f32 v73, v73
    v_cvt_pk_bf16_f32 v48, v68, v69
    v_cvt_pk_bf16_f32 v49, v70, v71
    v_exp_f32 v74, v74
    v_exp_f32 v75, v75
    v_mfma_f32_32x32x16_bf16 v[108:123], v[28:31], v[20:23], 0
    ds_read_b128 v[28:31], v2 offset:4096
    v_cvt_pk_bf16_f32 v50, v72, v73
    v_cvt_pk_bf16_f32 v51, v74, v75
    v_exp_f32 v92, v92
    v_exp_f32 v93, v93
    v_exp_f32 v94, v94
    v_exp_f32 v95, v95
    v_mfma_f32_32x32x16_bf16 v[124:139], v[40:43], v[48:51], v[124:139]
    v_exp_f32 v96, v96
    v_exp_f32 v97, v97
    v_exp_f32 v98, v98
    v_exp_f32 v99, v99
    v_cvt_pk_bf16_f32 v52, v92, v93
    v_cvt_pk_bf16_f32 v53, v94, v95
    v_mfma_f32_32x32x16_bf16 v[108:123], v[32:35], v[24:27], v[108:123]
    ds_read_b32 v32, v3 offset:1024
    v_cvt_pk_bf16_f32 v54, v96, v97
    v_cvt_pk_bf16_f32 v55, v98, v99
    v_exp_f32 v100, v100
    v_exp_f32 v101, v101
    v_exp_f32 v102, v102
    v_exp_f32 v103, v103
    v_mfma_f32_32x32x16_bf16 v[140:155], v[36:39], v[52:55], v[140:155]
    s_mov_b64 exec, s[54:55]
    ds_read_b128 v[36:39], v4 offset:3456
    ds_read_b128 v[156:159], v4 offset:4032
    s_mov_b64 exec, -1
    v_exp_f32 v104, v104
    v_exp_f32 v105, v105
    v_cvt_pk_bf16_f32 v56, v100, v101
    v_cvt_pk_bf16_f32 v57, v102, v103
    v_exp_f32 v106, v106
    v_exp_f32 v107, v107
    s_waitcnt lgkmcnt(3)
    v_mfma_f32_32x32x16_bf16 v[60:75], v[28:31], v[12:15], 0
    s_mov_b32 m0, s37
    s_add_u32 s37, s37, s39
    buffer_load_dwordx4 v171, s[64:67], s36 offen lds
    s_add_u32 s36, s36, s38
    v_cvt_pk_bf16_f32 v58, v104, v105
    v_cvt_pk_bf16_f32 v59, v106, v107
    v_exp_f32 v76, v76
    v_exp_f32 v77, v77
    v_exp_f32 v78, v78
    v_exp_f32 v79, v79
    v_mfma_f32_32x32x16_bf16 v[140:155], v[40:43], v[56:59], v[140:155]
    v_exp_f32 v80, v80
    v_exp_f32 v81, v81
    v_exp_f32 v82, v82
    v_exp_f32 v83, v83
    v_cvt_pk_bf16_f32 v44, v76, v77
    v_cvt_pk_bf16_f32 v45, v78, v79
    s_waitcnt lgkmcnt(0)
    v_mfma_f32_32x32x16_bf16 v[60:75], v[32:35], v[16:19], v[60:75]
    v_cvt_pk_bf16_f32 v46, v80, v81
    v_cvt_pk_bf16_f32 v47, v82, v83
    v_exp_f32 v84, v84
    v_exp_f32 v85, v85
    v_exp_f32 v86, v86
    v_exp_f32 v87, v87
    v_mfma_f32_32x32x16_bf16 v[124:139], v[36:39], v[44:47], v[124:139]
    v_exp_f32 v88, v88
    v_exp_f32 v89, v89
    v_cvt_pk_bf16_f32 v48, v84, v85
    v_cvt_pk_bf16_f32 v49, v86, v87
    v_exp_f32 v90, v90
    v_exp_f32 v91, v91
    v_mfma_f32_32x32x16_bf16 v[92:107], v[28:31], v[20:23], 0
    ds_read_b128 v[28:31], v2 offset:5120
    v_cvt_pk_bf16_f32 v50, v88, v89
    v_cvt_pk_bf16_f32 v51, v90, v91
    v_exp_f32 v108, v108
    v_exp_f32 v109, v109
    v_exp_f32 v110, v110
    v_exp_f32 v111, v111
    v_mfma_f32_32x32x16_bf16 v[124:139], v[156:159], v[48:51], v[124:139]
    v_exp_f32 v112, v112
    v_exp_f32 v113, v113
    v_exp_f32 v114, v114
    v_exp_f32 v115, v115
    v_cvt_pk_bf16_f32 v52, v108, v109
    v_cvt_pk_bf16_f32 v53, v110, v111
    v_mfma_f32_32x32x16_bf16 v[92:107], v[32:35], v[24:27], v[92:107]
    ds_read_b32 v32, v3 offset:1152
    v_cvt_pk_bf16_f32 v54, v112, v113
    v_cvt_pk_bf16_f32 v55, v114, v115
    v_exp_f32 v116, v116
    v_exp_f32 v117, v117
    v_exp_f32 v118, v118
    v_exp_f32 v119, v119
    v_mfma_f32_32x32x16_bf16 v[140:155], v[36:39], v[52:55], v[140:155]
    s_mov_b64 exec, s[54:55]
    ds_read_b128 v[36:39], v4 offset:4608
    ds_read_b128 v[40:43], v4 offset:5184
    s_mov_b64 exec, -1
    v_exp_f32 v120, v120
    v_exp_f32 v121, v121
    v_cvt_pk_bf16_f32 v56, v116, v117
    v_cvt_pk_bf16_f32 v57, v118, v119
    v_exp_f32 v122, v122
    v_exp_f32 v123, v123
    v_add_u32 v2, 4096, v2
    v_add_u32 v3, 1024, v3
    v_add_u32 v4, 4608, v4
    s_sub_u32 s52, s52, 1
    s_cmp_lg_u32 s52, 0
    s_cbranch_scc1 L_m_at36
    s_mov_b32 s52, 3
.p2align 3
L_m_at38:
    s_cmp_eq_u32 s16, 0
    s_cbranch_scc1 L_m_lp39
    s_setprio 1
L_m_lp39:
    s_waitcnt lgkmcnt(3)
    v_mfma_f32_32x32x16_bf16 v[76:91], v[28:31], v[12:15], 0
    v_cvt_pk_bf16_f32 v58, v120, v121
    v_cvt_pk_bf16_f32 v59, v122, v123
    v_exp_f32 v60, v60
    v_exp_f32 v61, v61
    v_exp_f32 v62, v62
    v_exp_f32 v63, v63
    v_mfma_f32_32x32x16_bf16 v[140:155], v[156:159], v[56:59], v[140:155]
    v_exp_f32 v64, v64
    v_exp_f32 v65, v65
    v_exp_f32 v66, v66
    v_exp_f32 v67, v67
    v_cvt_pk_bf16_f32 v44, v60, v61
    v_cvt_pk_bf16_f32 v45, v62, v63
    s_waitcnt lgkmcnt(0)
    v_mfma_f32_32x32x16_bf16 v[76:91], v[32:35], v[16:19], v[76:91]
    v_cvt_pk_bf16_f32 v46, v64, v65
    v_cvt_pk_bf16_f32 v47, v66, v67
    v_exp_f32 v68, v68
    v_exp_f32 v69, v69
    v_exp_f32 v70, v70
    v_exp_f32 v71, v71
    v_mfma_f32_32x32x16_bf16 v[124:139], v[36:39], v[44:47], v[124:139]
    v_exp_f32 v72, v72
    v_exp_f32 v73, v73
    v_cvt_pk_bf16_f32 v48, v68, v69
    v_cvt_pk_bf16_f32 v49, v70, v71
    v_exp_f32 v74, v74
    v_exp_f32 v75, v75
    v_mfma_f32_32x32x16_bf16 v[108:123], v[28:31], v[20:23], 0
    ds_read_b128 v[28:31], v2 offset:2048
    v_cvt_pk_bf16_f32 v50, v72, v73
    v_cvt_pk_bf16_f32 v51, v74, v75
    v_exp_f32 v92, v92
    v_exp_f32 v93, v93
    v_exp_f32 v94, v94
    v_exp_f32 v95, v95
    v_mfma_f32_32x32x16_bf16 v[124:139], v[40:43], v[48:51], v[124:139]
    v_exp_f32 v96, v96
    v_exp_f32 v97, v97
    v_exp_f32 v98, v98
    v_exp_f32 v99, v99
    v_cvt_pk_bf16_f32 v52, v92, v93
    v_cvt_pk_bf16_f32 v53, v94, v95
    v_mfma_f32_32x32x16_bf16 v[108:123], v[32:35], v[24:27], v[108:123]
    ds_read_b32 v32, v3 offset:256
    v_cvt_pk_bf16_f32 v54, v96, v97
    v_cvt_pk_bf16_f32 v55, v98, v99
    v_exp_f32 v100, v100
    v_exp_f32 v101, v101
    v_exp_f32 v102, v102
    v_exp_f32 v103, v103
    v_mfma_f32_32x32x16_bf16 v[140:155], v[36:39], v[52:55], v[140:155]
    s_mov_b64 exec, s[54:55]
    ds_read_b128 v[36:39], v4 offset:1152
    ds_read_b128 v[156:159], v4 offset:1728
    s_mov_b64 exec, -1
    v_exp_f32 v104, v104
    v_exp_f32 v105, v105
    v_cvt_pk_bf16_f32 v56, v100, v101
    v_cvt_pk_bf16_f32 v57, v102, v103
    v_exp_f32 v106, v106
    v_exp_f32 v107, v107
    s_waitcnt lgkmcnt(3)
    v_mfma_f32_32x32x16_bf16 v[60:75], v[28:31], v[12:15], 0
    v_cvt_pk_bf16_f32 v58, v104, v105
    v_cvt_pk_bf16_f32 v59, v106, v107
    v_exp_f32 v76, v76
    v_exp_f32 v77, v77
    v_exp_f32 v78, v78
    v_exp_f32 v79, v79
    v_mfma_f32_32x32x16_bf16 v[140:155], v[40:43], v[56:59], v[140:155]
    v_exp_f32 v80, v80
    v_exp_f32 v81, v81
    v_exp_f32 v82, v82
    v_exp_f32 v83, v83
    v_cvt_pk_bf16_f32 v44, v76, v77
    v_cvt_pk_bf16_f32 v45, v78, v79
    s_waitcnt lgkmcnt(0)
    v_mfma_f32_32x32x16_bf16 v[60:75], v[32:35], v[16:19], v[60:75]
    v_cvt_pk_bf16_f32 v46, v80, v81
    v_cvt_pk_bf16_f32 v47, v82, v83
    v_exp_f32 v84, v84
    v_exp_f32 v85, v85
    v_exp_f32 v86, v86
    v_exp_f32 v87, v87
    v_mfma_f32_32x32x16_bf16 v[124:139], v[36:39], v[44:47], v[124:139]
    v_exp_f32 v88, v88
    v_exp_f32 v89, v89
    v_cvt_pk_bf16_f32 v48, v84, v85
    v_cvt_pk_bf16_f32 v49, v86, v87
    v_exp_f32 v90, v90
    v_exp_f32 v91, v91
    v_mfma_f32_32x32x16_bf16 v[92:107], v[28:31], v[20:23], 0
    ds_read_b128 v[28:31], v2 offset:3072
    v_cvt_pk_bf16_f32 v50, v88, v89
    v_cvt_pk_bf16_f32 v51, v90, v91
    v_exp_f32 v108, v108
    v_exp_f32 v109, v109
    v_exp_f32 v110, v110
    v_exp_f32 v111, v111
    v_mfma_f32_32x32x16_bf16 v[124:139], v[156:159], v[48:51], v[124:139]
    v_exp_f32 v112, v112
    v_exp_f32 v113, v113
    v_exp_f32 v114, v114
    v_exp_f32 v115, v115
    v_cvt_pk_bf16_f32 v52, v108, v109
    v_cvt_pk_bf16_f32 v53, v110, v111
    v_mfma_f32_32x32x16_bf16 v[92:107], v[32:35], v[24:27], v[92:107]
    ds_read_b32 v32, v3 offset:384
    v_cvt_pk_bf16_f32 v54, v112, v113
    v_cvt_pk_bf16_f32 v55, v114, v115
    v_exp_f32 v116, v116
    v_exp_f32 v117, v117
    v_exp_f32 v118, v118
    v_exp_f32 v119, v119
    v_mfma_f32_32x32x16_bf16 v[140:155], v[36:39], v[52:55], v[140:155]
    s_mov_b64 exec, s[54:55]
    ds_read_b128 v[36:39], v4 offset:2304
    ds_read_b128 v[40:43], v4 offset:2880
    s_mov_b64 exec, -1
    v_exp_f32 v120, v120
    v_exp_f32 v121, v121
    v_cvt_pk_bf16_f32 v56, v116, v117
    v_cvt_pk_bf16_f32 v57, v118, v119
    v_exp_f32 v122, v122
    v_exp_f32 v123, v123
    s_waitcnt lgkmcnt(3)
    v_mfma_f32_32x32x16_bf16 v[76:91], v[28:31], v[12:15], 0
    v_cvt_pk_bf16_f32 v58, v120, v121
    v_cvt_pk_bf16_f32 v59, v122, v123
    v_exp_f32 v60, v60
    v_exp_f32 v61, v61
    v_exp_f32 v62, v62
    v_exp_f32 v63, v63
    v_mfma_f32_32x32x16_bf16 v[140:155], v[156:159], v[56:59], v[140:155]
    v_exp_f32 v64, v64
    v_exp_f32 v65, v65
    v_exp_f32 v66, v66
    v_exp_f32 v67, v67
    v_cvt_pk_bf16_f32 v44, v60, v61
    v_cvt_pk_bf16_f32 v45, v62, v63
    s_waitcnt lgkmcnt(0)
    v_mfma_f32_32x32x16_bf16 v[76:91], v[32:35], v[16:19], v[76:91]
    v_cvt_pk_bf16_f32 v46, v64, v65
    v_cvt_pk_bf16_f32 v47, v66, v67
    v_exp_f32 v68, v68
    v_exp_f32 v69, v69
    v_exp_f32 v70, v70
    v_exp_f32 v71, v71
    v_mfma_f32_32x32x16_bf16 v[124:139], v[36:39], v[44:47], v[124:139]
    v_exp_f32 v72, v72
    v_exp_f32 v73, v73
    v_cvt_pk_bf16_f32 v48, v68, v69
    v_cvt_pk_bf16_f32 v49, v70, v71
    v_exp_f32 v74, v74
    v_exp_f32 v75, v75
    v_mfma_f32_32x32x16_bf16 v[108:123], v[28:31], v[20:23], 0
    ds_read_b128 v[28:31], v2 offset:4096
    v_cvt_pk_bf16_f32 v50, v72, v73
    v_cvt_pk_bf16_f32 v51, v74, v75
    v_exp_f32 v92, v92
    v_exp_f32 v93, v93
    v_exp_f32 v94, v94
    v_exp_f32 v95, v95
    v_mfma_f32_32x32x16_bf16 v[124:139], v[40:43], v[48:51], v[124:139]
    v_exp_f32 v96, v96
    v_exp_f32 v97, v97
    v_exp_f32 v98, v98
    v_exp_f32 v99, v99
    v_cvt_pk_bf16_f32 v52, v92, v93
    v_cvt_pk_bf16_f32 v53, v94, v95
    v_mfma_f32_32x32x16_bf16 v[108:123], v[32:35], v[24:27], v[108:123]
    ds_read_b32 v32, v3 offset:1024
    v_cvt_pk_bf16_f32 v54, v96, v97
    v_cvt_pk_bf16_f32 v55, v98, v99
    v_exp_f32 v100, v100
    v_exp_f32 v101, v101
    v_exp_f32 v102, v102
    v_exp_f32 v103, v103
    v_mfma_f32_32x32x16_bf16 v[140:155], v[36:39], v[52:55], v[140:155]
    s_mov_b64 exec, s[54:55]
    ds_read_b128 v[36:39], v4 offset:3456
    ds_read_b128 v[156:159], v4 offset:4032
    s_mov_b64 exec, -1
    v_exp_f32 v104, v104
    v_exp_f32 v105, v105
    v_cvt_pk_bf16_f32 v56, v100, v101
    v_cvt_pk_bf16_f32 v57, v102, v103
    v_exp_f32 v106, v106
    v_exp_f32 v107, v107
    s_setprio 0
    s_waitcnt lgkmcnt(3)
    v_mfma_f32_32x32x16_bf16 v[60:75], v[28:31], v[12:15], 0
    v_cvt_pk_bf16_f32 v58, v104, v105
    v_cvt_pk_bf16_f32 v59, v106, v107
    v_exp_f32 v76, v76
    v_exp_f32 v77, v77
    v_exp_f32 v78, v78
    v_exp_f32 v79, v79
    v_mfma_f32_32x32x16_bf16 v[140:155], v[40:43], v[56:59], v[140:155]
    v_exp_f32 v80, v80
    v_exp_f32 v81, v81
    v_exp_f32 v82, v82
    v_exp_f32 v83, v83
    v_cvt_pk_bf16_f32 v44, v76, v77
    v_cvt_pk_bf16_f32 v45, v78, v79
    s_waitcnt lgkmcnt(0)
    v_mfma_f32_32x32x16_bf16 v[60:75], v[32:35], v[16:19], v[60:75]
    v_cvt_pk_bf16_f32 v46, v80, v81
    v_cvt_pk_bf16_f32 v47, v82, v83
    v_exp_f32 v84, v84
    v_exp_f32 v85, v85
    v_exp_f32 v86, v86
    v_exp_f32 v87, v87
    v_mfma_f32_32x32x16_bf16 v[124:139], v[36:39], v[44:47], v[124:139]
    v_exp_f32 v88, v88
    v_exp_f32 v89, v89
    v_cvt_pk_bf16_f32 v48, v84, v85
    v_cvt_pk_bf16_f32 v49, v86, v87
    v_exp_f32 v90, v90
    v_exp_f32 v91, v91
    v_mfma_f32_32x32x16_bf16 v[92:107], v[28:31], v[20:23], 0
    ds_read_b128 v[28:31], v2 offset:5120
    v_cvt_pk_bf16_f32 v50, v88, v89
    v_cvt_pk_bf16_f32 v51, v90, v91
    v_exp_f32 v108, v108
    v_exp_f32 v109, v109
    v_exp_f32 v110, v110
    v_exp_f32 v111, v111
    v_mfma_f32_32x32x16_bf16 v[124:139], v[156:159], v[48:51], v[124:139]
    v_exp_f32 v112, v112
    v_exp_f32 v113, v113
    v_exp_f32 v114, v114
    v_exp_f32 v115, v115
    v_cvt_pk_bf16_f32 v52, v108, v109
    v_cvt_pk_bf16_f32 v53, v110, v111
    v_mfma_f32_32x32x16_bf16 v[92:107], v[32:35], v[24:27], v[92:107]
    ds_read_b32 v32, v3 offset:1152
    v_cvt_pk_bf16_f32 v54, v112, v113
    v_cvt_pk_bf16_f32 v55, v114, v115
    v_exp_f32 v116, v116
    v_exp_f32 v117, v117
    v_exp_f32 v118, v118
    v_exp_f32 v119, v119
    v_mfma_f32_32x32x16_bf16 v[140:155], v[36:39], v[52:55], v[140:155]
    s_mov_b64 exec, s[54:55]
    ds_read_b128 v[36:39], v4 offset:4608
    ds_read_b128 v[40:43], v4 offset:5184
    s_mov_b64 exec, -1
    v_exp_f32 v120, v120
    v_exp_f32 v121, v121
    v_cvt_pk_bf16_f32 v56, v116, v117
    v_cvt_pk_bf16_f32 v57, v118, v119
    v_exp_f32 v122, v122
    v_exp_f32 v123, v123
    v_add_u32 v2, 4096, v2
    v_add_u32 v3, 1024, v3
    v_add_u32 v4, 4608, v4
    s_sub_u32 s52, s52, 1
    s_cmp_lg_u32 s52, 0
    s_cbranch_scc1 L_m_at38
    v_cvt_pk_bf16_f32 v58, v120, v121
    v_cvt_pk_bf16_f32 v59, v122, v123
    s_mul_i32 s10, s15, 3072
    s_lshl_b32 s11, s16, 15
    s_add_u32 s10, s10, s11
    s_add_u32 s10, s10, 12288
    v_add_u32 v2, s10, v5
    v_xor_b32 v3, 0x8000, v2
    v_mfma_f32_32x32x16_bf16 v[140:155], v[156:159], v[56:59], v[140:155]
    s_setprio 0
    s_nop 7
    s_nop 1
    s_waitcnt lgkmcnt(0)
    s_barrier
    ds_write_b128 v2, v[140:143] offset:0
    ds_write_b128 v2, v[144:147] offset:1024
    ds_write_b128 v2, v[148:151] offset:2048
    s_waitcnt lgkmcnt(0)
    s_barrier
    ds_read_b128 v[140:143], v3 offset:0
    ds_read_b128 v[144:147], v3 offset:1024
    ds_read_b128 v[148:151], v3 offset:2048
    s_mov_b32 s10, 528482304
    s_mov_b32 s11, 1602224128
    s_waitcnt lgkmcnt(0)
    s_barrier
    v_pk_add_f32 v[134:135], v[134:135], v[150:151]
    v_pk_add_f32 v[132:133], v[132:133], v[148:149]
    v_pk_add_f32 v[130:131], v[130:131], v[146:147]
    v_pk_add_f32 v[128:129], v[128:129], v[144:145]
    v_pk_add_f32 v[126:127], v[126:127], v[142:143]
    v_pk_add_f32 v[124:125], v[124:125], v[140:141]
    v_cmp_nle_f32 vcc, s10, v134
    v_cmp_nge_f32 s[12:13], s11, v134
    s_nop 1
    s_or_b64 vcc, vcc, s[12:13]
    s_cbranch_vccz L_p2_fin
    v_mov_b32 v92, 4284592614
    s_mov_b32 s52, 0
    v_and_b32 v10, 31, v1
    v_cmp_gt_u32 vcc, 16, v10
    v_lshl_add_u32 v2, v8, 4, v10
    v_lshl_add_u32 v3, v8, 1, v10
    v_add_u32 v3, 240, v3
    v_cndmask_b32 v2, v3, v2, vcc
    v_lshlrev_b32 v2, 4, v2
    v_mov_b32 v3, 64
    v_mov_b32 v4, 512
    v_cndmask_b32 v3, v3, v4, vcc
    v_mov_b32 v124, 0
    v_mov_b32 v125, 0
    v_mov_b32 v126, 0
    v_mov_b32 v127, 0
    v_mov_b32 v128, 0
    v_mov_b32 v129, 0
    v_mov_b32 v130, 0
    v_mov_b32 v131, 0
    v_mov_b32 v132, 0
    v_mov_b32 v133, 0
    v_mov_b32 v134, 0
    v_mov_b32 v135, 0
    v_mov_b32 v136, 0
    v_mov_b32 v137, 0
    v_mov_b32 v138, 0
    v_mov_b32 v139, 0
L_p2_sl:
    s_and_b32 s10, s52, 3
    s_lshl_b32 s10, s10, 1
    v_mad_u32_u24 v9, s10, v3, v2
    v_add_u32 v4, v9, v3
    s_lshr_b32 s10, s52, 2
    s_mul_i32 s10, s10, 4608
    s_add_u32 s10, s10, s58
    buffer_load_dwordx4 v[28:31], v5, s[24:27], s57 offen sc1
    buffer_load_dword v32, v7, s[24:27], s59 offen sc1
    s_mov_b64 exec, s[54:55]
    buffer_load_dwordx4 v[36:39], v9, s[24:27], s10 offen sc1
    buffer_load_dwordx4 v[40:43], v4, s[24:27], s10 offen sc1
    s_mov_b64 exec, -1
    s_add_u32 s57, s57, 1024
    s_add_u32 s59, s59, 128
    s_waitcnt vmcnt(0)
    v_mfma_f32_32x32x16_bf16 v[60:75], v[28:31], v[12:15], 0
    v_mfma_f32_32x32x16_bf16 v[60:75], v[32:35], v[16:19], v[60:75]
    s_nop 15
    s_nop 7
    v_max3_f32 v93, v60, v61, v92
    v_max3_f32 v93, v62, v63, v93
    v_max3_f32 v93, v64, v65, v93
    v_max3_f32 v93, v66, v67, v93
    v_max3_f32 v93, v68, v69, v93
    v_max3_f32 v93, v70, v71, v93
    v_max3_f32 v93, v72, v73, v93
    v_max3_f32 v93, v74, v75, v93
    v_mov_b32 v94, v93
    s_nop 1
    v_permlane32_swap_b32 v93, v94
    v_max_f32 v93, v93, v94
    v_sub_f32 v94, v92, v93
    v_exp_f32 v94, v94
    v_mov_b32 v92, v93
    v_sub_f32 v60, v60, v93
    v_sub_f32 v61, v61, v93
    v_sub_f32 v62, v62, v93
    v_sub_f32 v63, v63, v93
    v_sub_f32 v64, v64, v93
    v_sub_f32 v65, v65, v93
    v_sub_f32 v66, v66, v93
    v_sub_f32 v67, v67, v93
    v_sub_f32 v68, v68, v93
    v_sub_f32 v69, v69, v93
    v_sub_f32 v70, v70, v93
    v_sub_f32 v71, v71, v93
    v_sub_f32 v72, v72, v93
    v_sub_f32 v73, v73, v93
    v_sub_f32 v74, v74, v93
    v_sub_f32 v75, v75, v93
    v_mul_f32 v124, v124, v94
    v_mul_f32 v125, v125, v94
    v_mul_f32 v126, v126, v94
    v_mul_f32 v127, v127, v94
    v_mul_f32 v128, v128, v94
    v_mul_f32 v129, v129, v94
    v_mul_f32 v130, v130, v94
    v_mul_f32 v131, v131, v94
    v_mul_f32 v132, v132, v94
    v_mul_f32 v133, v133, v94
    v_mul_f32 v134, v134, v94
    v_mul_f32 v135, v135, v94
    v_mul_f32 v136, v136, v94
    v_mul_f32 v137, v137, v94
    v_mul_f32 v138, v138, v94
    v_mul_f32 v139, v139, v94
    v_exp_f32 v60, v60
    v_exp_f32 v61, v61
    v_exp_f32 v62, v62
    v_exp_f32 v63, v63
    v_exp_f32 v64, v64
    v_exp_f32 v65, v65
    v_exp_f32 v66, v66
    v_exp_f32 v67, v67
    v_exp_f32 v68, v68
    v_exp_f32 v69, v69
    v_exp_f32 v70, v70
    v_exp_f32 v71, v71
    v_exp_f32 v72, v72
    v_exp_f32 v73, v73
    v_exp_f32 v74, v74
    v_exp_f32 v75, v75
    s_nop 0
    v_cvt_pk_bf16_f32 v44, v60, v61
    v_cvt_pk_bf16_f32 v45, v62, v63
    v_cvt_pk_bf16_f32 v46, v64, v65
    v_cvt_pk_bf16_f32 v47, v66, v67
    v_cvt_pk_bf16_f32 v48, v68, v69
    v_cvt_pk_bf16_f32 v49, v70, v71
    v_cvt_pk_bf16_f32 v50, v72, v73
    v_cvt_pk_bf16_f32 v51, v74, v75
    s_nop 1
    v_mfma_f32_32x32x16_bf16 v[124:139], v[36:39], v[44:47], v[124:139]
    v_mfma_f32_32x32x16_bf16 v[124:139], v[40:43], v[48:51], v[124:139]
    s_add_u32 s52, s52, 1
    s_cmp_lg_u32 s52, 64
    s_cbranch_scc1 L_p2_sl
    s_nop 15
    s_nop 7
L_p2_fin:
    v_rcp_f32 v10, v134
    v_and_b32 v11, 15, v1
    v_bfe_u32 v9, v1, 4, 1
    v_mul_u32_u24 v9, 18432, v9
    v_lshl_add_u32 v9, v11, 4, v9
    v_pk_mul_f32 v[124:125], v[124:125], v[10:11] op_sel_hi:[1,0]
    v_pk_mul_f32 v[126:127], v[126:127], v[10:11] op_sel_hi:[1,0]
    v_pk_mul_f32 v[128:129], v[128:129], v[10:11] op_sel_hi:[1,0]
    v_pk_mul_f32 v[130:131], v[130:131], v[10:11] op_sel_hi:[1,0]
    v_pk_mul_f32 v[132:133], v[132:133], v[10:11] op_sel_hi:[1,0]
    v_lshl_add_u32 v8, v8, 8, v9
    v_cvt_pk_bf16_f32 v44, v124, v125
    v_cvt_pk_bf16_f32 v45, v126, v127
    v_cvt_pk_bf16_f32 v46, v128, v129
    v_cvt_pk_bf16_f32 v47, v130, v131
    v_cvt_pk_bf16_f32 v48, v132, v133
    buffer_store_dwordx4 v[44:47], v8, s[28:31], s50 offen sc1
    s_mov_b32 exec_hi, 0
    buffer_store_dword v48, v9, s[28:31], s51 offen sc1
    s_mov_b32 exec_hi, -1
    s_cmp_ge_u32 s20, 4
    s_cselect_b32 s10, s2, 255
    s_cmp_lt_u32 s10, 144
    s_cbranch_scc0 L_p2_wo
    s_waitcnt vmcnt(2)
    s_and_b32 s11, s19, 1
    s_mul_i32 s42, s11, 36864
    s_add_u32 s42, s42, 73728
    s_lshl_b32 s11, s11, 15
    s_cmp_lt_u32 s19, 2
    s_cselect_b32 s42, s42, s11
    s_and_b32 s16, s19, 1
    s_lshr_b32 s17, s19, 1
    s_lshl_b32 s10, s2, 1
    s_add_u32 s10, s10, s16
    s_cmp_lt_u32 s10, 144
    s_cselect_b32 s11, 9, 0
    s_cselect_b32 s12, 0, 144
    s_sub_u32 s10, s10, s12
    s_mul_i32 s12, s10, 7282
    s_lshr_b32 s12, s12, 16
    s_mul_i32 s13, s12, 9
    s_sub_u32 s10, s10, s13
    s_add_u32 s10, s10, s11
    s_mul_i32 s13, s12, 18
    s_add_u32 s13, s13, s10
    s_lshl_b32 s40, s13, 6
    s_mul_i32 s12, s12, 331776
    s_lshl_b32 s10, s10, 11
    s_add_u32 s41, s12, s10
    s_mul_i32 s10, s17, 147456
    s_add_u32 s41, s41, s10
    v_and_b32 v9, 15, v1
    v_lshrrev_b32 v8, 4, v1
    v_lshlrev_b32 v10, 4, v9
    v_lshl_add_u32 v10, v8, 8, v10
    s_lshl_b32 s10, s17, 10
    v_add_u32 v16, s10, v10
    s_xor_b32 s10, s10, 1024
    v_add_u32 v17, s10, v10
    v_lshrrev_b32 v3, 2, v9
    v_lshlrev_b32 v4, 5, v3
    v_lshl_add_u32 v4, v8, 8, v4
    v_and_b32 v5, 3, v1
    v_lshl_add_u32 v4, v5, 3, v4
    v_add_u32 v4, s42, v4
    s_add_u32 s10, s42, 9216
    v_lshl_add_u32 v5, v8, 5, s10
    s_lshl_b32 s10, s19, 8
    s_add_u32 s10, s10, 162752
    v_lshl_add_u32 v6, v9, 3, s10
    s_xor_b32 s11, s19, 2
    s_lshl_b32 s10, s11, 8
    s_add_u32 s10, s10, 162752
    v_lshl_add_u32 v7, v9, 3, s10
    s_add_u32 s24, s92, 33878016
    s_addc_u32 s25, s93, 0
    s_mov_b32 s26, 5308416
    s_mov_b32 s27, 0x20000
    s_add_u32 s28, s92, 24576
    s_addc_u32 s29, s93, 0
    s_mov_b32 s30, 18432
    s_mov_b32 s31, 0x20000
    ds_read_b64_tr_b16 v[92:93], v4 offset:0
    ds_read_b64_tr_b16 v[94:95], v4 offset:128
    ds_read_b128 v[100:103], v5 offset:1152
    ds_read_b128 v[104:107], v5 offset:1168
    ds_read_b128 v[108:111], v5 offset:0
    ds_read_b128 v[112:115], v5 offset:16
    ds_read_b64_tr_b16 v[96:97], v4 offset:1024
    ds_read_b64_tr_b16 v[98:99], v4 offset:1152
    ds_read_b128 v[116:119], v5 offset:1280
    ds_read_b128 v[120:123], v5 offset:1296
    ds_read_b128 v[124:127], v5 offset:128
    ds_read_b128 v[128:131], v5 offset:144
    s_waitcnt lgkmcnt(6)
    v_lshlrev_b32 v148, 16, v92
    v_and_b32 v149, 0xffff0000, v92
    v_lshlrev_b32 v150, 16, v93
    v_and_b32 v151, 0xffff0000, v93
    v_lshlrev_b32 v152, 16, v94
    v_and_b32 v153, 0xffff0000, v94
    v_lshlrev_b32 v154, 16, v95
    v_and_b32 v155, 0xffff0000, v95
    v_pk_mul_f32 v[20:21], v[148:149], v[100:101]
    v_pk_mul_f32 v[22:23], v[150:151], v[102:103]
    v_pk_mul_f32 v[24:25], v[152:153], v[104:105]
    v_pk_mul_f32 v[26:27], v[154:155], v[106:107]
    v_pk_mul_f32 v[140:141], v[148:149], v[108:109]
    v_pk_mul_f32 v[142:143], v[150:151], v[110:111]
    v_pk_mul_f32 v[144:145], v[152:153], v[112:113]
    v_pk_mul_f32 v[146:147], v[154:155], v[114:115]
    ds_read_b64_tr_b16 v[92:93], v4 offset:2048
    ds_read_b64_tr_b16 v[94:95], v4 offset:2176
    ds_read_b128 v[100:103], v5 offset:1408
    ds_read_b128 v[104:107], v5 offset:1424
    ds_read_b128 v[108:111], v5 offset:256
    ds_read_b128 v[112:115], v5 offset:272
    s_waitcnt lgkmcnt(6)
    v_lshlrev_b32 v148, 16, v96
    v_and_b32 v149, 0xffff0000, v96
    v_lshlrev_b32 v150, 16, v97
    v_and_b32 v151, 0xffff0000, v97
    v_lshlrev_b32 v152, 16, v98
    v_and_b32 v153, 0xffff0000, v98
    v_lshlrev_b32 v154, 16, v99
    v_and_b32 v155, 0xffff0000, v99
    v_pk_mul_f32 v[28:29], v[148:149], v[116:117]
    v_pk_mul_f32 v[30:31], v[150:151], v[118:119]
    v_pk_mul_f32 v[32:33], v[152:153], v[120:121]
    v_pk_mul_f32 v[34:35], v[154:155], v[122:123]
    v_pk_fma_f32 v[140:141], v[148:149], v[124:125], v[140:141]
    v_pk_fma_f32 v[142:143], v[150:151], v[126:127], v[142:143]
    v_pk_fma_f32 v[144:145], v[152:153], v[128:129], v[144:145]
    v_pk_fma_f32 v[146:147], v[154:155], v[130:131], v[146:147]
    v_pk_add_f32 v[132:133], v[20:21], v[28:29]
    v_pk_add_f32 v[134:135], v[22:23], v[30:31]
    v_pk_add_f32 v[136:137], v[24:25], v[32:33]
    v_pk_add_f32 v[138:139], v[26:27], v[34:35]
    s_waitcnt vmcnt(0)
    v_mov_b32 v2, 163784
    v_mov_b32 v3, 1
    s_mov_b64 exec, 1
    ds_add_rtn_u32 v3, v2, v3
    s_mov_b64 exec, -1
    s_waitcnt lgkmcnt(0)
    v_readfirstlane_b32 s10, v3
    s_cmp_eq_u32 s10, 7
    s_cbranch_scc0 L_m_ns40
    s_lshl_b32 s10, s2, 7
    s_add_u32 s10, s10, 131072
    v_mov_b32 v2, s3
    v_mov_b32 v3, 0
    s_mov_b64 exec, 1
    buffer_store_dword v2, v3, s[96:99], s10 offen sc1
    s_mov_b64 exec, -1
L_m_ns40:
    ds_read_b64_tr_b16 v[96:97], v4 offset:3072
    ds_read_b64_tr_b16 v[98:99], v4 offset:3200
    ds_read_b128 v[116:119], v5 offset:1536
    ds_read_b128 v[120:123], v5 offset:1552
    ds_read_b128 v[124:127], v5 offset:384
    ds_read_b128 v[128:131], v5 offset:400
    s_waitcnt lgkmcnt(6)
    v_lshlrev_b32 v148, 16, v92
    v_and_b32 v149, 0xffff0000, v92
    v_lshlrev_b32 v150, 16, v93
    v_and_b32 v151, 0xffff0000, v93
    v_lshlrev_b32 v152, 16, v94
    v_and_b32 v153, 0xffff0000, v94
    v_lshlrev_b32 v154, 16, v95
    v_and_b32 v155, 0xffff0000, v95
    v_pk_mul_f32 v[36:37], v[148:149], v[100:101]
    v_pk_mul_f32 v[38:39], v[150:151], v[102:103]
    v_pk_mul_f32 v[40:41], v[152:153], v[104:105]
    v_pk_mul_f32 v[42:43], v[154:155], v[106:107]
    v_pk_fma_f32 v[140:141], v[148:149], v[108:109], v[140:141]
    v_pk_fma_f32 v[142:143], v[150:151], v[110:111], v[142:143]
    v_pk_fma_f32 v[144:145], v[152:153], v[112:113], v[144:145]
    v_pk_fma_f32 v[146:147], v[154:155], v[114:115], v[146:147]
    v_pk_add_f32 v[132:133], v[132:133], v[36:37]
    v_pk_add_f32 v[134:135], v[134:135], v[38:39]
    v_pk_add_f32 v[136:137], v[136:137], v[40:41]
    v_pk_add_f32 v[138:139], v[138:139], v[42:43]
    ds_read_b64_tr_b16 v[92:93], v4 offset:4096
    ds_read_b64_tr_b16 v[94:95], v4 offset:4224
    ds_read_b128 v[100:103], v5 offset:1664
    ds_read_b128 v[104:107], v5 offset:1680
    ds_read_b128 v[108:111], v5 offset:512
    ds_read_b128 v[112:115], v5 offset:528
    s_waitcnt lgkmcnt(6)
    v_lshlrev_b32 v148, 16, v96
    v_and_b32 v149, 0xffff0000, v96
    v_lshlrev_b32 v150, 16, v97
    v_and_b32 v151, 0xffff0000, v97
    v_lshlrev_b32 v152, 16, v98
    v_and_b32 v153, 0xffff0000, v98
    v_lshlrev_b32 v154, 16, v99
    v_and_b32 v155, 0xffff0000, v99
    v_pk_mul_f32 v[44:45], v[148:149], v[116:117]
    v_pk_mul_f32 v[46:47], v[150:151], v[118:119]
    v_pk_mul_f32 v[48:49], v[152:153], v[120:121]
    v_pk_mul_f32 v[50:51], v[154:155], v[122:123]
    v_pk_fma_f32 v[140:141], v[148:149], v[124:125], v[140:141]
    v_pk_fma_f32 v[142:143], v[150:151], v[126:127], v[142:143]
    v_pk_fma_f32 v[144:145], v[152:153], v[128:129], v[144:145]
    v_pk_fma_f32 v[146:147], v[154:155], v[130:131], v[146:147]
    v_pk_add_f32 v[132:133], v[132:133], v[44:45]
    v_pk_add_f32 v[134:135], v[134:135], v[46:47]
    v_pk_add_f32 v[136:137], v[136:137], v[48:49]
    v_pk_add_f32 v[138:139], v[138:139], v[50:51]
    ds_read_b64_tr_b16 v[96:97], v4 offset:5120
    ds_read_b64_tr_b16 v[98:99], v4 offset:5248
    ds_read_b128 v[116:119], v5 offset:1792
    ds_read_b128 v[120:123], v5 offset:1808
    ds_read_b128 v[124:127], v5 offset:640
    ds_read_b128 v[128:131], v5 offset:656
    s_waitcnt lgkmcnt(6)
    v_lshlrev_b32 v148, 16, v92
    v_and_b32 v149, 0xffff0000, v92
    v_lshlrev_b32 v150, 16, v93
    v_and_b32 v151, 0xffff0000, v93
    v_lshlrev_b32 v152, 16, v94
    v_and_b32 v153, 0xffff0000, v94
    v_lshlrev_b32 v154, 16, v95
    v_and_b32 v155, 0xffff0000, v95
    v_pk_mul_f32 v[52:53], v[148:149], v[100:101]
    v_pk_mul_f32 v[54:55], v[150:151], v[102:103]
    v_pk_mul_f32 v[56:57], v[152:153], v[104:105]
    v_pk_mul_f32 v[58:59], v[154:155], v[106:107]
    v_pk_fma_f32 v[140:141], v[148:149], v[108:109], v[140:141]
    v_pk_fma_f32 v[142:143], v[150:151], v[110:111], v[142:143]
    v_pk_fma_f32 v[144:145], v[152:153], v[112:113], v[144:145]
    v_pk_fma_f32 v[146:147], v[154:155], v[114:115], v[146:147]
    v_pk_add_f32 v[132:133], v[132:133], v[52:53]
    v_pk_add_f32 v[134:135], v[134:135], v[54:55]
    v_pk_add_f32 v[136:137], v[136:137], v[56:57]
    v_pk_add_f32 v[138:139], v[138:139], v[58:59]
    ds_read_b64_tr_b16 v[92:93], v4 offset:6144
    ds_read_b64_tr_b16 v[94:95], v4 offset:6272
    ds_read_b128 v[100:103], v5 offset:1920
    ds_read_b128 v[104:107], v5 offset:1936
    ds_read_b128 v[108:111], v5 offset:768
    ds_read_b128 v[112:115], v5 offset:784
    s_waitcnt lgkmcnt(6)
    v_lshlrev_b32 v148, 16, v96
    v_and_b32 v149, 0xffff0000, v96
    v_lshlrev_b32 v150, 16, v97
    v_and_b32 v151, 0xffff0000, v97
    v_lshlrev_b32 v152, 16, v98
    v_and_b32 v153, 0xffff0000, v98
    v_lshlrev_b32 v154, 16, v99
    v_and_b32 v155, 0xffff0000, v99
    v_pk_mul_f32 v[60:61], v[148:149], v[116:117]
    v_pk_mul_f32 v[62:63], v[150:151], v[118:119]
    v_pk_mul_f32 v[64:65], v[152:153], v[120:121]
    v_pk_mul_f32 v[66:67], v[154:155], v[122:123]
    v_pk_fma_f32 v[140:141], v[148:149], v[124:125], v[140:141]
    v_pk_fma_f32 v[142:143], v[150:151], v[126:127], v[142:143]
    v_pk_fma_f32 v[144:145], v[152:153], v[128:129], v[144:145]
    v_pk_fma_f32 v[146:147], v[154:155], v[130:131], v[146:147]
    v_pk_add_f32 v[132:133], v[132:133], v[60:61]
    v_pk_add_f32 v[134:135], v[134:135], v[62:63]
    v_pk_add_f32 v[136:137], v[136:137], v[64:65]
    v_pk_add_f32 v[138:139], v[138:139], v[66:67]
    ds_read_b64_tr_b16 v[96:97], v4 offset:7168
    ds_read_b64_tr_b16 v[98:99], v4 offset:7296
    ds_read_b128 v[116:119], v5 offset:2048
    ds_read_b128 v[120:123], v5 offset:2064
    ds_read_b128 v[124:127], v5 offset:896
    ds_read_b128 v[128:131], v5 offset:912
    s_waitcnt lgkmcnt(6)
    v_lshlrev_b32 v148, 16, v92
    v_and_b32 v149, 0xffff0000, v92
    v_lshlrev_b32 v150, 16, v93
    v_and_b32 v151, 0xffff0000, v93
    v_lshlrev_b32 v152, 16, v94
    v_and_b32 v153, 0xffff0000, v94
    v_lshlrev_b32 v154, 16, v95
    v_and_b32 v155, 0xffff0000, v95
    v_pk_mul_f32 v[68:69], v[148:149], v[100:101]
    v_pk_mul_f32 v[70:71], v[150:151], v[102:103]
    v_pk_mul_f32 v[72:73], v[152:153], v[104:105]
    v_pk_mul_f32 v[74:75], v[154:155], v[106:107]
    v_pk_fma_f32 v[140:141], v[148:149], v[108:109], v[140:141]
    v_pk_fma_f32 v[142:143], v[150:151], v[110:111], v[142:143]
    v_pk_fma_f32 v[144:145], v[152:153], v[112:113], v[144:145]
    v_pk_fma_f32 v[146:147], v[154:155], v[114:115], v[146:147]
    v_pk_add_f32 v[132:133], v[132:133], v[68:69]
    v_pk_add_f32 v[134:135], v[134:135], v[70:71]
    v_pk_add_f32 v[136:137], v[136:137], v[72:73]
    v_pk_add_f32 v[138:139], v[138:139], v[74:75]
    ds_read_b64_tr_b16 v[92:93], v4 offset:8192
    ds_read_b64_tr_b16 v[94:95], v4 offset:8320
    ds_read_b128 v[100:103], v5 offset:2176
    ds_read_b128 v[104:107], v5 offset:2192
    ds_read_b128 v[108:111], v5 offset:1024
    ds_read_b128 v[112:115], v5 offset:1040
    s_waitcnt lgkmcnt(6)
    v_lshlrev_b32 v148, 16, v96
    v_and_b32 v149, 0xffff0000, v96
    v_lshlrev_b32 v150, 16, v97
    v_and_b32 v151, 0xffff0000, v97
    v_lshlrev_b32 v152, 16, v98
    v_and_b32 v153, 0xffff0000, v98
    v_lshlrev_b32 v154, 16, v99
    v_and_b32 v155, 0xffff0000, v99
    v_pk_mul_f32 v[76:77], v[148:149], v[116:117]
    v_pk_mul_f32 v[78:79], v[150:151], v[118:119]
    v_pk_mul_f32 v[80:81], v[152:153], v[120:121]
    v_pk_mul_f32 v[82:83], v[154:155], v[122:123]
    v_pk_fma_f32 v[140:141], v[148:149], v[124:125], v[140:141]
    v_pk_fma_f32 v[142:143], v[150:151], v[126:127], v[142:143]
    v_pk_fma_f32 v[144:145], v[152:153], v[128:129], v[144:145]
    v_pk_fma_f32 v[146:147], v[154:155], v[130:131], v[146:147]
    v_pk_add_f32 v[132:133], v[132:133], v[76:77]
    v_pk_add_f32 v[134:135], v[134:135], v[78:79]
    v_pk_add_f32 v[136:137], v[136:137], v[80:81]
    v_pk_add_f32 v[138:139], v[138:139], v[82:83]
    s_waitcnt lgkmcnt(0)
    v_lshlrev_b32 v148, 16, v92
    v_and_b32 v149, 0xffff0000, v92
    v_lshlrev_b32 v150, 16, v93
    v_and_b32 v151, 0xffff0000, v93
    v_lshlrev_b32 v152, 16, v94
    v_and_b32 v153, 0xffff0000, v94
    v_lshlrev_b32 v154, 16, v95
    v_and_b32 v155, 0xffff0000, v95
    v_pk_mul_f32 v[84:85], v[148:149], v[100:101]
    v_pk_mul_f32 v[86:87], v[150:151], v[102:103]
    v_pk_mul_f32 v[88:89], v[152:153], v[104:105]
    v_pk_mul_f32 v[90:91], v[154:155], v[106:107]
    v_pk_fma_f32 v[140:141], v[148:149], v[108:109], v[140:141]
    v_pk_fma_f32 v[142:143], v[150:151], v[110:111], v[142:143]
    v_pk_fma_f32 v[144:145], v[152:153], v[112:113], v[144:145]
    v_pk_fma_f32 v[146:147], v[154:155], v[114:115], v[146:147]
    v_pk_add_f32 v[132:133], v[132:133], v[84:85]
    v_pk_add_f32 v[134:135], v[134:135], v[86:87]
    v_pk_add_f32 v[136:137], v[136:137], v[88:89]
    v_pk_add_f32 v[138:139], v[138:139], v[90:91]
    v_pk_add_f32 v[132:133], v[132:133], v[134:135]
    v_pk_add_f32 v[136:137], v[136:137], v[138:139]
    v_pk_add_f32 v[140:141], v[140:141], v[142:143]
    v_pk_add_f32 v[144:145], v[144:145], v[146:147]
    v_pk_add_f32 v[132:133], v[132:133], v[136:137]
    v_pk_add_f32 v[140:141], v[140:141], v[144:145]
    v_add_f32 v132, v132, v133
    v_add_f32 v133, v140, v141
    v_mov_b32 v140, v132
    v_mov_b32 v141, v133
    s_nop 1
    v_permlane16_swap_b32 v132, v140
    v_permlane16_swap_b32 v133, v141
    v_pk_add_f32 v[132:133], v[132:133], v[140:141]
    v_mov_b32 v140, v132
    v_mov_b32 v141, v133
    s_nop 1
    v_permlane32_swap_b32 v132, v140
    v_permlane32_swap_b32 v133, v141
    v_pk_add_f32 v[132:133], v[132:133], v[140:141]
    v_cmp_eq_u32 vcc, -1, v132
    s_mov_b32 s11, 131072
    v_lshlrev_b32 v9, 2, v9
    v_cndmask_b32 v132, v132, -2, vcc
    ds_write_b64 v6, v[132:133]
L_p1_x:
    ds_read_b64 v[140:141], v7
    s_sub_u32 s11, s11, 1
    s_waitcnt lgkmcnt(0)
    v_cmp_eq_u32 vcc, -1, v140
    s_cmp_eq_u32 s11, 0
    s_cbranch_scc1 L_p1_xe
    s_nop 1
    s_cbranch_vccnz L_p1_x
L_p1_xe:
    v_pk_add_f32 v[132:133], v[132:133], v[140:141]
    v_mul_f32 v140, 3135475257, v132
    s_mov_b64 exec, 0xffff
    buffer_store_dword v133, v9, s[28:31], s40 offen sc1
    s_mov_b64 exec, -1
    v_pk_add_f32 v[20:21], v[20:21], v[140:141] op_sel_hi:[1,0]
    v_pk_add_f32 v[22:23], v[22:23], v[140:141] op_sel_hi:[1,0]
    v_pk_add_f32 v[24:25], v[24:25], v[140:141] op_sel_hi:[1,0]
    v_pk_add_f32 v[26:27], v[26:27], v[140:141] op_sel_hi:[1,0]
    v_cvt_pk_bf16_f32 v20, v20, v21
    v_cvt_pk_bf16_f32 v21, v22, v23
    v_cvt_pk_bf16_f32 v22, v24, v25
    v_cvt_pk_bf16_f32 v23, v26, v27
    buffer_store_dwordx4 v[20:23], v16, s[24:27], s41 offen sc1
    s_xor_b32 s10, s17, 0
    s_mul_i32 s10, s10, 36864
    s_add_u32 s41, s41, s10
    v_pk_add_f32 v[28:29], v[28:29], v[140:141] op_sel_hi:[1,0]
    v_pk_add_f32 v[30:31], v[30:31], v[140:141] op_sel_hi:[1,0]
    v_pk_add_f32 v[32:33], v[32:33], v[140:141] op_sel_hi:[1,0]
    v_pk_add_f32 v[34:35], v[34:35], v[140:141] op_sel_hi:[1,0]
    v_cvt_pk_bf16_f32 v28, v28, v29
    v_cvt_pk_bf16_f32 v29, v30, v31
    v_cvt_pk_bf16_f32 v30, v32, v33
    v_cvt_pk_bf16_f32 v31, v34, v35
    buffer_store_dwordx4 v[28:31], v17, s[24:27], s41 offen sc1
    s_xor_b32 s10, s17, 1
    s_mul_i32 s10, s10, 36864
    s_add_u32 s41, s41, s10
    v_pk_add_f32 v[36:37], v[36:37], v[140:141] op_sel_hi:[1,0]
    v_pk_add_f32 v[38:39], v[38:39], v[140:141] op_sel_hi:[1,0]
    v_pk_add_f32 v[40:41], v[40:41], v[140:141] op_sel_hi:[1,0]
    v_pk_add_f32 v[42:43], v[42:43], v[140:141] op_sel_hi:[1,0]
    v_cvt_pk_bf16_f32 v36, v36, v37
    v_cvt_pk_bf16_f32 v37, v38, v39
    v_cvt_pk_bf16_f32 v38, v40, v41
    v_cvt_pk_bf16_f32 v39, v42, v43
    buffer_store_dwordx4 v[36:39], v16, s[24:27], s41 offen sc1
    s_xor_b32 s10, s17, 0
    s_mul_i32 s10, s10, 36864
    s_add_u32 s41, s41, s10
    v_pk_add_f32 v[44:45], v[44:45], v[140:141] op_sel_hi:[1,0]
    v_pk_add_f32 v[46:47], v[46:47], v[140:141] op_sel_hi:[1,0]
    v_pk_add_f32 v[48:49], v[48:49], v[140:141] op_sel_hi:[1,0]
    v_pk_add_f32 v[50:51], v[50:51], v[140:141] op_sel_hi:[1,0]
    v_cvt_pk_bf16_f32 v44, v44, v45
    v_cvt_pk_bf16_f32 v45, v46, v47
    v_cvt_pk_bf16_f32 v46, v48, v49
    v_cvt_pk_bf16_f32 v47, v50, v51
    buffer_store_dwordx4 v[44:47], v17, s[24:27], s41 offen sc1
    s_xor_b32 s10, s17, 1
    s_mul_i32 s10, s10, 36864
    s_add_u32 s41, s41, s10
    v_pk_add_f32 v[52:53], v[52:53], v[140:141] op_sel_hi:[1,0]
    v_pk_add_f32 v[54:55], v[54:55], v[140:141] op_sel_hi:[1,0]
    v_pk_add_f32 v[56:57], v[56:57], v[140:141] op_sel_hi:[1,0]
    v_pk_add_f32 v[58:59], v[58:59], v[140:141] op_sel_hi:[1,0]
    v_cvt_pk_bf16_f32 v52, v52, v53
    v_cvt_pk_bf16_f32 v53, v54, v55
    v_cvt_pk_bf16_f32 v54, v56, v57
    v_cvt_pk_bf16_f32 v55, v58, v59
    buffer_store_dwordx4 v[52:55], v16, s[24:27], s41 offen sc1
    s_xor_b32 s10, s17, 0
    s_mul_i32 s10, s10, 36864
    s_add_u32 s41, s41, s10
    v_pk_add_f32 v[60:61], v[60:61], v[140:141] op_sel_hi:[1,0]
    v_pk_add_f32 v[62:63], v[62:63], v[140:141] op_sel_hi:[1,0]
    v_pk_add_f32 v[64:65], v[64:65], v[140:141] op_sel_hi:[1,0]
    v_pk_add_f32 v[66:67], v[66:67], v[140:141] op_sel_hi:[1,0]
    v_cvt_pk_bf16_f32 v60, v60, v61
    v_cvt_pk_bf16_f32 v61, v62, v63
    v_cvt_pk_bf16_f32 v62, v64, v65
    v_cvt_pk_bf16_f32 v63, v66, v67
    buffer_store_dwordx4 v[60:63], v17, s[24:27], s41 offen sc1
    s_xor_b32 s10, s17, 1
    s_mul_i32 s10, s10, 36864
    s_add_u32 s41, s41, s10
    v_pk_add_f32 v[68:69], v[68:69], v[140:141] op_sel_hi:[1,0]
    v_pk_add_f32 v[70:71], v[70:71], v[140:141] op_sel_hi:[1,0]
    v_pk_add_f32 v[72:73], v[72:73], v[140:141] op_sel_hi:[1,0]
    v_pk_add_f32 v[74:75], v[74:75], v[140:141] op_sel_hi:[1,0]
    v_cvt_pk_bf16_f32 v68, v68, v69
    v_cvt_pk_bf16_f32 v69, v70, v71
    v_cvt_pk_bf16_f32 v70, v72, v73
    v_cvt_pk_bf16_f32 v71, v74, v75
    buffer_store_dwordx4 v[68:71], v16, s[24:27], s41 offen sc1
    s_xor_b32 s10, s17, 0
    s_mul_i32 s10, s10, 36864
    s_add_u32 s41, s41, s10
    v_pk_add_f32 v[76:77], v[76:77], v[140:141] op_sel_hi:[1,0]
    v_pk_add_f32 v[78:79], v[78:79], v[140:141] op_sel_hi:[1,0]
    v_pk_add_f32 v[80:81], v[80:81], v[140:141] op_sel_hi:[1,0]
    v_pk_add_f32 v[82:83], v[82:83], v[140:141] op_sel_hi:[1,0]
    v_cvt_pk_bf16_f32 v76, v76, v77
    v_cvt_pk_bf16_f32 v77, v78, v79
    v_cvt_pk_bf16_f32 v78, v80, v81
    v_cvt_pk_bf16_f32 v79, v82, v83
    buffer_store_dwordx4 v[76:79], v17, s[24:27], s41 offen sc1
    s_xor_b32 s10, s17, 1
    s_mul_i32 s10, s10, 36864
    s_add_u32 s41, s41, s10
    v_pk_add_f32 v[84:85], v[84:85], v[140:141] op_sel_hi:[1,0]
    v_pk_add_f32 v[86:87], v[86:87], v[140:141] op_sel_hi:[1,0]
    v_pk_add_f32 v[88:89], v[88:89], v[140:141] op_sel_hi:[1,0]
    v_pk_add_f32 v[90:91], v[90:91], v[140:141] op_sel_hi:[1,0]
    v_cvt_pk_bf16_f32 v84, v84, v85
    v_cvt_pk_bf16_f32 v85, v86, v87
    v_cvt_pk_bf16_f32 v86, v88, v89
    v_cvt_pk_bf16_f32 v87, v90, v91
    buffer_store_dwordx4 v[84:87], v16, s[24:27], s41 offen sc1
    s_xor_b32 s10, s17, 0
    s_mul_i32 s10, s10, 36864
    s_add_u32 s41, s41, s10
    s_branch L_p2_end
L_p2_wo:
    s_cmp_lt_u32 s10, 216
    s_cbranch_scc0 L_p2_nj
    s_waitcnt vmcnt(2)
    s_and_b32 s11, s19, 1
    s_mul_i32 s42, s11, 36864
    s_add_u32 s42, s42, 73728
    s_lshl_b32 s11, s11, 15
    s_cmp_lt_u32 s19, 2
    s_cselect_b32 s42, s42, s11
    v_and_b32 v9, 15, v1
    v_lshrrev_b32 v8, 4, v1
    v_lshrrev_b32 v3, 2, v9
    v_lshlrev_b32 v4, 5, v3
    v_lshl_add_u32 v4, v8, 8, v4
    v_and_b32 v5, 3, v1
    v_lshl_add_u32 v4, v5, 3, v4
    v_add_u32 v4, s42, v4
    ds_read_b64_tr_b16 v[20:21], v4 offset:0
    ds_read_b64_tr_b16 v[22:23], v4 offset:128
    ds_read_b64_tr_b16 v[24:25], v4 offset:1024
    ds_read_b64_tr_b16 v[26:27], v4 offset:1152
    ds_read_b64_tr_b16 v[28:29], v4 offset:2048
    ds_read_b64_tr_b16 v[30:31], v4 offset:2176
    ds_read_b64_tr_b16 v[32:33], v4 offset:3072
    ds_read_b64_tr_b16 v[34:35], v4 offset:3200
    ds_read_b64_tr_b16 v[36:37], v4 offset:4096
    ds_read_b64_tr_b16 v[38:39], v4 offset:4224
    ds_read_b64_tr_b16 v[40:41], v4 offset:5120
    ds_read_b64_tr_b16 v[42:43], v4 offset:5248
    ds_read_b64_tr_b16 v[44:45], v4 offset:6144
    ds_read_b64_tr_b16 v[46:47], v4 offset:6272
    s_sub_u32 s10, s2, 144
    s_and_b32 s22, s10, 7
    s_lshr_b32 s10, s10, 3
    s_lshl_b32 s10, s10, 2
    s_add_u32 s10, s10, s19
    s_lshl_b32 s10, s10, 4
    v_add_u32 v10, s10, v9
    s_mov_b32 s13, 331776
    v_mul_u32_u24 v11, 911, v10
    v_lshrrev_b32 v11, 16, v11
    v_mul_u32_u24 v12, 72, v11
    v_sub_u32 v12, v10, v12
    v_cmp_gt_u32 vcc, 64, v12
    v_lshrrev_b32 v13, 4, v12
    v_and_b32 v14, 15, v12
    v_lshl_add_u32 v13, v13, 7, v14
    v_lshlrev_b32 v16, 4, v13
    v_mad_u32_u24 v16, v11, s13, v16
    v_mov_b32 v17, 128
    v_mov_b32 v14, 256
    v_cndmask_b32 v17, v17, v14, vcc
    v_mad_u32_u24 v16, v8, v17, v16
    v_lshlrev_b32 v17, 2, v17
    s_and_b32 s12, s22, 1
    v_mul_u32_u24 v18, s12, v17
    v_sub_u32 v17, v17, v18
    v_add_u32 v17, v16, v17
    v_add_u32 v16, v16, v18
    s_mul_i32 s14, s22, 9
    s_waitcnt lgkmcnt(10)
    ds_read_b64_tr_b16 v[48:49], v4 offset:7168
    ds_read_b64_tr_b16 v[50:51], v4 offset:7296
    ds_read_b64_tr_b16 v[52:53], v4 offset:8192
    ds_read_b64_tr_b16 v[54:55], v4 offset:8320
    s_add_u32 s28, s92, 39186432
    s_addc_u32 s29, s93, 0
    s_mov_b32 s30, 2654208
    s_mov_b32 s31, 0x20000
    s_waitcnt vmcnt(0)
    v_mov_b32 v2, 163784
    v_mov_b32 v3, 1
    s_mov_b64 exec, 1
    ds_add_rtn_u32 v3, v2, v3
    s_mov_b64 exec, -1
    s_waitcnt lgkmcnt(0)
    v_readfirstlane_b32 s10, v3
    s_cmp_eq_u32 s10, 7
    s_cbranch_scc0 L_m_ns41
    s_lshl_b32 s10, s2, 7
    s_add_u32 s10, s10, 131072
    v_mov_b32 v2, s3
    v_mov_b32 v3, 0
    s_mov_b64 exec, 1
    buffer_store_dword v2, v3, s[96:99], s10 offen sc1
    s_mov_b64 exec, -1
L_m_ns41:
    s_lshr_b32 s10, s14, 1
    s_mul_i32 s10, s10, 9216
    s_add_u32 s14, s14, 1
    buffer_store_dwordx4 v[20:23], v16, s[28:31], s10 offen sc1
    s_lshr_b32 s10, s14, 1
    s_mul_i32 s10, s10, 9216
    s_add_u32 s14, s14, 1
    buffer_store_dwordx4 v[24:27], v17, s[28:31], s10 offen sc1
    s_lshr_b32 s10, s14, 1
    s_mul_i32 s10, s10, 9216
    s_add_u32 s14, s14, 1
    buffer_store_dwordx4 v[28:31], v16, s[28:31], s10 offen sc1
    s_lshr_b32 s10, s14, 1
    s_mul_i32 s10, s10, 9216
    s_add_u32 s14, s14, 1
    buffer_store_dwordx4 v[32:35], v17, s[28:31], s10 offen sc1
    s_lshr_b32 s10, s14, 1
    s_mul_i32 s10, s10, 9216
    s_add_u32 s14, s14, 1
    buffer_store_dwordx4 v[36:39], v16, s[28:31], s10 offen sc1
    s_lshr_b32 s10, s14, 1
    s_mul_i32 s10, s10, 9216
    s_add_u32 s14, s14, 1
    buffer_store_dwordx4 v[40:43], v17, s[28:31], s10 offen sc1
    s_lshr_b32 s10, s14, 1
    s_mul_i32 s10, s10, 9216
    s_add_u32 s14, s14, 1
    buffer_store_dwordx4 v[44:47], v16, s[28:31], s10 offen sc1
    s_lshr_b32 s10, s14, 1
    s_mul_i32 s10, s10, 9216
    s_add_u32 s14, s14, 1
    buffer_store_dwordx4 v[48:51], v17, s[28:31], s10 offen sc1
    s_lshr_b32 s10, s14, 1
    s_mul_i32 s10, s10, 9216
    s_add_u32 s14, s14, 1
    buffer_store_dwordx4 v[52:55], v16, s[28:31], s10 offen sc1
    s_branch L_p2_end
L_p2_nj:
    s_waitcnt vmcnt(0)
    v_mov_b32 v2, 163784
    v_mov_b32 v3, 1
    s_mov_b64 exec, 1
    ds_add_rtn_u32 v3, v2, v3
    s_mov_b64 exec, -1
    s_waitcnt lgkmcnt(0)
    v_readfirstlane_b32 s10, v3
    s_cmp_eq_u32 s10, 7
    s_cbranch_scc0 L_m_ns42
    s_lshl_b32 s10, s2, 7
    s_add_u32 s10, s10, 131072
    v_mov_b32 v2, s3
    v_mov_b32 v3, 0
    s_mov_b64 exec, 1
    buffer_store_dword v2, v3, s[96:99], s10 offen sc1
    s_mov_b64 exec, -1
L_m_ns42:
L_p2_end:
L_ph3:
    s_and_b32 s10, s2, 56
    s_add_u32 s10, s10, s20
    s_cmp_eq_u32 s10, 3
    s_cbranch_scc0 L_ph3n
    v_lshlrev_b32 v250, 7, v1
    s_mov_b32 s10, L_ph3-adaLN_cond__softmax_full_mha__mixer_gmlp__prompt_kernel-0
    buffer_load_dword v251, v250, s[4:7], s10 offen
    s_add_u32 s10, s10, 8192
    buffer_load_dword v251, v250, s[4:7], s10 offen
    s_add_u32 s10, s10, 8192
    buffer_load_dword v251, v250, s[4:7], s10 offen
    s_add_u32 s10, s10, 8192
L_ph3n:
    s_and_b32 s10, s2, 7
    s_lshr_b32 s11, s2, 3
    s_lshl_b32 s10, s10, 2
    s_lshr_b32 s12, s11, 3
    s_add_u32 s21, s10, s12
    s_and_b32 s22, s11, 7
    s_lshl_b32 s12, s12, 1
    s_add_u32 s23, s22, s12
    s_mul_i32 s23, s23, 1
    s_and_b32 s19, s20, 3
    s_cmp_ge_u32 s20, 4
    s_cbranch_scc1 L_p3_cons
    s_mov_b32 s24, s68
    s_mov_b32 s25, s69
    s_mov_b32 s26, 2359296
    s_mov_b32 s27, 0x20000
    s_lshl_b32 s10, s21, 2
    s_add_u32 s10, s10, s19
    s_mul_i32 s10, s10, 18432
    s_mul_i32 s11, s22, 144
    s_add_u32 s10, s10, s11
    s_mul_i32 s11, s19, 2304
    s_add_u32 s11, s11, 142592
    v_add_u32 v20, 0, v1
    v_mul_u32_u24 v21, 7282, v20
    v_lshrrev_b32 v21, 16, v21
    v_mul_u32_u24 v23, 9, v21
    v_sub_u32 v22, v20, v23
    v_mul_u32_u24 v21, 1152, v21
    v_lshl_add_u32 v21, v22, 4, v21
    s_add_u32 m0, s11, 0
    s_nop 0
    buffer_load_dwordx4 v21, s[24:27], s10 offen lds
    v_add_u32 v20, 64, v1
    v_mul_u32_u24 v21, 7282, v20
    v_lshrrev_b32 v21, 16, v21
    v_mul_u32_u24 v23, 9, v21
    v_sub_u32 v22, v20, v23
    v_mul_u32_u24 v21, 1152, v21
    v_lshl_add_u32 v21, v22, 4, v21
    s_add_u32 m0, s11, 1024
    s_nop 0
    buffer_load_dwordx4 v21, s[24:27], s10 offen lds
    v_add_u32 v20, 128, v1
    v_mul_u32_u24 v21, 7282, v20
    v_lshrrev_b32 v21, 16, v21
    v_mul_u32_u24 v23, 9, v21
    v_sub_u32 v22, v20, v23
    v_mul_u32_u24 v21, 1152, v21
    v_lshl_add_u32 v21, v22, 4, v21
    s_add_u32 m0, s11, 2048
    s_mov_b64 exec, 0xffff
    s_nop 0
    buffer_load_dwordx4 v21, s[24:27], s10 offen lds
    s_mov_b64 exec, -1
    s_mul_i32 s10, s21, 73728
    s_mul_i32 s11, s22, 82944
    v_lshlrev_b32 v2, 4, v1
    s_mul_i32 s43, s19, 2048
    s_add_u32 s43, s43, 85248
    s_mul_i32 s41, s19, 4294966272
    s_add_u32 s41, s41, 8192
    v_add_u32 v3, s41, v2
    s_lshl_b32 s50, s19, 10
    s_add_u32 s50, s50, 52480
    s_mul_i32 s44, s19, 2048
    s_add_u32 s44, s44, 44288
    v_subrev_u32 v6, 9, v1
    v_min_u32 v6, v6, v1
    v_subrev_u32 v4, s23, v6
    v_add_u32 v4, 3, v4
    v_and_b32 v4, 7, v4
    v_cmp_gt_u32 vcc, 5, v4
    v_mov_b32 v5, 0
    s_nop 0
    v_cndmask_b32 v5, v5, -2, vcc
    v_cmp_gt_u32 vcc, 2, v4
    v_sub_u32 v4, v6, v4
    v_subrev_u32 v4, 0, v4
    v_cndmask_b32 v5, v5, 3, vcc
    v_cmp_ge_u32 vcc, 4, v4
    s_nop 1
    v_cndmask_b32 v5, 0, v5, vcc
    v_add_u32 v5, v5, v6
    v_cmp_le_u32 vcc, 9, v1
    v_mul_u32_u24 v6, 2048, v5
    v_mul_u32_u24 v7, 9216, v5
    s_mov_b32 s46, 0
    s_mov_b32 s47, 0
    s_mul_i32 s41, s19, 18432
    s_sub_u32 s26, 73728, s41
    s_add_u32 s41, s41, s10
    s_add_u32 s41, s41, 9601024
    s_add_u32 s24, s92, s41
    s_addc_u32 s25, s93, 0
    s_mov_b32 s27, 0x20000
    s_mul_i32 s41, s19, 2048
    s_sub_u32 s30, 82944, s41
    s_add_u32 s41, s41, s11
    s_add_u32 s41, s41, 33193984
    s_add_u32 s28, s92, s41
    s_addc_u32 s29, s93, 0
    s_mov_b32 s31, 0x20000
    v_readlane_b32 s46, v6, 0
    v_readlane_b32 s47, v7, 0
    s_nop 3
    s_add_u32 m0, s44, 0
    s_nop 0
    buffer_load_dwordx4 v2, s[28:31], s47 offen  lds
    buffer_load_dwordx4 v2, s[28:31], s47 offen offset:1024  lds
    s_add_u32 m0, s50, 0
    s_cmp_lt_u32 s19, 1
    s_cbranch_scc0 L_m_g43
    buffer_load_dwordx4 v3, s[28:31], s47 offen  lds
L_m_g43:
    v_readlane_b32 s47, v7, 1
    s_nop 3
    s_add_u32 m0, s44, 9216
    s_nop 0
    buffer_load_dwordx4 v2, s[28:31], s47 offen  lds
    buffer_load_dwordx4 v2, s[28:31], s47 offen offset:1024  lds
    s_add_u32 m0, s50, 9216
    s_cmp_lt_u32 s19, 1
    s_cbranch_scc0 L_m_g44
    buffer_load_dwordx4 v3, s[28:31], s47 offen  lds
L_m_g44:
    v_readlane_b32 s47, v7, 2
    s_nop 3
    s_add_u32 m0, s44, 18432
    s_nop 0
    buffer_load_dwordx4 v2, s[28:31], s47 offen  lds
    buffer_load_dwordx4 v2, s[28:31], s47 offen offset:1024  lds
    s_add_u32 m0, s50, 18432
    s_cmp_lt_u32 s19, 1
    s_cbranch_scc0 L_m_g45
    buffer_load_dwordx4 v3, s[28:31], s47 offen  lds
L_m_g45:
    v_readlane_b32 s47, v7, 3
    s_nop 3
    s_cmp_eq_u32 s19, 0
    s_cbranch_scc0 L_m_gw46
    s_lshr_b32 s10, s21, 2
    s_lshl_b32 s10, s10, 5
    v_and_b32 v20, 31, v1
    v_add_u32 v20, s10, v20
    v_lshlrev_b32 v20, 7, v20
    v_add_u32 v20, 131072, v20
    s_mov_b32 s11, 131072
L_m_pl48:
    buffer_load_dword v248, v20, s[96:99], 0 offen sc1
    s_waitcnt vmcnt(0)
    v_cmp_ne_u32 vcc, s3, v248
    s_sub_u32 s11, s11, 1
    s_cmp_eq_u32 s11, 0
    s_cbranch_scc1 L_m_pe49
    s_cbranch_vccnz L_m_pl48
L_m_pe49:
    v_mov_b32 v20, 163808
    v_mov_b32 v21, 1
    ds_write_b32 v20, v21
    s_branch L_m_gx47
L_m_gw46:
    v_mov_b32 v20, 163808
    s_mov_b32 s11, 131072
L_m_sp50:
    ds_read_b32 v21, v20
    s_sub_u32 s11, s11, 1
    s_waitcnt lgkmcnt(0)
    v_readfirstlane_b32 s10, v21
    s_cmp_eq_u32 s11, 0
    s_cbranch_scc1 L_m_se51
    s_cmp_eq_u32 s10, 1
    s_cbranch_scc0 L_m_sp50
L_m_se51:
L_m_gx47:
    s_add_u32 m0, s43, 0
    s_nop 0
    buffer_load_dwordx4 v2, s[24:27], s46 offen sc1 lds
    buffer_load_dwordx4 v2, s[24:27], s46 offen offset:1024 sc1 lds
    v_readlane_b32 s46, v6, 1
    s_nop 3
    s_add_u32 m0, s43, 8192
    s_nop 0
    buffer_load_dwordx4 v2, s[24:27], s46 offen sc1 lds
    buffer_load_dwordx4 v2, s[24:27], s46 offen offset:1024 sc1 lds
    v_readlane_b32 s46, v6, 2
    s_nop 3
    s_add_u32 m0, s43, 16384
    s_nop 0
    buffer_load_dwordx4 v2, s[24:27], s46 offen sc1 lds
    buffer_load_dwordx4 v2, s[24:27], s46 offen offset:1024 sc1 lds
    v_readlane_b32 s46, v6, 3
    s_nop 3
    s_mov_b32 s40, 4
    s_waitcnt vmcnt(4)
    s_barrier
    s_add_u32 m0, s43, 24576
    s_nop 0
    buffer_load_dwordx4 v2, s[24:27], s46 offen sc1 lds
    buffer_load_dwordx4 v2, s[24:27], s46 offen offset:1024 sc1 lds
    s_add_u32 m0, s44, 27648
    s_nop 0
    buffer_load_dwordx4 v2, s[28:31], s47 offen  lds
    buffer_load_dwordx4 v2, s[28:31], s47 offen offset:1024  lds
    s_add_u32 m0, s50, 27648
    s_cmp_lt_u32 s19, 1
    s_cbranch_scc0 L_m_g52
    buffer_load_dwordx4 v3, s[28:31], s47 offen  lds
L_m_g52:
    v_readlane_b32 s46, v6, s40
    v_readlane_b32 s47, v7, s40
    s_add_u32 s40, s40, 1
    s_nop 0
    s_waitcnt vmcnt(6)
    s_barrier
    s_add_u32 m0, s43, 0
    s_nop 0
    buffer_load_dwordx4 v2, s[24:27], s46 offen sc1 lds
    buffer_load_dwordx4 v2, s[24:27], s46 offen offset:1024 sc1 lds
    s_add_u32 m0, s44, 0
    s_nop 0
    buffer_load_dwordx4 v2, s[28:31], s47 offen  lds
    buffer_load_dwordx4 v2, s[28:31], s47 offen offset:1024  lds
    s_add_u32 m0, s50, 0
    s_cmp_lt_u32 s19, 1
    s_cbranch_scc0 L_m_g53
    buffer_load_dwordx4 v3, s[28:31], s47 offen  lds
L_m_g53:
    v_readlane_b32 s46, v6, s40
    v_readlane_b32 s47, v7, s40
    s_add_u32 s40, s40, 1
    s_nop 0
    s_waitcnt vmcnt(8)
    s_barrier
    s_add_u32 m0, s43, 8192
    s_nop 0
    buffer_load_dwordx4 v2, s[24:27], s46 offen sc1 lds
    buffer_load_dwordx4 v2, s[24:27], s46 offen offset:1024 sc1 lds
    s_add_u32 m0, s44, 9216
    s_nop 0
    buffer_load_dwordx4 v2, s[28:31], s47 offen  lds
    buffer_load_dwordx4 v2, s[28:31], s47 offen offset:1024  lds
    s_add_u32 m0, s50, 9216
    s_cmp_lt_u32 s19, 1
    s_cbranch_scc0 L_m_g54
    buffer_load_dwordx4 v3, s[28:31], s47 offen  lds
L_m_g54:
    v_readlane_b32 s46, v6, s40
    v_readlane_b32 s47, v7, s40
    s_add_u32 s40, s40, 1
    s_nop 0
    s_waitcnt vmcnt(8)
    s_barrier
    s_add_u32 m0, s43, 16384
    s_nop 0
    buffer_load_dwordx4 v2, s[24:27], s46 offen sc1 lds
    buffer_load_dwordx4 v2, s[24:27], s46 offen offset:1024 sc1 lds
    s_add_u32 m0, s44, 18432
    s_nop 0
    buffer_load_dwordx4 v2, s[28:31], s47 offen  lds
    buffer_load_dwordx4 v2, s[28:31], s47 offen offset:1024  lds
    s_add_u32 m0, s50, 18432
    s_cmp_lt_u32 s19, 1
    s_cbranch_scc0 L_m_g55
    buffer_load_dwordx4 v3, s[28:31], s47 offen  lds
L_m_g55:
    v_readlane_b32 s46, v6, s40
    v_readlane_b32 s47, v7, s40
    s_add_u32 s40, s40, 1
    s_nop 0
    s_waitcnt vmcnt(8)
    s_barrier
    s_add_u32 m0, s43, 24576
    s_nop 0
    buffer_load_dwordx4 v2, s[24:27], s46 offen sc1 lds
    buffer_load_dwordx4 v2, s[24:27], s46 offen offset:1024 sc1 lds
    s_add_u32 m0, s44, 27648
    s_nop 0
    buffer_load_dwordx4 v2, s[28:31], s47 offen  lds
    buffer_load_dwordx4 v2, s[28:31], s47 offen offset:1024  lds
    s_add_u32 m0, s50, 27648
    s_cmp_lt_u32 s19, 1
    s_cbranch_scc0 L_m_g56
    buffer_load_dwordx4 v3, s[28:31], s47 offen  lds
L_m_g56:
    v_readlane_b32 s46, v6, s40
    v_readlane_b32 s47, v7, s40
    s_add_u32 s40, s40, 1
    s_nop 0
    s_waitcnt vmcnt(8)
    s_barrier
    s_add_u32 m0, s43, 0
    s_nop 0
    buffer_load_dwordx4 v2, s[24:27], s46 offen sc1 lds
    buffer_load_dwordx4 v2, s[24:27], s46 offen offset:1024 sc1 lds
    s_add_u32 m0, s44, 0
    s_nop 0
    buffer_load_dwordx4 v2, s[28:31], s47 offen  lds
    buffer_load_dwordx4 v2, s[28:31], s47 offen offset:1024  lds
    s_add_u32 m0, s50, 0
    s_cmp_lt_u32 s19, 1
    s_cbranch_scc0 L_m_g57
    buffer_load_dwordx4 v3, s[28:31], s47 offen  lds
L_m_g57:
    v_readlane_b32 s46, v6, s40
    v_readlane_b32 s47, v7, s40
    s_add_u32 s40, s40, 1
    s_nop 0
    s_waitcnt vmcnt(8)
    s_barrier
    s_cmp_eq_u32 s19, 0
    s_cbranch_scc0 L_p3_nw
    s_lshl_b32 s10, s2, 7
    s_add_u32 s10, s10, 98304
    v_mov_b32 v20, s3
    v_mov_b32 v21, 0
    s_mov_b64 exec, 1
    buffer_store_dword v20, v21, s[96:99], s10 offen sc1
    s_mov_b64 exec, -1
L_p3_nw:
    s_waitcnt vmcnt(4)
    s_barrier
    s_waitcnt vmcnt(0)
    s_barrier
    s_branch L_p3_end
L_p3_cons:
L_p3_np:
    s_setprio 1
    s_and_b32 s16, s19, 0
    s_xor_b32 s12, s19, 1
    s_lshl_b32 s13, s16, 10
    v_lshlrev_b32 v6, 4, v1
    v_add_u32 v7, s13, v6
    s_lshl_b32 s14, s19, 11
    s_lshl_b32 s15, s12, 11
    s_add_u32 s14, s14, 85248
    s_add_u32 s15, s15, 85248
    v_add_u32 v2, s14, v7
    v_add_u32 v3, s15, v7
    v_add_u32 v4, 44288, v7
    v_lshrrev_b32 v8, 4, v1
    v_and_b32 v9, 15, v1
    v_and_b32 v10, 7, v1
    v_lshlrev_b32 v10, 4, v10
    v_lshl_add_u32 v10, v8, 7, v10
    s_lshl_b32 s13, s16, 9
    s_add_u32 s13, s13, 52480
    v_add_u32 v5, s13, v10
    s_mul_i32 s14, s19, 5120
    s_mul_i32 s15, s12, 5120
    s_add_u32 s14, s14, 122112
    s_add_u32 s15, s15, 122112
    v_add_u32 v12, s14, v6
    v_add_u32 v13, s15, v6
    s_lshl_b32 s10, s21, 2
    s_add_u32 s17, s10, s19
    s_mul_i32 s44, s22, 288
    s_add_u32 s44, s44, 4608
    v_lshlrev_b32 v11, 4, v8
    s_mul_i32 s45, s17, 18432
    s_mul_i32 s10, s22, 2304
    s_add_u32 s45, s45, s10
    v_and_b32 v14, 1, v8
    v_lshrrev_b32 v15, 1, v8
    v_lshlrev_b32 v15, 8, v15
    v_lshl_add_u32 v15, v9, 4, v15
    s_mov_b32 s24, s92
    s_mov_b32 s25, s93
    s_mov_b32 s26, 13824
    s_mov_b32 s27, 0x20000
    s_add_u32 s28, s92, 11960320
    s_addc_u32 s29, s93, 0
    s_mov_b32 s30, 2359296
    s_mov_b32 s31, 0x20000
    buffer_load_dwordx4 v[112:115], v11, s[24:27], s44 offen offset:0 sc1
    buffer_load_dwordx4 v[116:119], v11, s[24:27], s44 offen offset:64 sc1
    buffer_load_dwordx4 v[120:123], v11, s[24:27], s44 offen offset:128 sc1
    buffer_load_dwordx4 v[124:127], v11, s[24:27], s44 offen offset:192 sc1
    buffer_load_dwordx4 v[128:131], v11, s[24:27], s44 offen offset:256 sc1
    s_mov_b32 s37, 0
    s_mov_b32 s40, 4294942720
    s_mov_b32 s41, 4294939648
    s_waitcnt lgkmcnt(0)
    s_barrier
    ds_read_b128 v[56:59], v2 offset:0
    ds_read_b128 v[64:67], v4 offset:0
    ds_read_b128 v[68:71], v4 offset:2048
    ds_read_b128 v[72:75], v4 offset:4096
    ds_read_b128 v[76:79], v4 offset:6144
    ds_read_b128 v[80:83], v5 offset:0
    s_waitcnt lgkmcnt(4)
    v_mfma_f32_16x16x32_bf16 v[16:19], v[64:67], v[56:59], 0
    ds_read_b128 v[84:87], v2 offset:1024
    ds_read_b128 v[92:95], v4 offset:1024
    ds_read_b128 v[96:99], v4 offset:3072
    s_waitcnt lgkmcnt(6)
    v_mfma_f32_16x16x32_bf16 v[20:23], v[68:71], v[56:59], 0
    ds_read_b128 v[100:103], v4 offset:5120
    ds_read_b128 v[104:107], v4 offset:7168
    ds_read_b128 v[108:111], v5 offset:512
    s_waitcnt lgkmcnt(8)
    v_mfma_f32_16x16x32_bf16 v[24:27], v[72:75], v[56:59], 0
    s_add_u32 s37, s37, 1
    s_cmp_eq_u32 s37, 4
    s_cselect_b32 s37, 0, s37
    s_cselect_b32 s38, s40, 8192
    s_waitcnt lgkmcnt(7)
    v_mfma_f32_16x16x32_bf16 v[28:31], v[76:79], v[56:59], 0
    s_cselect_b32 s39, s41, 9216
    v_add_u32 v2, s38, v2
    s_waitcnt lgkmcnt(6)
    v_mfma_f32_16x16x32_bf16 v[32:35], v[80:83], v[56:59], 0
    v_add_u32 v4, s39, v4
    v_add_u32 v5, s39, v5
    s_mov_b32 s36, 5
.p2align 3
L_m_mm58:
    s_waitcnt lgkmcnt(4)
    v_mfma_f32_16x16x32_bf16 v[16:19], v[92:95], v[84:87], v[16:19]
    s_waitcnt lgkmcnt(0)
    s_barrier
    ds_read_b128 v[56:59], v2 offset:0
    ds_read_b128 v[64:67], v4 offset:0
    ds_read_b128 v[68:71], v4 offset:2048
    v_mfma_f32_16x16x32_bf16 v[20:23], v[96:99], v[84:87], v[20:23]
    ds_read_b128 v[72:75], v4 offset:4096
    ds_read_b128 v[76:79], v4 offset:6144
    ds_read_b128 v[80:83], v5 offset:0
    v_mfma_f32_16x16x32_bf16 v[24:27], v[100:103], v[84:87], v[24:27]
    v_mfma_f32_16x16x32_bf16 v[28:31], v[104:107], v[84:87], v[28:31]
    v_mfma_f32_16x16x32_bf16 v[32:35], v[108:111], v[84:87], v[32:35]
    s_waitcnt lgkmcnt(4)
    v_mfma_f32_16x16x32_bf16 v[16:19], v[64:67], v[56:59], v[16:19]
    ds_read_b128 v[84:87], v2 offset:1024
    ds_read_b128 v[92:95], v4 offset:1024
    ds_read_b128 v[96:99], v4 offset:3072
    s_waitcnt lgkmcnt(6)
    v_mfma_f32_16x16x32_bf16 v[20:23], v[68:71], v[56:59], v[20:23]
    ds_read_b128 v[100:103], v4 offset:5120
    ds_read_b128 v[104:107], v4 offset:7168
    ds_read_b128 v[108:111], v5 offset:512
    s_waitcnt lgkmcnt(8)
    v_mfma_f32_16x16x32_bf16 v[24:27], v[72:75], v[56:59], v[24:27]
    s_add_u32 s37, s37, 1
    s_cmp_eq_u32 s37, 4
    s_cselect_b32 s37, 0, s37
    s_cselect_b32 s38, s40, 8192
    s_waitcnt lgkmcnt(7)
    v_mfma_f32_16x16x32_bf16 v[28:31], v[76:79], v[56:59], v[28:31]
    s_cselect_b32 s39, s41, 9216
    v_add_u32 v2, s38, v2
    v_add_u32 v4, s39, v4
    s_waitcnt lgkmcnt(6)
    v_mfma_f32_16x16x32_bf16 v[32:35], v[80:83], v[56:59], v[32:35]
    v_add_u32 v5, s39, v5
    s_sub_u32 s36, s36, 1
    s_cmp_lg_u32 s36, 0
    s_cbranch_scc1 L_m_mm58
    s_waitcnt lgkmcnt(4)
    v_mfma_f32_16x16x32_bf16 v[16:19], v[92:95], v[84:87], v[16:19]
    s_waitcnt vmcnt(0) lgkmcnt(0)
    s_barrier
    ds_read_b128 v[56:59], v2 offset:0
    ds_read_b128 v[64:67], v4 offset:0
    ds_read_b128 v[68:71], v4 offset:2048
    v_mfma_f32_16x16x32_bf16 v[20:23], v[96:99], v[84:87], v[20:23]
    ds_read_b128 v[72:75], v4 offset:4096
    ds_read_b128 v[76:79], v4 offset:6144
    ds_read_b128 v[80:83], v5 offset:0
    v_mfma_f32_16x16x32_bf16 v[24:27], v[100:103], v[84:87], v[24:27]
    v_mfma_f32_16x16x32_bf16 v[28:31], v[104:107], v[84:87], v[28:31]
    v_mfma_f32_16x16x32_bf16 v[32:35], v[108:111], v[84:87], v[32:35]
    s_waitcnt lgkmcnt(4)
    v_mfma_f32_16x16x32_bf16 v[16:19], v[64:67], v[56:59], v[16:19]
    ds_read_b128 v[84:87], v2 offset:1024
    ds_read_b128 v[92:95], v4 offset:1024
    ds_read_b128 v[96:99], v4 offset:3072
    s_waitcnt lgkmcnt(6)
    v_mfma_f32_16x16x32_bf16 v[20:23], v[68:71], v[56:59], v[20:23]
    ds_read_b128 v[100:103], v4 offset:5120
    ds_read_b128 v[104:107], v4 offset:7168
    ds_read_b128 v[108:111], v5 offset:512
    s_waitcnt lgkmcnt(8)
    v_mfma_f32_16x16x32_bf16 v[24:27], v[72:75], v[56:59], v[24:27]
    s_add_u32 s37, s37, 1
    s_cmp_eq_u32 s37, 4
    s_cselect_b32 s37, 0, s37
    s_cselect_b32 s38, s40, 8192
    s_waitcnt lgkmcnt(7)
    v_mfma_f32_16x16x32_bf16 v[28:31], v[76:79], v[56:59], v[28:31]
    s_cselect_b32 s39, s41, 9216
    v_add_u32 v2, s38, v2
    s_waitcnt lgkmcnt(6)
    v_mfma_f32_16x16x32_bf16 v[32:35], v[80:83], v[56:59], v[32:35]
    v_add_u32 v4, s39, v4
    v_add_u32 v5, s39, v5
    s_waitcnt lgkmcnt(4)
    v_mfma_f32_16x16x32_bf16 v[16:19], v[92:95], v[84:87], v[16:19]
    s_waitcnt lgkmcnt(0)
    s_barrier
    ds_read_b128 v[56:59], v2 offset:0
    ds_read_b128 v[64:67], v4 offset:0
    ds_read_b128 v[68:71], v4 offset:2048
    v_mfma_f32_16x16x32_bf16 v[20:23], v[96:99], v[84:87], v[20:23]
    ds_read_b128 v[72:75], v4 offset:4096
    ds_read_b128 v[76:79], v4 offset:6144
    ds_read_b128 v[80:83], v5 offset:0
    v_mfma_f32_16x16x32_bf16 v[24:27], v[100:103], v[84:87], v[24:27]
    v_mfma_f32_16x16x32_bf16 v[28:31], v[104:107], v[84:87], v[28:31]
    v_mfma_f32_16x16x32_bf16 v[32:35], v[108:111], v[84:87], v[32:35]
    s_waitcnt lgkmcnt(4)
    v_mfma_f32_16x16x32_bf16 v[16:19], v[64:67], v[56:59], v[16:19]
    ds_read_b128 v[84:87], v2 offset:1024
    ds_read_b128 v[92:95], v4 offset:1024
    ds_read_b128 v[96:99], v4 offset:3072
    s_waitcnt lgkmcnt(6)
    v_mfma_f32_16x16x32_bf16 v[20:23], v[68:71], v[56:59], v[20:23]
    ds_read_b128 v[100:103], v4 offset:5120
    ds_read_b128 v[104:107], v4 offset:7168
    ds_read_b128 v[108:111], v5 offset:512
    s_waitcnt lgkmcnt(8)
    v_mfma_f32_16x16x32_bf16 v[24:27], v[72:75], v[56:59], v[24:27]
    s_add_u32 s37, s37, 1
    s_cmp_eq_u32 s37, 4
    s_cselect_b32 s37, 0, s37
    s_cselect_b32 s38, s40, 8192
    s_waitcnt lgkmcnt(7)
    v_mfma_f32_16x16x32_bf16 v[28:31], v[76:79], v[56:59], v[28:31]
    s_cselect_b32 s39, s41, 9216
    v_add_u32 v2, s38, v2
    s_waitcnt lgkmcnt(6)
    v_mfma_f32_16x16x32_bf16 v[32:35], v[80:83], v[56:59], v[32:35]
    v_add_u32 v4, s39, v4
    v_add_u32 v5, s39, v5
    s_waitcnt lgkmcnt(4)
    v_mfma_f32_16x16x32_bf16 v[16:19], v[92:95], v[84:87], v[16:19]
    s_waitcnt lgkmcnt(0)
    s_barrier
    ds_read_b128 v[56:59], v2 offset:0
    ds_read_b128 v[64:67], v4 offset:0
    ds_read_b128 v[68:71], v4 offset:2048
    v_mfma_f32_16x16x32_bf16 v[20:23], v[96:99], v[84:87], v[20:23]
    ds_read_b128 v[72:75], v4 offset:4096
    ds_read_b128 v[76:79], v4 offset:6144
    ds_read_b128 v[80:83], v5 offset:0
    v_mfma_f32_16x16x32_bf16 v[24:27], v[100:103], v[84:87], v[24:27]
    v_mfma_f32_16x16x32_bf16 v[28:31], v[104:107], v[84:87], v[28:31]
    v_mfma_f32_16x16x32_bf16 v[32:35], v[108:111], v[84:87], v[32:35]
    s_waitcnt lgkmcnt(4)
    v_mfma_f32_16x16x32_bf16 v[16:19], v[64:67], v[56:59], v[16:19]
    ds_read_b128 v[84:87], v2 offset:1024
    ds_read_b128 v[92:95], v4 offset:1024
    ds_read_b128 v[96:99], v4 offset:3072
    s_waitcnt lgkmcnt(6)
    v_mfma_f32_16x16x32_bf16 v[20:23], v[68:71], v[56:59], v[20:23]
    ds_read_b128 v[100:103], v4 offset:5120
    ds_read_b128 v[104:107], v4 offset:7168
    ds_read_b128 v[108:111], v5 offset:512
    s_waitcnt lgkmcnt(8)
    v_mfma_f32_16x16x32_bf16 v[24:27], v[72:75], v[56:59], v[24:27]
    s_add_u32 s37, s37, 1
    s_cmp_eq_u32 s37, 4
    s_cselect_b32 s37, 0, s37
    s_cselect_b32 s38, s40, 8192
    s_waitcnt lgkmcnt(7)
    v_mfma_f32_16x16x32_bf16 v[28:31], v[76:79], v[56:59], v[28:31]
    s_cselect_b32 s39, s41, 9216
    v_add_u32 v2, s38, v2
    s_waitcnt lgkmcnt(6)
    v_mfma_f32_16x16x32_bf16 v[32:35], v[80:83], v[56:59], v[32:35]
    v_add_u32 v4, s39, v4
    v_add_u32 v5, s39, v5
    s_waitcnt lgkmcnt(4)
    v_mfma_f32_16x16x32_bf16 v[16:19], v[92:95], v[84:87], v[16:19]
    s_waitcnt lgkmcnt(3)
    v_mfma_f32_16x16x32_bf16 v[20:23], v[96:99], v[84:87], v[20:23]
    s_waitcnt lgkmcnt(2)
    v_mfma_f32_16x16x32_bf16 v[24:27], v[100:103], v[84:87], v[24:27]
    s_waitcnt lgkmcnt(1)
    v_mfma_f32_16x16x32_bf16 v[28:31], v[104:107], v[84:87], v[28:31]
    s_waitcnt lgkmcnt(0)
    v_mfma_f32_16x16x32_bf16 v[32:35], v[108:111], v[84:87], v[32:35]
    v_mov_b32 v2, 163820
    v_mov_b32 v3, 1
    s_mov_b64 exec, 1
    ds_add_u32 v2, v3
    s_mov_b64 exec, -1
    s_mul_i32 s10, s19, 2304
    s_add_u32 s10, s10, 142592
    v_mul_u32_u24 v10, 144, v9
    v_lshl_add_u32 v10, v8, 3, v10
    v_add_u32 v10, s10, v10
    ds_read_b64 v[132:133], v10 offset:0
    ds_read_b64 v[134:135], v10 offset:32
    ds_read_b64 v[136:137], v10 offset:64
    ds_read_b64 v[138:139], v10 offset:96
    ds_read_b64 v[140:141], v10 offset:128
    s_waitcnt vmcnt(0) lgkmcnt(0)
    v_lshlrev_b32 v84, 16, v132
    v_lshlrev_b32 v88, 16, v134
    v_lshlrev_b32 v92, 16, v136
    v_lshlrev_b32 v96, 16, v138
    v_lshlrev_b32 v100, 16, v140
    v_and_b32 v85, 0xffff0000, v132
    v_and_b32 v89, 0xffff0000, v134
    v_and_b32 v93, 0xffff0000, v136
    v_and_b32 v97, 0xffff0000, v138
    v_and_b32 v101, 0xffff0000, v140
    v_lshlrev_b32 v86, 16, v133
    v_lshlrev_b32 v90, 16, v135
    v_lshlrev_b32 v94, 16, v137
    v_lshlrev_b32 v98, 16, v139
    v_lshlrev_b32 v102, 16, v141
    v_and_b32 v87, 0xffff0000, v133
    v_and_b32 v91, 0xffff0000, v135
    v_and_b32 v95, 0xffff0000, v137
    v_and_b32 v99, 0xffff0000, v139
    v_and_b32 v103, 0xffff0000, v141
    v_pk_fma_f32 v[16:17], v[16:17], v[112:113], v[84:85]
    v_pk_fma_f32 v[20:21], v[20:21], v[116:117], v[88:89]
    v_pk_fma_f32 v[24:25], v[24:25], v[120:121], v[92:93]
    v_pk_fma_f32 v[28:29], v[28:29], v[124:125], v[96:97]
    v_pk_fma_f32 v[32:33], v[32:33], v[128:129], v[100:101]
    v_pk_fma_f32 v[18:19], v[18:19], v[114:115], v[86:87]
    v_pk_fma_f32 v[22:23], v[22:23], v[118:119], v[90:91]
    v_pk_fma_f32 v[26:27], v[26:27], v[122:123], v[94:95]
    v_pk_fma_f32 v[30:31], v[30:31], v[126:127], v[98:99]
    v_pk_fma_f32 v[34:35], v[34:35], v[130:131], v[102:103]
    v_cvt_pk_bf16_f32 v144, v16, v17
    v_cvt_pk_bf16_f32 v146, v20, v21
    v_cvt_pk_bf16_f32 v148, v24, v25
    v_cvt_pk_bf16_f32 v150, v28, v29
    v_cvt_pk_bf16_f32 v152, v32, v33
    v_cvt_pk_bf16_f32 v145, v18, v19
    v_cvt_pk_bf16_f32 v147, v22, v23
    v_cvt_pk_bf16_f32 v149, v26, v27
    v_cvt_pk_bf16_f32 v151, v30, v31
    v_cvt_pk_bf16_f32 v153, v34, v35
    v_lshl_add_u32 v11, v14, 9, v15
    v_permlane16_swap_b32 v144, v146
    v_permlane16_swap_b32 v145, v147
    v_permlane16_swap_b32 v148, v150
    v_permlane16_swap_b32 v149, v151
    buffer_store_dwordx4 v[144:147], v11, s[28:31], s45 offen sc1
    buffer_store_dwordx4 v[148:151], v11, s[28:31], s45 offen offset:1024 sc1
    v_mov_b32 v154, v152
    v_mov_b32 v155, v153
    s_nop 1
    v_permlane16_swap_b32 v152, v154
    v_permlane16_swap_b32 v153, v155
    s_mov_b64 exec, 0xffff
    buffer_store_dwordx4 v[152:155], v11, s[28:31], s45 offen offset:2048 sc1
    s_mov_b64 exec, -1
    s_add_u32 s24, s92, 45056
    s_addc_u32 s25, s93, 0
    s_mov_b32 s26, 131072
    s_mov_b32 s27, 0x20000
    v_pk_add_f32 v[84:85], v[16:17], v[18:19]
    v_pk_mul_f32 v[86:87], v[16:17], v[16:17]
    v_pk_fma_f32 v[86:87], v[18:19], v[18:19], v[86:87]
    v_pk_add_f32 v[84:85], v[84:85], v[20:21]
    v_pk_fma_f32 v[86:87], v[20:21], v[20:21], v[86:87]
    v_pk_add_f32 v[84:85], v[84:85], v[22:23]
    v_pk_fma_f32 v[86:87], v[22:23], v[22:23], v[86:87]
    v_pk_add_f32 v[84:85], v[84:85], v[24:25]
    v_pk_fma_f32 v[86:87], v[24:25], v[24:25], v[86:87]
    v_pk_add_f32 v[84:85], v[84:85], v[26:27]
    v_pk_fma_f32 v[86:87], v[26:27], v[26:27], v[86:87]
    v_pk_add_f32 v[84:85], v[84:85], v[28:29]
    v_pk_fma_f32 v[86:87], v[28:29], v[28:29], v[86:87]
    v_pk_add_f32 v[84:85], v[84:85], v[30:31]
    v_pk_fma_f32 v[86:87], v[30:31], v[30:31], v[86:87]
    s_mov_b32 exec_hi, 0
    v_pk_add_f32 v[84:85], v[84:85], v[32:33]
    v_pk_fma_f32 v[86:87], v[32:33], v[32:33], v[86:87]
    v_pk_add_f32 v[84:85], v[84:85], v[34:35]
    v_pk_fma_f32 v[86:87], v[34:35], v[34:35], v[86:87]
    s_mov_b32 exec_hi, -1
    v_add_f32 v84, v84, v85
    v_add_f32 v85, v86, v87
    v_mov_b32 v86, v84
    v_mov_b32 v87, v85
    s_nop 1
    v_permlane16_swap_b32 v84, v86
    v_permlane16_swap_b32 v85, v87
    v_add_f32 v84, v84, v86
    v_add_f32 v85, v85, v87
    v_mov_b32 v86, v84
    v_mov_b32 v87, v85
    s_nop 1
    v_permlane32_swap_b32 v84, v86
    v_permlane32_swap_b32 v85, v87
    v_add_f32 v84, v84, v86
    v_add_f32 v85, v85, v87
    s_lshl_b32 s10, s22, 14
    s_lshl_b32 s11, s17, 7
    s_add_u32 s10, s10, s11
    v_lshlrev_b32 v11, 3, v9
    s_mov_b64 exec, 0xffff
    buffer_store_dwordx2 v[84:85], v11, s[24:27], s10 offen sc1
    s_mov_b64 exec, -1
    s_setprio 0
    s_waitcnt vmcnt(0)
    v_mov_b32 v2, 163824
    v_mov_b32 v3, 1
    s_mov_b64 exec, 1
    ds_add_rtn_u32 v3, v2, v3
    s_mov_b64 exec, -1
    s_waitcnt lgkmcnt(0)
    v_readfirstlane_b32 s10, v3
    s_cmp_eq_u32 s10, 3
    s_cbranch_scc0 L_p3_end
    s_lshl_b32 s10, s2, 7
    s_add_u32 s10, s10, 163840
    v_mov_b32 v2, s3
    v_mov_b32 v3, 0
    s_mov_b64 exec, 1
    buffer_store_dword v2, v3, s[96:99], s10 offen sc1
    s_mov_b64 exec, -1
L_p3_end:
L_ph4:
    s_and_b32 s10, s2, 56
    s_add_u32 s10, s10, s20
    s_cmp_eq_u32 s10, 3
    s_cbranch_scc0 L_ph4n
    v_lshlrev_b32 v250, 7, v1
    s_mov_b32 s10, L_ph4-adaLN_cond__softmax_full_mha__mixer_gmlp__prompt_kernel-0
    buffer_load_dword v251, v250, s[4:7], s10 offen
    s_add_u32 s10, s10, 8192
    buffer_load_dword v251, v250, s[4:7], s10 offen
    s_add_u32 s10, s10, 8192
    buffer_load_dword v251, v250, s[4:7], s10 offen
    s_add_u32 s10, s10, 8192
L_ph4n:
    s_and_b32 s10, s2, 7
    s_lshr_b32 s11, s2, 3
    s_and_b32 s12, s10, 1
    s_lshl_b32 s12, s12, 3
    s_and_b32 s13, s11, 7
    s_add_u32 s21, s12, s13
    s_lshr_b32 s12, s10, 1
    s_lshl_b32 s12, s12, 2
    s_lshr_b32 s14, s11, 3
    s_add_u32 s22, s12, s14
    s_lshl_b32 s14, s14, 1
    s_add_u32 s23, s13, s14
    s_mov_b32 s23, 0
    s_and_b32 s19, s20, 3
    s_mul_i32 s10, s21, 147456
    s_mul_i32 s11, s22, 331776
    v_lshlrev_b32 v240, 4, v1
    v_add_u32 v241, 16384, v240
    s_mul_i32 s57, s19, 4096
    s_mul_i32 s55, s19, 4294964224
    s_add_u32 s55, s55, 16384
    v_add_u32 v242, s55, v240
    s_lshl_b32 s64, s19, 10
    s_add_u32 s64, s64, 81920
    s_mul_i32 s58, s19, 4096
    s_add_u32 s58, s58, 65536
    v_subrev_u32 v245, 9, v1
    v_min_u32 v245, v245, v1
    v_add_u32 v243, s23, v245
    v_subrev_u32 v244, 9, v243
    v_min_u32 v244, v244, v243
    v_cmp_le_u32 vcc, 9, v1
    v_mul_u32_u24 v245, 2048, v244
    v_mul_u32_u24 v246, 36864, v244
    v_add_u32 v243, 18432, v246
    v_cndmask_b32 v246, v246, v243, vcc
    s_mov_b32 s60, 0
    s_mov_b32 s61, 0
    s_mul_i32 s55, s19, 36864
    s_sub_u32 s26, 147456, s55
    s_add_u32 s55, s55, s10
    s_add_u32 s55, s55, 11960320
    s_add_u32 s24, s92, s55
    s_addc_u32 s25, s93, 0
    s_mov_b32 s27, 0x20000
    s_mul_i32 s55, s19, 4096
    s_sub_u32 s30, 331776, s55
    s_add_u32 s55, s55, s11
    s_add_u32 s55, s55, 33878016
    s_add_u32 s28, s92, s55
    s_addc_u32 s29, s93, 0
    s_mov_b32 s31, 0x20000
    v_readlane_b32 s60, v245, 0
    v_readlane_b32 s61, v246, 0
    s_nop 3
    s_cmp_ge_u32 s20, 4
    s_cbranch_scc1 L_p4_g0
    s_cmp_eq_u32 s19, 0
    s_cbranch_scc0 L_m_gw59
    s_mul_i32 s12, s22, 9
    s_lshr_b32 s12, s12, 1
    v_min_u32 v20, 9, v1
    v_cmp_lt_u32 vcc, 4, v20
    v_add_u32 v20, s12, v20
    v_add_u32 v21, 67, v20
    v_cndmask_b32 v20, v20, v21, vcc
    v_lshlrev_b32 v20, 7, v20
    v_add_u32 v20, 98304, v20
    s_mov_b32 s11, 131072
L_m_pl61:
    buffer_load_dword v248, v20, s[96:99], 0 offen sc1
    s_waitcnt vmcnt(0)
    v_cmp_ne_u32 vcc, s3, v248
    s_sub_u32 s11, s11, 1
    s_cmp_eq_u32 s11, 0
    s_cbranch_scc1 L_m_pe62
    s_cbranch_vccnz L_m_pl61
L_m_pe62:
    v_mov_b32 v20, 163828
    v_mov_b32 v21, 1
    ds_write_b32 v20, v21
    s_branch L_m_gx60
L_m_gw59:
    v_mov_b32 v20, 163828
    s_mov_b32 s11, 131072
L_m_sp63:
    ds_read_b32 v21, v20
    s_sub_u32 s11, s11, 1
    s_waitcnt lgkmcnt(0)
    v_readfirstlane_b32 s10, v21
    s_cmp_eq_u32 s11, 0
    s_cbranch_scc1 L_m_se64
    s_cmp_eq_u32 s10, 1
    s_cbranch_scc0 L_m_sp63
L_m_se64:
L_m_gx60:
    v_mov_b32 v20, 163820
    s_mov_b32 s11, 131072
L_m_sp65:
    ds_read_b32 v21, v20
    s_sub_u32 s11, s11, 1
    s_waitcnt lgkmcnt(0)
    v_readfirstlane_b32 s10, v21
    s_cmp_eq_u32 s11, 0
    s_cbranch_scc1 L_m_se66
    s_cmp_eq_u32 s10, 4
    s_cbranch_scc0 L_m_sp65
L_m_se66:
    s_add_u32 s32, s92, 24576
    s_addc_u32 s33, s93, 0
    s_mov_b32 s34, 18432
    s_mov_b32 s35, 0x20000
    s_mul_i32 s12, s22, 1152
    s_cmp_lt_u32 s19, 2
    s_cbranch_scc0 L_p4_nov
    s_lshl_b32 s13, s19, 10
    s_add_u32 s12, s12, s13
    s_add_u32 m0, s13, 139776
    v_lshlrev_b32 v20, 4, v1
    buffer_load_dwordx4 v20, s[32:35], s12 offen sc1 lds
L_p4_nov:
    s_add_u32 m0, s58, 0
    s_nop 0
    buffer_load_dwordx4 v240, s[28:31], s61 offen sc1 lds
    buffer_load_dwordx4 v240, s[28:31], s61 offen offset:1024 sc1 lds
    buffer_load_dwordx4 v240, s[28:31], s61 offen offset:2048 sc1 lds
    buffer_load_dwordx4 v240, s[28:31], s61 offen offset:3072 sc1 lds
    s_add_u32 m0, s64, 0
    s_cmp_lt_u32 s19, 2
    s_cbranch_scc0 L_m_g67
    buffer_load_dwordx4 v242, s[28:31], s61 offen sc1 lds
L_m_g67:
    v_readlane_b32 s61, v246, 1
    s_nop 3
    s_add_u32 m0, s58, 18432
    s_nop 0
    buffer_load_dwordx4 v240, s[28:31], s61 offen sc1 lds
    buffer_load_dwordx4 v240, s[28:31], s61 offen offset:1024 sc1 lds
    buffer_load_dwordx4 v240, s[28:31], s61 offen offset:2048 sc1 lds
    buffer_load_dwordx4 v240, s[28:31], s61 offen offset:3072 sc1 lds
    s_add_u32 m0, s64, 18432
    s_cmp_lt_u32 s19, 2
    s_cbranch_scc0 L_m_g68
    buffer_load_dwordx4 v242, s[28:31], s61 offen sc1 lds
L_m_g68:
    v_readlane_b32 s61, v246, 2
    s_nop 3
    s_add_u32 m0, s58, 36864
    s_nop 0
    buffer_load_dwordx4 v240, s[28:31], s61 offen sc1 lds
    buffer_load_dwordx4 v240, s[28:31], s61 offen offset:1024 sc1 lds
    buffer_load_dwordx4 v240, s[28:31], s61 offen offset:2048 sc1 lds
    buffer_load_dwordx4 v240, s[28:31], s61 offen offset:3072 sc1 lds
    s_add_u32 m0, s64, 36864
    s_cmp_lt_u32 s19, 2
    s_cbranch_scc0 L_m_g69
    buffer_load_dwordx4 v242, s[28:31], s61 offen sc1 lds
L_m_g69:
    v_readlane_b32 s61, v246, 3
    s_nop 3
    s_and_b32 s16, s19, 1
    s_xor_b32 s12, s19, 1
    s_lshl_b32 s13, s19, 12
    s_lshl_b32 s14, s12, 12
    s_add_u32 s13, s13, 16384
    s_add_u32 s14, s14, 16384
    s_mul_i32 s15, s16, 10240
    s_add_u32 s15, s15, 83968
    v_lshlrev_b32 v6, 4, v1
    v_add_u32 v2, s13, v6
    v_add_u32 v3, s14, v6
    v_add_u32 v4, s15, v6
    v_add_u32 v5, 92160, v6
    s_lshl_b32 s10, s21, 2
    s_add_u32 s11, s19, s10
    s_add_u32 s17, s12, s10
    s_mul_i32 s13, s22, 9
    s_mul_i32 s14, s16, 5
    s_add_u32 s14, s14, s13
    s_lshl_b32 s51, s19, 7
    s_lshl_b32 s52, s12, 7
    s_mul_i32 s53, s16, 320
    v_mov_b32 v182, 3222493025
    v_mov_b32 v183, v182
    v_mov_b32 v184, 3184710632
    v_mov_b32 v185, v184
    v_lshrrev_b32 v6, 4, v1
    v_and_b32 v7, 15, v1
    v_lshlrev_b32 v10, 2, v7
    v_add_u32 v12, s51, v10
    v_add_u32 v13, s52, v10
    v_add_u32 v12, 139264, v12
    v_add_u32 v13, 139264, v13
    v_lshlrev_b32 v15, 4, v6
    v_add_u32 v15, 140352, v15
    v_add_u32 v14, s53, v15
    s_add_u32 s32, s92, 45056
    s_addc_u32 s33, s93, 0
    s_mov_b32 s34, 131072
    s_mov_b32 s35, 0x20000
    s_lshl_b32 s47, s21, 10
    s_lshl_b32 s11, s19, 8
    s_add_u32 s47, s47, s11
    v_and_b32 v9, 31, v1
    v_lshrrev_b32 v8, 5, v1
    v_lshlrev_b32 v8, 16, v8
    v_lshl_add_u32 v8, v9, 3, v8
    s_lshl_b32 s11, s19, 7
    v_lshl_add_u32 v9, v9, 2, s11
    v_add_u32 v9, 139264, v9
    s_cmp_eq_u32 s19, 0
    s_cbranch_scc0 L_m_gw70
    s_lshl_b32 s10, s21, 1
    v_bfe_u32 v22, v1, 3, 1
    v_add_u32 v22, s10, v22
    v_lshrrev_b32 v20, 2, v22
    v_and_b32 v22, 3, v22
    v_lshl_add_u32 v20, v22, 6, v20
    v_and_b32 v22, 7, v1
    v_lshl_add_u32 v20, v22, 3, v20
    v_lshlrev_b32 v20, 7, v20
    v_add_u32 v20, 163840, v20
    s_mov_b32 s11, 131072
L_m_pl72:
    buffer_load_dword v248, v20, s[96:99], 0 offen sc1
    s_waitcnt vmcnt(0)
    v_cmp_ne_u32 vcc, s3, v248
    s_sub_u32 s11, s11, 1
    s_cmp_eq_u32 s11, 0
    s_cbranch_scc1 L_m_pe73
    s_cbranch_vccnz L_m_pl72
L_m_pe73:
    v_mov_b32 v20, 163832
    v_mov_b32 v21, 1
    ds_write_b32 v20, v21
    s_branch L_m_gx71
L_m_gw70:
    v_mov_b32 v20, 163832
    s_mov_b32 s11, 131072
L_m_sp74:
    ds_read_b32 v21, v20
    s_sub_u32 s11, s11, 1
    s_waitcnt lgkmcnt(0)
    v_readfirstlane_b32 s10, v21
    s_cmp_eq_u32 s11, 0
    s_cbranch_scc1 L_m_se75
    s_cmp_eq_u32 s10, 1
    s_cbranch_scc0 L_m_sp74
L_m_se75:
L_m_gx71:
    s_add_u32 m0, s57, 0
    s_nop 0
    buffer_load_dwordx4 v240, s[24:27], s60 offen sc1 lds
    buffer_load_dwordx4 v240, s[24:27], s60 offen offset:1024 sc1 lds
    buffer_load_dwordx4 v241, s[24:27], s60 offen offset:2048 sc1 lds
    buffer_load_dwordx4 v241, s[24:27], s60 offen offset:3072 sc1 lds
    v_readlane_b32 s60, v245, 1
    s_nop 3
    buffer_load_dwordx2 v[16:17], v8, s[32:35], s47 offen sc1
    s_add_u32 s47, s47, 16384
    buffer_load_dwordx2 v[18:19], v8, s[32:35], s47 offen sc1
    s_add_u32 s47, s47, 16384
    buffer_load_dwordx2 v[20:21], v8, s[32:35], s47 offen sc1
    s_add_u32 s47, s47, 16384
    buffer_load_dwordx2 v[22:23], v8, s[32:35], s47 offen sc1
    s_add_u32 s47, s47, 16384
    s_add_u32 m0, s57, 16384
    s_nop 0
    buffer_load_dwordx4 v240, s[24:27], s60 offen sc1 lds
    buffer_load_dwordx4 v240, s[24:27], s60 offen offset:1024 sc1 lds
    buffer_load_dwordx4 v241, s[24:27], s60 offen offset:2048 sc1 lds
    buffer_load_dwordx4 v241, s[24:27], s60 offen offset:3072 sc1 lds
    v_readlane_b32 s60, v245, 2
    s_nop 3
    s_add_u32 m0, s57, 32768
    s_nop 0
    buffer_load_dwordx4 v240, s[24:27], s60 offen sc1 lds
    buffer_load_dwordx4 v240, s[24:27], s60 offen offset:1024 sc1 lds
    buffer_load_dwordx4 v241, s[24:27], s60 offen offset:2048 sc1 lds
    buffer_load_dwordx4 v241, s[24:27], s60 offen offset:3072 sc1 lds
    v_readlane_b32 s60, v245, 3
    s_nop 3
    s_waitcnt vmcnt(12) lgkmcnt(0)
    s_barrier
    s_add_u32 m0, s57, 49152
    s_nop 0
    buffer_load_dwordx4 v240, s[24:27], s60 offen sc1 lds
    buffer_load_dwordx4 v240, s[24:27], s60 offen offset:1024 sc1 lds
    buffer_load_dwordx4 v241, s[24:27], s60 offen offset:2048 sc1 lds
    buffer_load_dwordx4 v241, s[24:27], s60 offen offset:3072 sc1 lds
    s_add_u32 m0, s58, 55296
    s_nop 0
    buffer_load_dwordx4 v240, s[28:31], s61 offen sc1 lds
    buffer_load_dwordx4 v240, s[28:31], s61 offen offset:1024 sc1 lds
    buffer_load_dwordx4 v240, s[28:31], s61 offen offset:2048 sc1 lds
    buffer_load_dwordx4 v240, s[28:31], s61 offen offset:3072 sc1 lds
    s_add_u32 m0, s64, 55296
    s_cmp_lt_u32 s19, 2
    s_cbranch_scc0 L_m_g76
    buffer_load_dwordx4 v242, s[28:31], s61 offen sc1 lds
L_m_g76:
    v_readlane_b32 s60, v245, 4
    v_readlane_b32 s61, v246, 4
    s_nop 3
    s_waitcnt vmcnt(12) lgkmcnt(0)
    s_barrier
    s_add_u32 m0, s57, 0
    s_nop 0
    buffer_load_dwordx4 v240, s[24:27], s60 offen sc1 lds
    buffer_load_dwordx4 v240, s[24:27], s60 offen offset:1024 sc1 lds
    buffer_load_dwordx4 v241, s[24:27], s60 offen offset:2048 sc1 lds
    buffer_load_dwordx4 v241, s[24:27], s60 offen offset:3072 sc1 lds
    s_add_u32 m0, s58, 0
    s_nop 0
    buffer_load_dwordx4 v240, s[28:31], s61 offen sc1 lds
    buffer_load_dwordx4 v240, s[28:31], s61 offen offset:1024 sc1 lds
    buffer_load_dwordx4 v240, s[28:31], s61 offen offset:2048 sc1 lds
    buffer_load_dwordx4 v240, s[28:31], s61 offen offset:3072 sc1 lds
    s_add_u32 m0, s64, 0
    s_cmp_lt_u32 s19, 2
    s_cbranch_scc0 L_m_g77
    buffer_load_dwordx4 v242, s[28:31], s61 offen sc1 lds
L_m_g77:
    v_readlane_b32 s60, v245, 5
    v_readlane_b32 s61, v246, 5
    s_nop 3
    s_mov_b32 s14, 987991609
    v_mov_b32 v24, 925353388
    v_pk_add_f32 v[16:17], v[16:17], v[18:19]
    v_pk_add_f32 v[20:21], v[20:21], v[22:23]
    v_pk_add_f32 v[16:17], v[16:17], v[20:21]
    v_mov_b32 v18, v16
    v_mov_b32 v19, v17
    s_nop 1
    v_permlane32_swap_b32 v16, v18
    v_permlane32_swap_b32 v17, v19
    v_add_f32 v16, v16, v18
    v_add_f32 v17, v17, v19
    v_mul_f32 v16, s14, v16
    v_fma_f32 v17, v17, s14, v24
    v_fma_f32 v17, -v16, v16, v17
    v_max_f32 v17, v17, v24
    v_rsq_f32 v17, v17
    s_nop 0
    ds_write_b32 v9, v17
    s_waitcnt vmcnt(16) lgkmcnt(0)
    s_barrier
    s_add_u32 m0, s57, 16384
    s_nop 0
    buffer_load_dwordx4 v240, s[24:27], s60 offen sc1 lds
    buffer_load_dwordx4 v240, s[24:27], s60 offen offset:1024 sc1 lds
    buffer_load_dwordx4 v241, s[24:27], s60 offen offset:2048 sc1 lds
    buffer_load_dwordx4 v241, s[24:27], s60 offen offset:3072 sc1 lds
    s_add_u32 m0, s58, 18432
    s_nop 0
    buffer_load_dwordx4 v240, s[28:31], s61 offen sc1 lds
    buffer_load_dwordx4 v240, s[28:31], s61 offen offset:1024 sc1 lds
    buffer_load_dwordx4 v240, s[28:31], s61 offen offset:2048 sc1 lds
    buffer_load_dwordx4 v240, s[28:31], s61 offen offset:3072 sc1 lds
    s_add_u32 m0, s64, 18432
    s_cmp_lt_u32 s19, 2
    s_cbranch_scc0 L_m_g78
    buffer_load_dwordx4 v242, s[28:31], s61 offen sc1 lds
L_m_g78:
    v_readlane_b32 s60, v245, 6
    v_readlane_b32 s61, v246, 6
    s_nop 3
    s_waitcnt vmcnt(16) lgkmcnt(0)
    s_barrier
    s_add_u32 m0, s57, 32768
    s_nop 0
    buffer_load_dwordx4 v240, s[24:27], s60 offen sc1 lds
    buffer_load_dwordx4 v240, s[24:27], s60 offen offset:1024 sc1 lds
    buffer_load_dwordx4 v241, s[24:27], s60 offen offset:2048 sc1 lds
    buffer_load_dwordx4 v241, s[24:27], s60 offen offset:3072 sc1 lds
    s_add_u32 m0, s58, 36864
    s_nop 0
    buffer_load_dwordx4 v240, s[28:31], s61 offen sc1 lds
    buffer_load_dwordx4 v240, s[28:31], s61 offen offset:1024 sc1 lds
    buffer_load_dwordx4 v240, s[28:31], s61 offen offset:2048 sc1 lds
    buffer_load_dwordx4 v240, s[28:31], s61 offen offset:3072 sc1 lds
    s_add_u32 m0, s64, 36864
    s_cmp_lt_u32 s19, 2
    s_cbranch_scc0 L_m_g79
    buffer_load_dwordx4 v242, s[28:31], s61 offen sc1 lds
L_m_g79:
    v_readlane_b32 s60, v245, 7
    v_readlane_b32 s61, v246, 7
    s_nop 3
    s_waitcnt vmcnt(16) lgkmcnt(0)
    s_barrier
    s_add_u32 m0, s57, 49152
    s_nop 0
    buffer_load_dwordx4 v240, s[24:27], s60 offen sc1 lds
    buffer_load_dwordx4 v240, s[24:27], s60 offen offset:1024 sc1 lds
    buffer_load_dwordx4 v241, s[24:27], s60 offen offset:2048 sc1 lds
    buffer_load_dwordx4 v241, s[24:27], s60 offen offset:3072 sc1 lds
    s_add_u32 m0, s58, 55296
    s_nop 0
    buffer_load_dwordx4 v240, s[28:31], s61 offen sc1 lds
    buffer_load_dwordx4 v240, s[28:31], s61 offen offset:1024 sc1 lds
    buffer_load_dwordx4 v240, s[28:31], s61 offen offset:2048 sc1 lds
    buffer_load_dwordx4 v240, s[28:31], s61 offen offset:3072 sc1 lds
    s_add_u32 m0, s64, 55296
    s_cmp_lt_u32 s19, 2
    s_cbranch_scc0 L_m_g80
    buffer_load_dwordx4 v242, s[28:31], s61 offen sc1 lds
L_m_g80:
    v_readlane_b32 s60, v245, 8
    v_readlane_b32 s61, v246, 8
    s_nop 3
    s_waitcnt vmcnt(16) lgkmcnt(0)
    s_barrier
    s_add_u32 m0, s57, 0
    s_nop 0
    buffer_load_dwordx4 v240, s[24:27], s60 offen sc1 lds
    buffer_load_dwordx4 v240, s[24:27], s60 offen offset:1024 sc1 lds
    buffer_load_dwordx4 v241, s[24:27], s60 offen offset:2048 sc1 lds
    buffer_load_dwordx4 v241, s[24:27], s60 offen offset:3072 sc1 lds
    s_add_u32 m0, s58, 0
    s_nop 0
    buffer_load_dwordx4 v240, s[28:31], s61 offen sc1 lds
    buffer_load_dwordx4 v240, s[28:31], s61 offen offset:1024 sc1 lds
    buffer_load_dwordx4 v240, s[28:31], s61 offen offset:2048 sc1 lds
    buffer_load_dwordx4 v240, s[28:31], s61 offen offset:3072 sc1 lds
    s_add_u32 m0, s64, 0
    s_cmp_lt_u32 s19, 2
    s_cbranch_scc0 L_m_g81
    buffer_load_dwordx4 v242, s[28:31], s61 offen sc1 lds
L_m_g81:
    v_readlane_b32 s60, v245, 9
    v_readlane_b32 s61, v246, 9
    s_nop 3
    s_waitcnt vmcnt(16) lgkmcnt(0)
    s_barrier
    s_add_u32 m0, s57, 16384
    s_nop 0
    buffer_load_dwordx4 v240, s[24:27], s60 offen sc1 lds
    buffer_load_dwordx4 v240, s[24:27], s60 offen offset:1024 sc1 lds
    buffer_load_dwordx4 v241, s[24:27], s60 offen offset:2048 sc1 lds
    buffer_load_dwordx4 v241, s[24:27], s60 offen offset:3072 sc1 lds
    s_add_u32 m0, s58, 18432
    s_nop 0
    buffer_load_dwordx4 v240, s[28:31], s61 offen sc1 lds
    buffer_load_dwordx4 v240, s[28:31], s61 offen offset:1024 sc1 lds
    buffer_load_dwordx4 v240, s[28:31], s61 offen offset:2048 sc1 lds
    buffer_load_dwordx4 v240, s[28:31], s61 offen offset:3072 sc1 lds
    s_add_u32 m0, s64, 18432
    s_cmp_lt_u32 s19, 2
    s_cbranch_scc0 L_m_g82
    buffer_load_dwordx4 v242, s[28:31], s61 offen sc1 lds
L_m_g82:
    v_readlane_b32 s60, v245, 10
    v_readlane_b32 s61, v246, 10
    s_nop 3
    s_waitcnt vmcnt(16) lgkmcnt(0)
    s_barrier
    s_add_u32 m0, s57, 32768
    s_nop 0
    buffer_load_dwordx4 v240, s[24:27], s60 offen sc1 lds
    buffer_load_dwordx4 v240, s[24:27], s60 offen offset:1024 sc1 lds
    buffer_load_dwordx4 v241, s[24:27], s60 offen offset:2048 sc1 lds
    buffer_load_dwordx4 v241, s[24:27], s60 offen offset:3072 sc1 lds
    s_add_u32 m0, s58, 36864
    s_nop 0
    buffer_load_dwordx4 v240, s[28:31], s61 offen sc1 lds
    buffer_load_dwordx4 v240, s[28:31], s61 offen offset:1024 sc1 lds
    buffer_load_dwordx4 v240, s[28:31], s61 offen offset:2048 sc1 lds
    buffer_load_dwordx4 v240, s[28:31], s61 offen offset:3072 sc1 lds
    s_add_u32 m0, s64, 36864
    s_cmp_lt_u32 s19, 2
    s_cbranch_scc0 L_m_g83
    buffer_load_dwordx4 v242, s[28:31], s61 offen sc1 lds
L_m_g83:
    v_readlane_b32 s60, v245, 11
    v_readlane_b32 s61, v246, 11
    s_nop 3
    s_waitcnt vmcnt(16) lgkmcnt(0)
    s_barrier
    s_add_u32 m0, s57, 49152
    s_nop 0
    buffer_load_dwordx4 v240, s[24:27], s60 offen sc1 lds
    buffer_load_dwordx4 v240, s[24:27], s60 offen offset:1024 sc1 lds
    buffer_load_dwordx4 v241, s[24:27], s60 offen offset:2048 sc1 lds
    buffer_load_dwordx4 v241, s[24:27], s60 offen offset:3072 sc1 lds
    s_add_u32 m0, s58, 55296
    s_nop 0
    buffer_load_dwordx4 v240, s[28:31], s61 offen sc1 lds
    buffer_load_dwordx4 v240, s[28:31], s61 offen offset:1024 sc1 lds
    buffer_load_dwordx4 v240, s[28:31], s61 offen offset:2048 sc1 lds
    buffer_load_dwordx4 v240, s[28:31], s61 offen offset:3072 sc1 lds
    s_add_u32 m0, s64, 55296
    s_cmp_lt_u32 s19, 2
    s_cbranch_scc0 L_m_g84
    buffer_load_dwordx4 v242, s[28:31], s61 offen sc1 lds
L_m_g84:
    v_readlane_b32 s60, v245, 12
    v_readlane_b32 s61, v246, 12
    s_nop 3
    s_setprio 1
    s_mov_b32 s37, 1
    s_mov_b32 s40, 4294918144
    s_mov_b32 s41, 4294912000
    s_waitcnt vmcnt(16) lgkmcnt(0)
    s_barrier
    ds_read_b128 v[88:91], v2 offset:0
    ds_read_b128 v[104:107], v4 offset:0
    ds_read_b128 v[92:95], v2 offset:2048
    ds_read_b128 v[96:99], v3 offset:0
    ds_read_b128 v[100:103], v3 offset:2048
    ds_read_b128 v[108:111], v4 offset:2048
    ds_read_b128 v[112:115], v4 offset:4096
    ds_read_b128 v[116:119], v4 offset:6144
    ds_read_b128 v[120:123], v5 offset:0
    s_waitcnt lgkmcnt(7)
    v_mfma_f32_16x16x32_bf16 v[16:19], v[104:107], v[88:91], 0
    ds_read_b128 v[124:127], v2 offset:1024
    s_waitcnt lgkmcnt(7)
    v_mfma_f32_16x16x32_bf16 v[20:23], v[104:107], v[92:95], 0
    ds_read_b128 v[140:143], v4 offset:1024
    s_waitcnt lgkmcnt(7)
    v_mfma_f32_16x16x32_bf16 v[24:27], v[104:107], v[96:99], 0
    ds_read_b128 v[128:131], v2 offset:3072
    s_waitcnt lgkmcnt(7)
    v_mfma_f32_16x16x32_bf16 v[28:31], v[104:107], v[100:103], 0
    ds_read_b128 v[132:135], v3 offset:1024
    s_waitcnt lgkmcnt(7)
    v_mfma_f32_16x16x32_bf16 v[44:47], v[108:111], v[100:103], 0
    ds_read_b128 v[136:139], v3 offset:3072
    v_mfma_f32_16x16x32_bf16 v[40:43], v[108:111], v[96:99], 0
    ds_read_b128 v[144:147], v4 offset:3072
    v_mfma_f32_16x16x32_bf16 v[36:39], v[108:111], v[92:95], 0
    ds_read_b128 v[148:151], v4 offset:5120
    v_mfma_f32_16x16x32_bf16 v[32:35], v[108:111], v[88:91], 0
    ds_read_b128 v[152:155], v4 offset:7168
    s_waitcnt lgkmcnt(10)
    v_mfma_f32_16x16x32_bf16 v[48:51], v[112:115], v[88:91], 0
    ds_read_b128 v[156:159], v5 offset:1024
    v_mfma_f32_16x16x32_bf16 v[52:55], v[112:115], v[92:95], 0
    s_add_u32 s37, s37, 1
    v_mfma_f32_16x16x32_bf16 v[56:59], v[112:115], v[96:99], 0
    s_cmp_eq_u32 s37, 4
    s_cselect_b32 s37, 0, s37
    v_mfma_f32_16x16x32_bf16 v[60:63], v[112:115], v[100:103], 0
    s_cselect_b32 s38, s40, 16384
    s_waitcnt lgkmcnt(10)
    v_mfma_f32_16x16x32_bf16 v[76:79], v[116:119], v[100:103], 0
    s_cselect_b32 s39, s41, 18432
    v_mfma_f32_16x16x32_bf16 v[72:75], v[116:119], v[96:99], 0
    v_add_u32 v2, s38, v2
    v_mfma_f32_16x16x32_bf16 v[68:71], v[116:119], v[92:95], 0
    v_add_u32 v3, s38, v3
    v_mfma_f32_16x16x32_bf16 v[64:67], v[116:119], v[88:91], 0
    v_add_u32 v4, s39, v4
    s_waitcnt lgkmcnt(9)
    v_mfma_f32_16x16x32_bf16 v[80:83], v[120:123], v[88:91], 0
    v_add_u32 v5, s39, v5
    v_mfma_f32_16x16x32_bf16 v[84:87], v[120:123], v[92:95], 0
    s_mov_b32 s36, 3
.p2align 3
L_m_mm85:
    s_waitcnt lgkmcnt(7)
    v_mfma_f32_16x16x32_bf16 v[16:19], v[140:143], v[124:127], v[16:19]
    s_waitcnt vmcnt(0) lgkmcnt(0)
    s_barrier
    ds_read_b128 v[88:91], v2 offset:0
    v_mfma_f32_16x16x32_bf16 v[20:23], v[140:143], v[128:131], v[20:23]
    ds_read_b128 v[104:107], v4 offset:0
    v_mfma_f32_16x16x32_bf16 v[24:27], v[140:143], v[132:135], v[24:27]
    ds_read_b128 v[92:95], v2 offset:2048
    v_mfma_f32_16x16x32_bf16 v[28:31], v[140:143], v[136:139], v[28:31]
    ds_read_b128 v[96:99], v3 offset:0
    v_mfma_f32_16x16x32_bf16 v[44:47], v[144:147], v[136:139], v[44:47]
    ds_read_b128 v[100:103], v3 offset:2048
    v_mfma_f32_16x16x32_bf16 v[40:43], v[144:147], v[132:135], v[40:43]
    ds_read_b128 v[108:111], v4 offset:2048
    v_mfma_f32_16x16x32_bf16 v[36:39], v[144:147], v[128:131], v[36:39]
    ds_read_b128 v[112:115], v4 offset:4096
    v_mfma_f32_16x16x32_bf16 v[32:35], v[144:147], v[124:127], v[32:35]
    ds_read_b128 v[116:119], v4 offset:6144
    v_mfma_f32_16x16x32_bf16 v[48:51], v[148:151], v[124:127], v[48:51]
    ds_read_b128 v[120:123], v5 offset:0
    v_mfma_f32_16x16x32_bf16 v[52:55], v[148:151], v[128:131], v[52:55]
    v_mfma_f32_16x16x32_bf16 v[56:59], v[148:151], v[132:135], v[56:59]
    v_mfma_f32_16x16x32_bf16 v[60:63], v[148:151], v[136:139], v[60:63]
    v_mfma_f32_16x16x32_bf16 v[76:79], v[152:155], v[136:139], v[76:79]
    v_mfma_f32_16x16x32_bf16 v[72:75], v[152:155], v[132:135], v[72:75]
    v_mfma_f32_16x16x32_bf16 v[68:71], v[152:155], v[128:131], v[68:71]
    v_mfma_f32_16x16x32_bf16 v[64:67], v[152:155], v[124:127], v[64:67]
    v_mfma_f32_16x16x32_bf16 v[80:83], v[156:159], v[124:127], v[80:83]
    v_mfma_f32_16x16x32_bf16 v[84:87], v[156:159], v[128:131], v[84:87]
    s_waitcnt lgkmcnt(7)
    v_mfma_f32_16x16x32_bf16 v[16:19], v[104:107], v[88:91], v[16:19]
    ds_read_b128 v[124:127], v2 offset:1024
    s_waitcnt lgkmcnt(7)
    v_mfma_f32_16x16x32_bf16 v[20:23], v[104:107], v[92:95], v[20:23]
    ds_read_b128 v[140:143], v4 offset:1024
    s_waitcnt lgkmcnt(7)
    v_mfma_f32_16x16x32_bf16 v[24:27], v[104:107], v[96:99], v[24:27]
    ds_read_b128 v[128:131], v2 offset:3072
    s_waitcnt lgkmcnt(7)
    v_mfma_f32_16x16x32_bf16 v[28:31], v[104:107], v[100:103], v[28:31]
    ds_read_b128 v[132:135], v3 offset:1024
    s_waitcnt lgkmcnt(7)
    v_mfma_f32_16x16x32_bf16 v[44:47], v[108:111], v[100:103], v[44:47]
    ds_read_b128 v[136:139], v3 offset:3072
    v_mfma_f32_16x16x32_bf16 v[40:43], v[108:111], v[96:99], v[40:43]
    ds_read_b128 v[144:147], v4 offset:3072
    v_mfma_f32_16x16x32_bf16 v[36:39], v[108:111], v[92:95], v[36:39]
    ds_read_b128 v[148:151], v4 offset:5120
    v_mfma_f32_16x16x32_bf16 v[32:35], v[108:111], v[88:91], v[32:35]
    ds_read_b128 v[152:155], v4 offset:7168
    s_waitcnt lgkmcnt(10)
    v_mfma_f32_16x16x32_bf16 v[48:51], v[112:115], v[88:91], v[48:51]
    ds_read_b128 v[156:159], v5 offset:1024
    v_mfma_f32_16x16x32_bf16 v[52:55], v[112:115], v[92:95], v[52:55]
    s_add_u32 s37, s37, 1
    v_mfma_f32_16x16x32_bf16 v[56:59], v[112:115], v[96:99], v[56:59]
    s_cmp_eq_u32 s37, 4
    s_cselect_b32 s37, 0, s37
    v_mfma_f32_16x16x32_bf16 v[60:63], v[112:115], v[100:103], v[60:63]
    s_cselect_b32 s38, s40, 16384
    s_waitcnt lgkmcnt(10)
    v_mfma_f32_16x16x32_bf16 v[76:79], v[116:119], v[100:103], v[76:79]
    s_cselect_b32 s39, s41, 18432
    v_mfma_f32_16x16x32_bf16 v[72:75], v[116:119], v[96:99], v[72:75]
    v_add_u32 v2, s38, v2
    v_mfma_f32_16x16x32_bf16 v[68:71], v[116:119], v[92:95], v[68:71]
    v_add_u32 v3, s38, v3
    v_mfma_f32_16x16x32_bf16 v[64:67], v[116:119], v[88:91], v[64:67]
    v_add_u32 v4, s39, v4
    s_waitcnt lgkmcnt(9)
    v_mfma_f32_16x16x32_bf16 v[80:83], v[120:123], v[88:91], v[80:83]
    v_add_u32 v5, s39, v5
    v_mfma_f32_16x16x32_bf16 v[84:87], v[120:123], v[92:95], v[84:87]
    s_waitcnt lgkmcnt(7)
    v_mfma_f32_16x16x32_bf16 v[16:19], v[140:143], v[124:127], v[16:19]
    s_waitcnt vmcnt(0) lgkmcnt(0)
    s_barrier
    ds_read_b128 v[88:91], v2 offset:0
    v_mfma_f32_16x16x32_bf16 v[20:23], v[140:143], v[128:131], v[20:23]
    ds_read_b128 v[104:107], v4 offset:0
    v_mfma_f32_16x16x32_bf16 v[24:27], v[140:143], v[132:135], v[24:27]
    ds_read_b128 v[92:95], v2 offset:2048
    v_mfma_f32_16x16x32_bf16 v[28:31], v[140:143], v[136:139], v[28:31]
    ds_read_b128 v[96:99], v3 offset:0
    v_mfma_f32_16x16x32_bf16 v[44:47], v[144:147], v[136:139], v[44:47]
    ds_read_b128 v[100:103], v3 offset:2048
    v_mfma_f32_16x16x32_bf16 v[40:43], v[144:147], v[132:135], v[40:43]
    ds_read_b128 v[108:111], v4 offset:2048
    v_mfma_f32_16x16x32_bf16 v[36:39], v[144:147], v[128:131], v[36:39]
    ds_read_b128 v[112:115], v4 offset:4096
    v_mfma_f32_16x16x32_bf16 v[32:35], v[144:147], v[124:127], v[32:35]
    ds_read_b128 v[116:119], v4 offset:6144
    v_mfma_f32_16x16x32_bf16 v[48:51], v[148:151], v[124:127], v[48:51]
    ds_read_b128 v[120:123], v5 offset:0
    v_mfma_f32_16x16x32_bf16 v[52:55], v[148:151], v[128:131], v[52:55]
    v_mfma_f32_16x16x32_bf16 v[56:59], v[148:151], v[132:135], v[56:59]
    v_mfma_f32_16x16x32_bf16 v[60:63], v[148:151], v[136:139], v[60:63]
    v_mfma_f32_16x16x32_bf16 v[76:79], v[152:155], v[136:139], v[76:79]
    v_mfma_f32_16x16x32_bf16 v[72:75], v[152:155], v[132:135], v[72:75]
    v_mfma_f32_16x16x32_bf16 v[68:71], v[152:155], v[128:131], v[68:71]
    v_mfma_f32_16x16x32_bf16 v[64:67], v[152:155], v[124:127], v[64:67]
    v_mfma_f32_16x16x32_bf16 v[80:83], v[156:159], v[124:127], v[80:83]
    v_mfma_f32_16x16x32_bf16 v[84:87], v[156:159], v[128:131], v[84:87]
    s_waitcnt lgkmcnt(7)
    v_mfma_f32_16x16x32_bf16 v[16:19], v[104:107], v[88:91], v[16:19]
    ds_read_b128 v[124:127], v2 offset:1024
    s_waitcnt lgkmcnt(7)
    v_mfma_f32_16x16x32_bf16 v[20:23], v[104:107], v[92:95], v[20:23]
    ds_read_b128 v[140:143], v4 offset:1024
    s_waitcnt lgkmcnt(7)
    v_mfma_f32_16x16x32_bf16 v[24:27], v[104:107], v[96:99], v[24:27]
    ds_read_b128 v[128:131], v2 offset:3072
    s_waitcnt lgkmcnt(7)
    v_mfma_f32_16x16x32_bf16 v[28:31], v[104:107], v[100:103], v[28:31]
    ds_read_b128 v[132:135], v3 offset:1024
    s_waitcnt lgkmcnt(7)
    v_mfma_f32_16x16x32_bf16 v[44:47], v[108:111], v[100:103], v[44:47]
    ds_read_b128 v[136:139], v3 offset:3072
    v_mfma_f32_16x16x32_bf16 v[40:43], v[108:111], v[96:99], v[40:43]
    ds_read_b128 v[144:147], v4 offset:3072
    v_mfma_f32_16x16x32_bf16 v[36:39], v[108:111], v[92:95], v[36:39]
    ds_read_b128 v[148:151], v4 offset:5120
    v_mfma_f32_16x16x32_bf16 v[32:35], v[108:111], v[88:91], v[32:35]
    ds_read_b128 v[152:155], v4 offset:7168
    s_waitcnt lgkmcnt(10)
    v_mfma_f32_16x16x32_bf16 v[48:51], v[112:115], v[88:91], v[48:51]
    ds_read_b128 v[156:159], v5 offset:1024
    v_mfma_f32_16x16x32_bf16 v[52:55], v[112:115], v[92:95], v[52:55]
    s_add_u32 s37, s37, 1
    s_cmp_eq_u32 s37, 4
    s_cselect_b32 s37, 0, s37
    v_mfma_f32_16x16x32_bf16 v[56:59], v[112:115], v[96:99], v[56:59]
    s_cselect_b32 s38, s40, 16384
    v_mfma_f32_16x16x32_bf16 v[60:63], v[112:115], v[100:103], v[60:63]
    s_cselect_b32 s39, s41, 18432
    s_waitcnt lgkmcnt(10)
    v_mfma_f32_16x16x32_bf16 v[76:79], v[116:119], v[100:103], v[76:79]
    v_add_u32 v2, s38, v2
    v_mfma_f32_16x16x32_bf16 v[72:75], v[116:119], v[96:99], v[72:75]
    v_add_u32 v3, s38, v3
    v_mfma_f32_16x16x32_bf16 v[68:71], v[116:119], v[92:95], v[68:71]
    v_add_u32 v4, s39, v4
    v_mfma_f32_16x16x32_bf16 v[64:67], v[116:119], v[88:91], v[64:67]
    v_add_u32 v5, s39, v5
    s_waitcnt lgkmcnt(9)
    v_mfma_f32_16x16x32_bf16 v[80:83], v[120:123], v[88:91], v[80:83]
    s_sub_u32 s36, s36, 1
    v_mfma_f32_16x16x32_bf16 v[84:87], v[120:123], v[92:95], v[84:87]
    s_cmp_lg_u32 s36, 0
    s_cbranch_scc1 L_m_mm85
    s_waitcnt lgkmcnt(7)
    v_mfma_f32_16x16x32_bf16 v[16:19], v[140:143], v[124:127], v[16:19]
    ds_read_b128 v[88:91], v2 offset:0
    s_waitcnt lgkmcnt(7)
    v_mfma_f32_16x16x32_bf16 v[20:23], v[140:143], v[128:131], v[20:23]
    ds_read_b128 v[104:107], v4 offset:0
    s_waitcnt lgkmcnt(7)
    v_mfma_f32_16x16x32_bf16 v[24:27], v[140:143], v[132:135], v[24:27]
    ds_read_b128 v[92:95], v2 offset:2048
    s_waitcnt lgkmcnt(7)
    v_mfma_f32_16x16x32_bf16 v[28:31], v[140:143], v[136:139], v[28:31]
    ds_read_b128 v[96:99], v3 offset:0
    s_waitcnt lgkmcnt(7)
    v_mfma_f32_16x16x32_bf16 v[44:47], v[144:147], v[136:139], v[44:47]
    ds_read_b128 v[100:103], v3 offset:2048
    v_mfma_f32_16x16x32_bf16 v[40:43], v[144:147], v[132:135], v[40:43]
    ds_read_b128 v[108:111], v4 offset:2048
    v_mfma_f32_16x16x32_bf16 v[36:39], v[144:147], v[128:131], v[36:39]
    ds_read_b128 v[112:115], v4 offset:4096
    v_mfma_f32_16x16x32_bf16 v[32:35], v[144:147], v[124:127], v[32:35]
    ds_read_b128 v[116:119], v4 offset:6144
    s_waitcnt lgkmcnt(10)
    v_mfma_f32_16x16x32_bf16 v[48:51], v[148:151], v[124:127], v[48:51]
    ds_read_b128 v[120:123], v5 offset:0
    v_mfma_f32_16x16x32_bf16 v[52:55], v[148:151], v[128:131], v[52:55]
    v_mfma_f32_16x16x32_bf16 v[56:59], v[148:151], v[132:135], v[56:59]
    v_mfma_f32_16x16x32_bf16 v[60:63], v[148:151], v[136:139], v[60:63]
    s_waitcnt lgkmcnt(10)
    v_mfma_f32_16x16x32_bf16 v[76:79], v[152:155], v[136:139], v[76:79]
    v_mfma_f32_16x16x32_bf16 v[72:75], v[152:155], v[132:135], v[72:75]
    v_mfma_f32_16x16x32_bf16 v[68:71], v[152:155], v[128:131], v[68:71]
    v_mfma_f32_16x16x32_bf16 v[64:67], v[152:155], v[124:127], v[64:67]
    s_waitcnt lgkmcnt(9)
    v_mfma_f32_16x16x32_bf16 v[80:83], v[156:159], v[124:127], v[80:83]
    v_mfma_f32_16x16x32_bf16 v[84:87], v[156:159], v[128:131], v[84:87]
    s_waitcnt lgkmcnt(7)
    v_mfma_f32_16x16x32_bf16 v[16:19], v[104:107], v[88:91], v[16:19]
    ds_read_b128 v[124:127], v2 offset:1024
    s_waitcnt lgkmcnt(7)
    v_mfma_f32_16x16x32_bf16 v[20:23], v[104:107], v[92:95], v[20:23]
    ds_read_b128 v[140:143], v4 offset:1024
    s_waitcnt lgkmcnt(7)
    v_mfma_f32_16x16x32_bf16 v[24:27], v[104:107], v[96:99], v[24:27]
    ds_read_b128 v[128:131], v2 offset:3072
    s_waitcnt lgkmcnt(7)
    v_mfma_f32_16x16x32_bf16 v[28:31], v[104:107], v[100:103], v[28:31]
    ds_read_b128 v[132:135], v3 offset:1024
    s_waitcnt lgkmcnt(7)
    v_mfma_f32_16x16x32_bf16 v[44:47], v[108:111], v[100:103], v[44:47]
    ds_read_b128 v[136:139], v3 offset:3072
    v_mfma_f32_16x16x32_bf16 v[40:43], v[108:111], v[96:99], v[40:43]
    ds_read_b128 v[144:147], v4 offset:3072
    v_mfma_f32_16x16x32_bf16 v[36:39], v[108:111], v[92:95], v[36:39]
    ds_read_b128 v[148:151], v4 offset:5120
    v_mfma_f32_16x16x32_bf16 v[32:35], v[108:111], v[88:91], v[32:35]
    ds_read_b128 v[152:155], v4 offset:7168
    s_waitcnt lgkmcnt(10)
    v_mfma_f32_16x16x32_bf16 v[48:51], v[112:115], v[88:91], v[48:51]
    ds_read_b128 v[156:159], v5 offset:1024
    v_mfma_f32_16x16x32_bf16 v[52:55], v[112:115], v[92:95], v[52:55]
    s_add_u32 s37, s37, 1
    v_mfma_f32_16x16x32_bf16 v[56:59], v[112:115], v[96:99], v[56:59]
    s_cmp_eq_u32 s37, 4
    s_cselect_b32 s37, 0, s37
    v_mfma_f32_16x16x32_bf16 v[60:63], v[112:115], v[100:103], v[60:63]
    s_cselect_b32 s38, s40, 16384
    s_waitcnt lgkmcnt(10)
    v_mfma_f32_16x16x32_bf16 v[76:79], v[116:119], v[100:103], v[76:79]
    s_cselect_b32 s39, s41, 18432
    v_mfma_f32_16x16x32_bf16 v[72:75], v[116:119], v[96:99], v[72:75]
    v_add_u32 v2, s38, v2
    v_mfma_f32_16x16x32_bf16 v[68:71], v[116:119], v[92:95], v[68:71]
    v_add_u32 v3, s38, v3
    v_mfma_f32_16x16x32_bf16 v[64:67], v[116:119], v[88:91], v[64:67]
    v_add_u32 v4, s39, v4
    s_waitcnt lgkmcnt(9)
    v_mfma_f32_16x16x32_bf16 v[80:83], v[120:123], v[88:91], v[80:83]
    v_add_u32 v5, s39, v5
    v_mfma_f32_16x16x32_bf16 v[84:87], v[120:123], v[92:95], v[84:87]
    s_waitcnt lgkmcnt(7)
    v_mfma_f32_16x16x32_bf16 v[16:19], v[140:143], v[124:127], v[16:19]
    ds_read_b128 v[88:91], v2 offset:0
    s_waitcnt lgkmcnt(7)
    v_mfma_f32_16x16x32_bf16 v[20:23], v[140:143], v[128:131], v[20:23]
    ds_read_b128 v[104:107], v4 offset:0
    s_waitcnt lgkmcnt(7)
    v_mfma_f32_16x16x32_bf16 v[24:27], v[140:143], v[132:135], v[24:27]
    ds_read_b128 v[92:95], v2 offset:2048
    s_waitcnt lgkmcnt(7)
    v_mfma_f32_16x16x32_bf16 v[28:31], v[140:143], v[136:139], v[28:31]
    ds_read_b128 v[96:99], v3 offset:0
    s_waitcnt lgkmcnt(7)
    v_mfma_f32_16x16x32_bf16 v[44:47], v[144:147], v[136:139], v[44:47]
    ds_read_b128 v[100:103], v3 offset:2048
    v_mfma_f32_16x16x32_bf16 v[40:43], v[144:147], v[132:135], v[40:43]
    ds_read_b128 v[108:111], v4 offset:2048
    v_mfma_f32_16x16x32_bf16 v[36:39], v[144:147], v[128:131], v[36:39]
    ds_read_b128 v[112:115], v4 offset:4096
    v_mfma_f32_16x16x32_bf16 v[32:35], v[144:147], v[124:127], v[32:35]
    ds_read_b128 v[116:119], v4 offset:6144
    s_waitcnt lgkmcnt(10)
    v_mfma_f32_16x16x32_bf16 v[48:51], v[148:151], v[124:127], v[48:51]
    ds_read_b128 v[120:123], v5 offset:0
    v_mfma_f32_16x16x32_bf16 v[52:55], v[148:151], v[128:131], v[52:55]
    v_mfma_f32_16x16x32_bf16 v[56:59], v[148:151], v[132:135], v[56:59]
    v_mfma_f32_16x16x32_bf16 v[60:63], v[148:151], v[136:139], v[60:63]
    s_waitcnt lgkmcnt(10)
    v_mfma_f32_16x16x32_bf16 v[76:79], v[152:155], v[136:139], v[76:79]
    v_mfma_f32_16x16x32_bf16 v[72:75], v[152:155], v[132:135], v[72:75]
    v_mfma_f32_16x16x32_bf16 v[68:71], v[152:155], v[128:131], v[68:71]
    v_mfma_f32_16x16x32_bf16 v[64:67], v[152:155], v[124:127], v[64:67]
    s_waitcnt lgkmcnt(9)
    v_mfma_f32_16x16x32_bf16 v[80:83], v[156:159], v[124:127], v[80:83]
    v_mfma_f32_16x16x32_bf16 v[84:87], v[156:159], v[128:131], v[84:87]
    s_waitcnt lgkmcnt(7)
    v_mfma_f32_16x16x32_bf16 v[16:19], v[104:107], v[88:91], v[16:19]
    ds_read_b128 v[124:127], v2 offset:1024
    s_waitcnt lgkmcnt(7)
    v_mfma_f32_16x16x32_bf16 v[20:23], v[104:107], v[92:95], v[20:23]
    ds_read_b128 v[140:143], v4 offset:1024
    s_waitcnt lgkmcnt(7)
    v_mfma_f32_16x16x32_bf16 v[24:27], v[104:107], v[96:99], v[24:27]
    ds_read_b128 v[128:131], v2 offset:3072
    s_waitcnt lgkmcnt(7)
    v_mfma_f32_16x16x32_bf16 v[28:31], v[104:107], v[100:103], v[28:31]
    ds_read_b128 v[132:135], v3 offset:1024
    s_waitcnt lgkmcnt(7)
    v_mfma_f32_16x16x32_bf16 v[44:47], v[108:111], v[100:103], v[44:47]
    ds_read_b128 v[136:139], v3 offset:3072
    v_mfma_f32_16x16x32_bf16 v[40:43], v[108:111], v[96:99], v[40:43]
    ds_read_b128 v[144:147], v4 offset:3072
    v_mfma_f32_16x16x32_bf16 v[36:39], v[108:111], v[92:95], v[36:39]
    ds_read_b128 v[148:151], v4 offset:5120
    v_mfma_f32_16x16x32_bf16 v[32:35], v[108:111], v[88:91], v[32:35]
    ds_read_b128 v[152:155], v4 offset:7168
    s_waitcnt lgkmcnt(10)
    v_mfma_f32_16x16x32_bf16 v[48:51], v[112:115], v[88:91], v[48:51]
    ds_read_b128 v[156:159], v5 offset:1024
    v_mfma_f32_16x16x32_bf16 v[52:55], v[112:115], v[92:95], v[52:55]
    s_add_u32 s37, s37, 1
    v_mfma_f32_16x16x32_bf16 v[56:59], v[112:115], v[96:99], v[56:59]
    s_cmp_eq_u32 s37, 4
    s_cselect_b32 s37, 0, s37
    v_mfma_f32_16x16x32_bf16 v[60:63], v[112:115], v[100:103], v[60:63]
    s_cselect_b32 s38, s40, 16384
    s_waitcnt lgkmcnt(10)
    v_mfma_f32_16x16x32_bf16 v[76:79], v[116:119], v[100:103], v[76:79]
    s_cselect_b32 s39, s41, 18432
    v_mfma_f32_16x16x32_bf16 v[72:75], v[116:119], v[96:99], v[72:75]
    v_add_u32 v2, s38, v2
    v_mfma_f32_16x16x32_bf16 v[68:71], v[116:119], v[92:95], v[68:71]
    v_add_u32 v3, s38, v3
    v_mfma_f32_16x16x32_bf16 v[64:67], v[116:119], v[88:91], v[64:67]
    v_add_u32 v4, s39, v4
    s_waitcnt lgkmcnt(9)
    v_mfma_f32_16x16x32_bf16 v[80:83], v[120:123], v[88:91], v[80:83]
    v_add_u32 v5, s39, v5
    v_mfma_f32_16x16x32_bf16 v[84:87], v[120:123], v[92:95], v[84:87]
    s_waitcnt lgkmcnt(7)
    v_mfma_f32_16x16x32_bf16 v[16:19], v[140:143], v[124:127], v[16:19]
    s_waitcnt lgkmcnt(6)
    v_mfma_f32_16x16x32_bf16 v[20:23], v[140:143], v[128:131], v[20:23]
    s_waitcnt lgkmcnt(5)
    v_mfma_f32_16x16x32_bf16 v[24:27], v[140:143], v[132:135], v[24:27]
    s_waitcnt lgkmcnt(4)
    v_mfma_f32_16x16x32_bf16 v[28:31], v[140:143], v[136:139], v[28:31]
    s_waitcnt lgkmcnt(3)
    v_mfma_f32_16x16x32_bf16 v[44:47], v[144:147], v[136:139], v[44:47]
    v_mfma_f32_16x16x32_bf16 v[40:43], v[144:147], v[132:135], v[40:43]
    v_mfma_f32_16x16x32_bf16 v[36:39], v[144:147], v[128:131], v[36:39]
    v_mfma_f32_16x16x32_bf16 v[32:35], v[144:147], v[124:127], v[32:35]
    s_waitcnt lgkmcnt(2)
    v_mfma_f32_16x16x32_bf16 v[48:51], v[148:151], v[124:127], v[48:51]
    v_mfma_f32_16x16x32_bf16 v[52:55], v[148:151], v[128:131], v[52:55]
    v_mfma_f32_16x16x32_bf16 v[56:59], v[148:151], v[132:135], v[56:59]
    v_mfma_f32_16x16x32_bf16 v[60:63], v[148:151], v[136:139], v[60:63]
    s_waitcnt lgkmcnt(1)
    v_mfma_f32_16x16x32_bf16 v[76:79], v[152:155], v[136:139], v[76:79]
    v_mfma_f32_16x16x32_bf16 v[72:75], v[152:155], v[132:135], v[72:75]
    v_mfma_f32_16x16x32_bf16 v[68:71], v[152:155], v[128:131], v[68:71]
    v_mfma_f32_16x16x32_bf16 v[64:67], v[152:155], v[124:127], v[64:67]
    s_waitcnt lgkmcnt(0)
    v_mfma_f32_16x16x32_bf16 v[80:83], v[156:159], v[124:127], v[80:83]
    v_mfma_f32_16x16x32_bf16 v[84:87], v[156:159], v[128:131], v[84:87]
    s_setprio 0
    ds_read_b32 v160, v12 offset:0
    ds_read_b32 v162, v12 offset:64
    ds_read_b32 v164, v13 offset:0
    ds_read_b32 v166, v13 offset:64
    ds_read_b128 v[186:189], v14 offset:0
    ds_read_b128 v[190:193], v14 offset:64
    ds_read_b128 v[194:197], v14 offset:128
    ds_read_b128 v[198:201], v14 offset:192
    ds_read_b128 v[202:205], v15 offset:256
    v_mov_b32 v2, 163796
    v_mov_b32 v3, 1
    s_mov_b64 exec, 1
    ds_add_u32 v2, v3
    s_mov_b64 exec, -1
    s_waitcnt lgkmcnt(0)
    v_pk_fma_f32 v[16:17], v[16:17], v[160:161], v[186:187] op_sel_hi:[1,0,1]
    v_pk_fma_f32 v[18:19], v[18:19], v[160:161], v[188:189] op_sel_hi:[1,0,1]
    v_pk_fma_f32 v[20:21], v[20:21], v[162:163], v[186:187] op_sel_hi:[1,0,1]
    v_pk_fma_f32 v[22:23], v[22:23], v[162:163], v[188:189] op_sel_hi:[1,0,1]
    v_pk_mul_f32 v[218:219], v[16:17], v[16:17]
    v_pk_mul_f32 v[220:221], v[18:19], v[18:19]
    v_pk_mul_f32 v[222:223], v[20:21], v[20:21]
    v_pk_mul_f32 v[224:225], v[22:23], v[22:23]
    v_pk_fma_f32 v[218:219], v[218:219], v[184:185], v[182:183]
    v_pk_fma_f32 v[220:221], v[220:221], v[184:185], v[182:183]
    v_pk_fma_f32 v[222:223], v[222:223], v[184:185], v[182:183]
    v_pk_fma_f32 v[224:225], v[224:225], v[184:185], v[182:183]
    v_pk_mul_f32 v[218:219], v[218:219], v[16:17]
    v_pk_mul_f32 v[220:221], v[220:221], v[18:19]
    v_pk_mul_f32 v[222:223], v[222:223], v[20:21]
    v_pk_mul_f32 v[224:225], v[224:225], v[22:23]
    v_exp_f32 v218, v218
    v_exp_f32 v220, v220
    v_exp_f32 v222, v222
    v_exp_f32 v224, v224
    v_exp_f32 v219, v219
    v_exp_f32 v221, v221
    v_exp_f32 v223, v223
    v_exp_f32 v225, v225
    v_pk_add_f32 v[218:219], v[218:219], 1.0 op_sel_hi:[1,0]
    v_pk_add_f32 v[220:221], v[220:221], 1.0 op_sel_hi:[1,0]
    v_pk_add_f32 v[222:223], v[222:223], 1.0 op_sel_hi:[1,0]
    v_pk_add_f32 v[224:225], v[224:225], 1.0 op_sel_hi:[1,0]
    v_rcp_f32 v218, v218
    v_rcp_f32 v220, v220
    v_rcp_f32 v222, v222
    v_rcp_f32 v224, v224
    v_rcp_f32 v219, v219
    v_rcp_f32 v221, v221
    v_rcp_f32 v223, v223
    v_rcp_f32 v225, v225
    v_pk_mul_f32 v[16:17], v[16:17], v[218:219]
    v_pk_mul_f32 v[18:19], v[18:19], v[220:221]
    v_pk_mul_f32 v[20:21], v[20:21], v[222:223]
    v_pk_mul_f32 v[22:23], v[22:23], v[224:225]
    v_cvt_pk_bf16_f32 v124, v16, v17
    v_cvt_pk_bf16_f32 v125, v18, v19
    v_cvt_pk_bf16_f32 v126, v20, v21
    v_cvt_pk_bf16_f32 v127, v22, v23
    v_pk_fma_f32 v[24:25], v[24:25], v[164:165], v[186:187] op_sel_hi:[1,0,1]
    v_pk_fma_f32 v[26:27], v[26:27], v[164:165], v[188:189] op_sel_hi:[1,0,1]
    v_pk_fma_f32 v[28:29], v[28:29], v[166:167], v[186:187] op_sel_hi:[1,0,1]
    v_pk_fma_f32 v[30:31], v[30:31], v[166:167], v[188:189] op_sel_hi:[1,0,1]
    v_pk_mul_f32 v[218:219], v[24:25], v[24:25]
    v_pk_mul_f32 v[220:221], v[26:27], v[26:27]
    v_pk_mul_f32 v[222:223], v[28:29], v[28:29]
    v_pk_mul_f32 v[224:225], v[30:31], v[30:31]
    v_pk_fma_f32 v[218:219], v[218:219], v[184:185], v[182:183]
    v_pk_fma_f32 v[220:221], v[220:221], v[184:185], v[182:183]
    v_pk_fma_f32 v[222:223], v[222:223], v[184:185], v[182:183]
    v_pk_fma_f32 v[224:225], v[224:225], v[184:185], v[182:183]
    v_pk_mul_f32 v[218:219], v[218:219], v[24:25]
    v_pk_mul_f32 v[220:221], v[220:221], v[26:27]
    v_pk_mul_f32 v[222:223], v[222:223], v[28:29]
    v_pk_mul_f32 v[224:225], v[224:225], v[30:31]
    v_exp_f32 v218, v218
    v_exp_f32 v220, v220
    v_exp_f32 v222, v222
    v_exp_f32 v224, v224
    v_exp_f32 v219, v219
    v_exp_f32 v221, v221
    v_exp_f32 v223, v223
    v_exp_f32 v225, v225
    v_pk_add_f32 v[218:219], v[218:219], 1.0 op_sel_hi:[1,0]
    v_pk_add_f32 v[220:221], v[220:221], 1.0 op_sel_hi:[1,0]
    v_pk_add_f32 v[222:223], v[222:223], 1.0 op_sel_hi:[1,0]
    v_pk_add_f32 v[224:225], v[224:225], 1.0 op_sel_hi:[1,0]
    v_rcp_f32 v218, v218
    v_rcp_f32 v220, v220
    v_rcp_f32 v222, v222
    v_rcp_f32 v224, v224
    v_rcp_f32 v219, v219
    v_rcp_f32 v221, v221
    v_rcp_f32 v223, v223
    v_rcp_f32 v225, v225
    v_pk_mul_f32 v[24:25], v[24:25], v[218:219]
    v_pk_mul_f32 v[26:27], v[26:27], v[220:221]
    v_pk_mul_f32 v[28:29], v[28:29], v[222:223]
    v_pk_mul_f32 v[30:31], v[30:31], v[224:225]
    v_cvt_pk_bf16_f32 v128, v24, v25
    v_cvt_pk_bf16_f32 v129, v26, v27
    v_cvt_pk_bf16_f32 v130, v28, v29
    v_cvt_pk_bf16_f32 v131, v30, v31
    v_pk_fma_f32 v[32:33], v[32:33], v[160:161], v[190:191] op_sel_hi:[1,0,1]
    v_pk_fma_f32 v[34:35], v[34:35], v[160:161], v[192:193] op_sel_hi:[1,0,1]
    v_pk_fma_f32 v[36:37], v[36:37], v[162:163], v[190:191] op_sel_hi:[1,0,1]
    v_pk_fma_f32 v[38:39], v[38:39], v[162:163], v[192:193] op_sel_hi:[1,0,1]
    v_pk_mul_f32 v[218:219], v[32:33], v[32:33]
    v_pk_mul_f32 v[220:221], v[34:35], v[34:35]
    v_pk_mul_f32 v[222:223], v[36:37], v[36:37]
    v_pk_mul_f32 v[224:225], v[38:39], v[38:39]
    v_pk_fma_f32 v[218:219], v[218:219], v[184:185], v[182:183]
    v_pk_fma_f32 v[220:221], v[220:221], v[184:185], v[182:183]
    v_pk_fma_f32 v[222:223], v[222:223], v[184:185], v[182:183]
    v_pk_fma_f32 v[224:225], v[224:225], v[184:185], v[182:183]
    v_pk_mul_f32 v[218:219], v[218:219], v[32:33]
    v_pk_mul_f32 v[220:221], v[220:221], v[34:35]
    v_pk_mul_f32 v[222:223], v[222:223], v[36:37]
    v_pk_mul_f32 v[224:225], v[224:225], v[38:39]
    v_exp_f32 v218, v218
    v_exp_f32 v220, v220
    v_exp_f32 v222, v222
    v_exp_f32 v224, v224
    v_exp_f32 v219, v219
    v_exp_f32 v221, v221
    v_exp_f32 v223, v223
    v_exp_f32 v225, v225
    v_pk_add_f32 v[218:219], v[218:219], 1.0 op_sel_hi:[1,0]
    v_pk_add_f32 v[220:221], v[220:221], 1.0 op_sel_hi:[1,0]
    v_pk_add_f32 v[222:223], v[222:223], 1.0 op_sel_hi:[1,0]
    v_pk_add_f32 v[224:225], v[224:225], 1.0 op_sel_hi:[1,0]
    v_rcp_f32 v218, v218
    v_rcp_f32 v220, v220
    v_rcp_f32 v222, v222
    v_rcp_f32 v224, v224
    v_rcp_f32 v219, v219
    v_rcp_f32 v221, v221
    v_rcp_f32 v223, v223
    v_rcp_f32 v225, v225
    v_pk_mul_f32 v[32:33], v[32:33], v[218:219]
    v_pk_mul_f32 v[34:35], v[34:35], v[220:221]
    v_pk_mul_f32 v[36:37], v[36:37], v[222:223]
    v_pk_mul_f32 v[38:39], v[38:39], v[224:225]
    v_cvt_pk_bf16_f32 v132, v32, v33
    v_cvt_pk_bf16_f32 v133, v34, v35
    v_cvt_pk_bf16_f32 v134, v36, v37
    v_cvt_pk_bf16_f32 v135, v38, v39
    v_pk_fma_f32 v[40:41], v[40:41], v[164:165], v[190:191] op_sel_hi:[1,0,1]
    v_pk_fma_f32 v[42:43], v[42:43], v[164:165], v[192:193] op_sel_hi:[1,0,1]
    v_pk_fma_f32 v[44:45], v[44:45], v[166:167], v[190:191] op_sel_hi:[1,0,1]
    v_pk_fma_f32 v[46:47], v[46:47], v[166:167], v[192:193] op_sel_hi:[1,0,1]
    v_pk_mul_f32 v[218:219], v[40:41], v[40:41]
    v_pk_mul_f32 v[220:221], v[42:43], v[42:43]
    v_pk_mul_f32 v[222:223], v[44:45], v[44:45]
    v_pk_mul_f32 v[224:225], v[46:47], v[46:47]
    v_pk_fma_f32 v[218:219], v[218:219], v[184:185], v[182:183]
    v_pk_fma_f32 v[220:221], v[220:221], v[184:185], v[182:183]
    v_pk_fma_f32 v[222:223], v[222:223], v[184:185], v[182:183]
    v_pk_fma_f32 v[224:225], v[224:225], v[184:185], v[182:183]
    v_pk_mul_f32 v[218:219], v[218:219], v[40:41]
    v_pk_mul_f32 v[220:221], v[220:221], v[42:43]
    v_pk_mul_f32 v[222:223], v[222:223], v[44:45]
    v_pk_mul_f32 v[224:225], v[224:225], v[46:47]
    v_exp_f32 v218, v218
    v_exp_f32 v220, v220
    v_exp_f32 v222, v222
    v_exp_f32 v224, v224
    v_exp_f32 v219, v219
    v_exp_f32 v221, v221
    v_exp_f32 v223, v223
    v_exp_f32 v225, v225
    v_pk_add_f32 v[218:219], v[218:219], 1.0 op_sel_hi:[1,0]
    v_pk_add_f32 v[220:221], v[220:221], 1.0 op_sel_hi:[1,0]
    v_pk_add_f32 v[222:223], v[222:223], 1.0 op_sel_hi:[1,0]
    v_pk_add_f32 v[224:225], v[224:225], 1.0 op_sel_hi:[1,0]
    v_rcp_f32 v218, v218
    v_rcp_f32 v220, v220
    v_rcp_f32 v222, v222
    v_rcp_f32 v224, v224
    v_rcp_f32 v219, v219
    v_rcp_f32 v221, v221
    v_rcp_f32 v223, v223
    v_rcp_f32 v225, v225
    v_pk_mul_f32 v[40:41], v[40:41], v[218:219]
    v_pk_mul_f32 v[42:43], v[42:43], v[220:221]
    v_pk_mul_f32 v[44:45], v[44:45], v[222:223]
    v_pk_mul_f32 v[46:47], v[46:47], v[224:225]
    v_cvt_pk_bf16_f32 v136, v40, v41
    v_cvt_pk_bf16_f32 v137, v42, v43
    v_cvt_pk_bf16_f32 v138, v44, v45
    v_cvt_pk_bf16_f32 v139, v46, v47
    v_pk_fma_f32 v[48:49], v[48:49], v[160:161], v[194:195] op_sel_hi:[1,0,1]
    v_pk_fma_f32 v[50:51], v[50:51], v[160:161], v[196:197] op_sel_hi:[1,0,1]
    v_pk_fma_f32 v[52:53], v[52:53], v[162:163], v[194:195] op_sel_hi:[1,0,1]
    v_pk_fma_f32 v[54:55], v[54:55], v[162:163], v[196:197] op_sel_hi:[1,0,1]
    v_pk_mul_f32 v[218:219], v[48:49], v[48:49]
    v_pk_mul_f32 v[220:221], v[50:51], v[50:51]
    v_pk_mul_f32 v[222:223], v[52:53], v[52:53]
    v_pk_mul_f32 v[224:225], v[54:55], v[54:55]
    v_pk_fma_f32 v[218:219], v[218:219], v[184:185], v[182:183]
    v_pk_fma_f32 v[220:221], v[220:221], v[184:185], v[182:183]
    v_pk_fma_f32 v[222:223], v[222:223], v[184:185], v[182:183]
    v_pk_fma_f32 v[224:225], v[224:225], v[184:185], v[182:183]
    v_pk_mul_f32 v[218:219], v[218:219], v[48:49]
    v_pk_mul_f32 v[220:221], v[220:221], v[50:51]
    v_pk_mul_f32 v[222:223], v[222:223], v[52:53]
    v_pk_mul_f32 v[224:225], v[224:225], v[54:55]
    v_exp_f32 v218, v218
    v_exp_f32 v220, v220
    v_exp_f32 v222, v222
    v_exp_f32 v224, v224
    v_exp_f32 v219, v219
    v_exp_f32 v221, v221
    v_exp_f32 v223, v223
    v_exp_f32 v225, v225
    v_pk_add_f32 v[218:219], v[218:219], 1.0 op_sel_hi:[1,0]
    v_pk_add_f32 v[220:221], v[220:221], 1.0 op_sel_hi:[1,0]
    v_pk_add_f32 v[222:223], v[222:223], 1.0 op_sel_hi:[1,0]
    v_pk_add_f32 v[224:225], v[224:225], 1.0 op_sel_hi:[1,0]
    v_rcp_f32 v218, v218
    v_rcp_f32 v220, v220
    v_rcp_f32 v222, v222
    v_rcp_f32 v224, v224
    v_rcp_f32 v219, v219
    v_rcp_f32 v221, v221
    v_rcp_f32 v223, v223
    v_rcp_f32 v225, v225
    v_pk_mul_f32 v[48:49], v[48:49], v[218:219]
    v_pk_mul_f32 v[50:51], v[50:51], v[220:221]
    v_pk_mul_f32 v[52:53], v[52:53], v[222:223]
    v_pk_mul_f32 v[54:55], v[54:55], v[224:225]
    v_cvt_pk_bf16_f32 v140, v48, v49
    v_cvt_pk_bf16_f32 v141, v50, v51
    v_cvt_pk_bf16_f32 v142, v52, v53
    v_cvt_pk_bf16_f32 v143, v54, v55
    v_pk_fma_f32 v[56:57], v[56:57], v[164:165], v[194:195] op_sel_hi:[1,0,1]
    v_pk_fma_f32 v[58:59], v[58:59], v[164:165], v[196:197] op_sel_hi:[1,0,1]
    v_pk_fma_f32 v[60:61], v[60:61], v[166:167], v[194:195] op_sel_hi:[1,0,1]
    v_pk_fma_f32 v[62:63], v[62:63], v[166:167], v[196:197] op_sel_hi:[1,0,1]
    v_pk_mul_f32 v[218:219], v[56:57], v[56:57]
    v_pk_mul_f32 v[220:221], v[58:59], v[58:59]
    v_pk_mul_f32 v[222:223], v[60:61], v[60:61]
    v_pk_mul_f32 v[224:225], v[62:63], v[62:63]
    v_pk_fma_f32 v[218:219], v[218:219], v[184:185], v[182:183]
    v_pk_fma_f32 v[220:221], v[220:221], v[184:185], v[182:183]
    v_pk_fma_f32 v[222:223], v[222:223], v[184:185], v[182:183]
    v_pk_fma_f32 v[224:225], v[224:225], v[184:185], v[182:183]
    v_pk_mul_f32 v[218:219], v[218:219], v[56:57]
    v_pk_mul_f32 v[220:221], v[220:221], v[58:59]
    v_pk_mul_f32 v[222:223], v[222:223], v[60:61]
    v_pk_mul_f32 v[224:225], v[224:225], v[62:63]
    v_exp_f32 v218, v218
    v_exp_f32 v220, v220
    v_exp_f32 v222, v222
    v_exp_f32 v224, v224
    v_exp_f32 v219, v219
    v_exp_f32 v221, v221
    v_exp_f32 v223, v223
    v_exp_f32 v225, v225
    v_pk_add_f32 v[218:219], v[218:219], 1.0 op_sel_hi:[1,0]
    v_pk_add_f32 v[220:221], v[220:221], 1.0 op_sel_hi:[1,0]
    v_pk_add_f32 v[222:223], v[222:223], 1.0 op_sel_hi:[1,0]
    v_pk_add_f32 v[224:225], v[224:225], 1.0 op_sel_hi:[1,0]
    v_rcp_f32 v218, v218
    v_rcp_f32 v220, v220
    v_rcp_f32 v222, v222
    v_rcp_f32 v224, v224
    v_rcp_f32 v219, v219
    v_rcp_f32 v221, v221
    v_rcp_f32 v223, v223
    v_rcp_f32 v225, v225
    v_pk_mul_f32 v[56:57], v[56:57], v[218:219]
    v_pk_mul_f32 v[58:59], v[58:59], v[220:221]
    v_pk_mul_f32 v[60:61], v[60:61], v[222:223]
    v_pk_mul_f32 v[62:63], v[62:63], v[224:225]
    v_cvt_pk_bf16_f32 v144, v56, v57
    v_cvt_pk_bf16_f32 v145, v58, v59
    v_cvt_pk_bf16_f32 v146, v60, v61
    v_cvt_pk_bf16_f32 v147, v62, v63
    v_pk_fma_f32 v[64:65], v[64:65], v[160:161], v[198:199] op_sel_hi:[1,0,1]
    v_pk_fma_f32 v[66:67], v[66:67], v[160:161], v[200:201] op_sel_hi:[1,0,1]
    v_pk_fma_f32 v[68:69], v[68:69], v[162:163], v[198:199] op_sel_hi:[1,0,1]
    v_pk_fma_f32 v[70:71], v[70:71], v[162:163], v[200:201] op_sel_hi:[1,0,1]
    v_pk_mul_f32 v[218:219], v[64:65], v[64:65]
    v_pk_mul_f32 v[220:221], v[66:67], v[66:67]
    v_pk_mul_f32 v[222:223], v[68:69], v[68:69]
    v_pk_mul_f32 v[224:225], v[70:71], v[70:71]
    v_pk_fma_f32 v[218:219], v[218:219], v[184:185], v[182:183]
    v_pk_fma_f32 v[220:221], v[220:221], v[184:185], v[182:183]
    v_pk_fma_f32 v[222:223], v[222:223], v[184:185], v[182:183]
    v_pk_fma_f32 v[224:225], v[224:225], v[184:185], v[182:183]
    v_pk_mul_f32 v[218:219], v[218:219], v[64:65]
    v_pk_mul_f32 v[220:221], v[220:221], v[66:67]
    v_pk_mul_f32 v[222:223], v[222:223], v[68:69]
    v_pk_mul_f32 v[224:225], v[224:225], v[70:71]
    v_exp_f32 v218, v218
    v_exp_f32 v220, v220
    v_exp_f32 v222, v222
    v_exp_f32 v224, v224
    v_exp_f32 v219, v219
    v_exp_f32 v221, v221
    v_exp_f32 v223, v223
    v_exp_f32 v225, v225
    v_pk_add_f32 v[218:219], v[218:219], 1.0 op_sel_hi:[1,0]
    v_pk_add_f32 v[220:221], v[220:221], 1.0 op_sel_hi:[1,0]
    v_pk_add_f32 v[222:223], v[222:223], 1.0 op_sel_hi:[1,0]
    v_pk_add_f32 v[224:225], v[224:225], 1.0 op_sel_hi:[1,0]
    v_rcp_f32 v218, v218
    v_rcp_f32 v220, v220
    v_rcp_f32 v222, v222
    v_rcp_f32 v224, v224
    v_rcp_f32 v219, v219
    v_rcp_f32 v221, v221
    v_rcp_f32 v223, v223
    v_rcp_f32 v225, v225
    v_pk_mul_f32 v[64:65], v[64:65], v[218:219]
    v_pk_mul_f32 v[66:67], v[66:67], v[220:221]
    v_pk_mul_f32 v[68:69], v[68:69], v[222:223]
    v_pk_mul_f32 v[70:71], v[70:71], v[224:225]
    v_cvt_pk_bf16_f32 v148, v64, v65
    v_cvt_pk_bf16_f32 v149, v66, v67
    v_cvt_pk_bf16_f32 v150, v68, v69
    v_cvt_pk_bf16_f32 v151, v70, v71
    v_pk_fma_f32 v[72:73], v[72:73], v[164:165], v[198:199] op_sel_hi:[1,0,1]
    v_pk_fma_f32 v[74:75], v[74:75], v[164:165], v[200:201] op_sel_hi:[1,0,1]
    v_pk_fma_f32 v[76:77], v[76:77], v[166:167], v[198:199] op_sel_hi:[1,0,1]
    v_pk_fma_f32 v[78:79], v[78:79], v[166:167], v[200:201] op_sel_hi:[1,0,1]
    v_pk_mul_f32 v[218:219], v[72:73], v[72:73]
    v_pk_mul_f32 v[220:221], v[74:75], v[74:75]
    v_pk_mul_f32 v[222:223], v[76:77], v[76:77]
    v_pk_mul_f32 v[224:225], v[78:79], v[78:79]
    v_pk_fma_f32 v[218:219], v[218:219], v[184:185], v[182:183]
    v_pk_fma_f32 v[220:221], v[220:221], v[184:185], v[182:183]
    v_pk_fma_f32 v[222:223], v[222:223], v[184:185], v[182:183]
    v_pk_fma_f32 v[224:225], v[224:225], v[184:185], v[182:183]
    v_pk_mul_f32 v[218:219], v[218:219], v[72:73]
    v_pk_mul_f32 v[220:221], v[220:221], v[74:75]
    v_pk_mul_f32 v[222:223], v[222:223], v[76:77]
    v_pk_mul_f32 v[224:225], v[224:225], v[78:79]
    v_exp_f32 v218, v218
    v_exp_f32 v220, v220
    v_exp_f32 v222, v222
    v_exp_f32 v224, v224
    v_exp_f32 v219, v219
    v_exp_f32 v221, v221
    v_exp_f32 v223, v223
    v_exp_f32 v225, v225
    v_pk_add_f32 v[218:219], v[218:219], 1.0 op_sel_hi:[1,0]
    v_pk_add_f32 v[220:221], v[220:221], 1.0 op_sel_hi:[1,0]
    v_pk_add_f32 v[222:223], v[222:223], 1.0 op_sel_hi:[1,0]
    v_pk_add_f32 v[224:225], v[224:225], 1.0 op_sel_hi:[1,0]
    v_rcp_f32 v218, v218
    v_rcp_f32 v220, v220
    v_rcp_f32 v222, v222
    v_rcp_f32 v224, v224
    v_rcp_f32 v219, v219
    v_rcp_f32 v221, v221
    v_rcp_f32 v223, v223
    v_rcp_f32 v225, v225
    v_pk_mul_f32 v[72:73], v[72:73], v[218:219]
    v_pk_mul_f32 v[74:75], v[74:75], v[220:221]
    v_pk_mul_f32 v[76:77], v[76:77], v[222:223]
    v_pk_mul_f32 v[78:79], v[78:79], v[224:225]
    v_cvt_pk_bf16_f32 v152, v72, v73
    v_cvt_pk_bf16_f32 v153, v74, v75
    v_cvt_pk_bf16_f32 v154, v76, v77
    v_cvt_pk_bf16_f32 v155, v78, v79
    v_pk_fma_f32 v[80:81], v[80:81], v[160:161], v[202:203] op_sel_hi:[1,0,1]
    v_pk_fma_f32 v[82:83], v[82:83], v[160:161], v[204:205] op_sel_hi:[1,0,1]
    v_pk_fma_f32 v[84:85], v[84:85], v[162:163], v[202:203] op_sel_hi:[1,0,1]
    v_pk_fma_f32 v[86:87], v[86:87], v[162:163], v[204:205] op_sel_hi:[1,0,1]
    v_pk_mul_f32 v[218:219], v[80:81], v[80:81]
    v_pk_mul_f32 v[220:221], v[82:83], v[82:83]
    v_pk_mul_f32 v[222:223], v[84:85], v[84:85]
    v_pk_mul_f32 v[224:225], v[86:87], v[86:87]
    v_pk_fma_f32 v[218:219], v[218:219], v[184:185], v[182:183]
    v_pk_fma_f32 v[220:221], v[220:221], v[184:185], v[182:183]
    v_pk_fma_f32 v[222:223], v[222:223], v[184:185], v[182:183]
    v_pk_fma_f32 v[224:225], v[224:225], v[184:185], v[182:183]
    v_pk_mul_f32 v[218:219], v[218:219], v[80:81]
    v_pk_mul_f32 v[220:221], v[220:221], v[82:83]
    v_pk_mul_f32 v[222:223], v[222:223], v[84:85]
    v_pk_mul_f32 v[224:225], v[224:225], v[86:87]
    v_exp_f32 v218, v218
    v_exp_f32 v220, v220
    v_exp_f32 v222, v222
    v_exp_f32 v224, v224
    v_exp_f32 v219, v219
    v_exp_f32 v221, v221
    v_exp_f32 v223, v223
    v_exp_f32 v225, v225
    v_pk_add_f32 v[218:219], v[218:219], 1.0 op_sel_hi:[1,0]
    v_pk_add_f32 v[220:221], v[220:221], 1.0 op_sel_hi:[1,0]
    v_pk_add_f32 v[222:223], v[222:223], 1.0 op_sel_hi:[1,0]
    v_pk_add_f32 v[224:225], v[224:225], 1.0 op_sel_hi:[1,0]
    v_rcp_f32 v218, v218
    v_rcp_f32 v220, v220
    v_rcp_f32 v222, v222
    v_rcp_f32 v224, v224
    v_rcp_f32 v219, v219
    v_rcp_f32 v221, v221
    v_rcp_f32 v223, v223
    v_rcp_f32 v225, v225
    v_pk_mul_f32 v[80:81], v[80:81], v[218:219]
    v_pk_mul_f32 v[82:83], v[82:83], v[220:221]
    v_pk_mul_f32 v[84:85], v[84:85], v[222:223]
    v_pk_mul_f32 v[86:87], v[86:87], v[224:225]
    v_cvt_pk_bf16_f32 v156, v80, v81
    v_cvt_pk_bf16_f32 v157, v82, v83
    v_cvt_pk_bf16_f32 v158, v84, v85
    v_cvt_pk_bf16_f32 v159, v86, v87
    s_branch L_p4_end
L_p4_g0:
    s_setprio 1
    s_and_b32 s16, s19, 1
    s_xor_b32 s12, s19, 1
    s_lshl_b32 s13, s19, 12
    s_lshl_b32 s14, s12, 12
    s_add_u32 s13, s13, 0
    s_add_u32 s14, s14, 0
    s_mul_i32 s15, s16, 10240
    s_add_u32 s15, s15, 65536
    v_lshlrev_b32 v6, 4, v1
    v_add_u32 v2, s13, v6
    v_add_u32 v3, s14, v6
    v_add_u32 v4, s15, v6
    v_add_u32 v5, 73728, v6
    s_lshl_b32 s10, s21, 2
    s_add_u32 s11, s19, s10
    s_add_u32 s17, s12, s10
    s_mul_i32 s13, s22, 9
    s_mul_i32 s14, s16, 5
    s_add_u32 s14, s14, s13
    s_lshl_b32 s51, s19, 7
    s_lshl_b32 s52, s12, 7
    s_mul_i32 s53, s16, 320
    v_mov_b32 v182, 3222493025
    v_mov_b32 v183, v182
    v_mov_b32 v184, 3184710632
    v_mov_b32 v185, v184
    v_lshrrev_b32 v6, 4, v1
    v_and_b32 v7, 15, v1
    v_readlane_b32 s60, v245, 12
    v_readlane_b32 s61, v246, 12
    s_nop 3
    s_add_u32 s32, s92, 14319616
    s_addc_u32 s33, s93, 0
    s_mov_b32 s34, 9437184
    s_mov_b32 s35, 0x20000
    s_lshl_b32 s47, s14, 16
    s_lshl_b32 s10, s11, 10
    s_add_u32 s48, s47, s10
    s_add_u32 s15, s13, 4
    s_lshl_b32 s15, s15, 16
    s_add_u32 s50, s15, s10
    s_lshl_b32 s10, s17, 10
    s_add_u32 s49, s47, s10
    v_lshlrev_b32 v8, 4, v6
    v_add_u32 v9, s52, v8
    v_add_u32 v8, s51, v8
    v_lshlrev_b32 v10, 2, v7
    v_add_u32 v11, s53, v10
    v_add_u32 v8, 139264, v8
    v_add_u32 v9, 139264, v9
    v_add_u32 v14, 139776, v11
    v_add_u32 v15, 139776, v10
    s_mov_b32 s37, 0
    s_mov_b32 s40, 4294918144
    s_mov_b32 s41, 4294912000
    s_waitcnt lgkmcnt(0)
    s_barrier
    ds_read_b128 v[88:91], v2 offset:0
    ds_read_b128 v[104:107], v4 offset:0
    ds_read_b128 v[92:95], v2 offset:2048
    ds_read_b128 v[96:99], v3 offset:0
    ds_read_b128 v[100:103], v3 offset:2048
    ds_read_b128 v[108:111], v4 offset:2048
    ds_read_b128 v[112:115], v4 offset:4096
    ds_read_b128 v[116:119], v4 offset:6144
    ds_read_b128 v[120:123], v5 offset:0
    s_waitcnt lgkmcnt(7)
    v_mfma_f32_16x16x32_bf16 v[16:19], v[88:91], v[104:107], 0
    ds_read_b128 v[124:127], v2 offset:1024
    s_waitcnt lgkmcnt(7)
    v_mfma_f32_16x16x32_bf16 v[20:23], v[92:95], v[104:107], 0
    ds_read_b128 v[140:143], v4 offset:1024
    s_waitcnt lgkmcnt(7)
    v_mfma_f32_16x16x32_bf16 v[24:27], v[96:99], v[104:107], 0
    ds_read_b128 v[128:131], v2 offset:3072
    s_waitcnt lgkmcnt(7)
    v_mfma_f32_16x16x32_bf16 v[28:31], v[100:103], v[104:107], 0
    ds_read_b128 v[132:135], v3 offset:1024
    s_waitcnt lgkmcnt(7)
    v_mfma_f32_16x16x32_bf16 v[44:47], v[100:103], v[108:111], 0
    ds_read_b128 v[136:139], v3 offset:3072
    v_mfma_f32_16x16x32_bf16 v[40:43], v[96:99], v[108:111], 0
    ds_read_b128 v[144:147], v4 offset:3072
    v_mfma_f32_16x16x32_bf16 v[36:39], v[92:95], v[108:111], 0
    ds_read_b128 v[148:151], v4 offset:5120
    v_mfma_f32_16x16x32_bf16 v[32:35], v[88:91], v[108:111], 0
    ds_read_b128 v[152:155], v4 offset:7168
    s_waitcnt lgkmcnt(10)
    v_mfma_f32_16x16x32_bf16 v[48:51], v[88:91], v[112:115], 0
    ds_read_b128 v[156:159], v5 offset:1024
    v_mfma_f32_16x16x32_bf16 v[52:55], v[92:95], v[112:115], 0
    s_add_u32 s37, s37, 1
    v_mfma_f32_16x16x32_bf16 v[56:59], v[96:99], v[112:115], 0
    s_cmp_eq_u32 s37, 4
    s_cselect_b32 s37, 0, s37
    v_mfma_f32_16x16x32_bf16 v[60:63], v[100:103], v[112:115], 0
    s_cselect_b32 s38, s40, 16384
    s_waitcnt lgkmcnt(10)
    v_mfma_f32_16x16x32_bf16 v[76:79], v[100:103], v[116:119], 0
    s_cselect_b32 s39, s41, 18432
    v_mfma_f32_16x16x32_bf16 v[72:75], v[96:99], v[116:119], 0
    v_add_u32 v2, s38, v2
    v_mfma_f32_16x16x32_bf16 v[68:71], v[92:95], v[116:119], 0
    v_add_u32 v3, s38, v3
    v_mfma_f32_16x16x32_bf16 v[64:67], v[88:91], v[116:119], 0
    v_add_u32 v4, s39, v4
    s_waitcnt lgkmcnt(9)
    v_mfma_f32_16x16x32_bf16 v[80:83], v[88:91], v[120:123], 0
    v_add_u32 v5, s39, v5
    v_mfma_f32_16x16x32_bf16 v[84:87], v[92:95], v[120:123], 0
    s_mov_b32 s36, 4
.p2align 3
L_m_mm86:
    s_waitcnt lgkmcnt(7)
    v_mfma_f32_16x16x32_bf16 v[16:19], v[124:127], v[140:143], v[16:19]
    s_waitcnt lgkmcnt(0)
    s_barrier
    ds_read_b128 v[88:91], v2 offset:0
    v_mfma_f32_16x16x32_bf16 v[20:23], v[128:131], v[140:143], v[20:23]
    ds_read_b128 v[104:107], v4 offset:0
    v_mfma_f32_16x16x32_bf16 v[24:27], v[132:135], v[140:143], v[24:27]
    ds_read_b128 v[92:95], v2 offset:2048
    v_mfma_f32_16x16x32_bf16 v[28:31], v[136:139], v[140:143], v[28:31]
    ds_read_b128 v[96:99], v3 offset:0
    v_mfma_f32_16x16x32_bf16 v[44:47], v[136:139], v[144:147], v[44:47]
    ds_read_b128 v[100:103], v3 offset:2048
    v_mfma_f32_16x16x32_bf16 v[40:43], v[132:135], v[144:147], v[40:43]
    ds_read_b128 v[108:111], v4 offset:2048
    v_mfma_f32_16x16x32_bf16 v[36:39], v[128:131], v[144:147], v[36:39]
    ds_read_b128 v[112:115], v4 offset:4096
    v_mfma_f32_16x16x32_bf16 v[32:35], v[124:127], v[144:147], v[32:35]
    ds_read_b128 v[116:119], v4 offset:6144
    v_mfma_f32_16x16x32_bf16 v[48:51], v[124:127], v[148:151], v[48:51]
    ds_read_b128 v[120:123], v5 offset:0
    v_mfma_f32_16x16x32_bf16 v[52:55], v[128:131], v[148:151], v[52:55]
    v_mfma_f32_16x16x32_bf16 v[56:59], v[132:135], v[148:151], v[56:59]
    v_mfma_f32_16x16x32_bf16 v[60:63], v[136:139], v[148:151], v[60:63]
    v_mfma_f32_16x16x32_bf16 v[76:79], v[136:139], v[152:155], v[76:79]
    v_mfma_f32_16x16x32_bf16 v[72:75], v[132:135], v[152:155], v[72:75]
    v_mfma_f32_16x16x32_bf16 v[68:71], v[128:131], v[152:155], v[68:71]
    v_mfma_f32_16x16x32_bf16 v[64:67], v[124:127], v[152:155], v[64:67]
    v_mfma_f32_16x16x32_bf16 v[80:83], v[124:127], v[156:159], v[80:83]
    v_mfma_f32_16x16x32_bf16 v[84:87], v[128:131], v[156:159], v[84:87]
    s_waitcnt lgkmcnt(7)
    v_mfma_f32_16x16x32_bf16 v[16:19], v[88:91], v[104:107], v[16:19]
    ds_read_b128 v[124:127], v2 offset:1024
    s_waitcnt lgkmcnt(7)
    v_mfma_f32_16x16x32_bf16 v[20:23], v[92:95], v[104:107], v[20:23]
    ds_read_b128 v[140:143], v4 offset:1024
    s_waitcnt lgkmcnt(7)
    v_mfma_f32_16x16x32_bf16 v[24:27], v[96:99], v[104:107], v[24:27]
    ds_read_b128 v[128:131], v2 offset:3072
    s_waitcnt lgkmcnt(7)
    v_mfma_f32_16x16x32_bf16 v[28:31], v[100:103], v[104:107], v[28:31]
    ds_read_b128 v[132:135], v3 offset:1024
    s_waitcnt lgkmcnt(7)
    v_mfma_f32_16x16x32_bf16 v[44:47], v[100:103], v[108:111], v[44:47]
    ds_read_b128 v[136:139], v3 offset:3072
    v_mfma_f32_16x16x32_bf16 v[40:43], v[96:99], v[108:111], v[40:43]
    ds_read_b128 v[144:147], v4 offset:3072
    v_mfma_f32_16x16x32_bf16 v[36:39], v[92:95], v[108:111], v[36:39]
    ds_read_b128 v[148:151], v4 offset:5120
    v_mfma_f32_16x16x32_bf16 v[32:35], v[88:91], v[108:111], v[32:35]
    ds_read_b128 v[152:155], v4 offset:7168
    s_waitcnt lgkmcnt(10)
    v_mfma_f32_16x16x32_bf16 v[48:51], v[88:91], v[112:115], v[48:51]
    ds_read_b128 v[156:159], v5 offset:1024
    v_mfma_f32_16x16x32_bf16 v[52:55], v[92:95], v[112:115], v[52:55]
    s_add_u32 s37, s37, 1
    v_mfma_f32_16x16x32_bf16 v[56:59], v[96:99], v[112:115], v[56:59]
    s_cmp_eq_u32 s37, 4
    s_cselect_b32 s37, 0, s37
    v_mfma_f32_16x16x32_bf16 v[60:63], v[100:103], v[112:115], v[60:63]
    s_cselect_b32 s38, s40, 16384
    s_waitcnt lgkmcnt(10)
    v_mfma_f32_16x16x32_bf16 v[76:79], v[100:103], v[116:119], v[76:79]
    s_cselect_b32 s39, s41, 18432
    v_mfma_f32_16x16x32_bf16 v[72:75], v[96:99], v[116:119], v[72:75]
    v_add_u32 v2, s38, v2
    v_mfma_f32_16x16x32_bf16 v[68:71], v[92:95], v[116:119], v[68:71]
    v_add_u32 v3, s38, v3
    v_mfma_f32_16x16x32_bf16 v[64:67], v[88:91], v[116:119], v[64:67]
    v_add_u32 v4, s39, v4
    s_waitcnt lgkmcnt(9)
    v_mfma_f32_16x16x32_bf16 v[80:83], v[88:91], v[120:123], v[80:83]
    v_add_u32 v5, s39, v5
    v_mfma_f32_16x16x32_bf16 v[84:87], v[92:95], v[120:123], v[84:87]
    s_waitcnt lgkmcnt(7)
    v_mfma_f32_16x16x32_bf16 v[16:19], v[124:127], v[140:143], v[16:19]
    s_waitcnt lgkmcnt(0)
    s_barrier
    ds_read_b128 v[88:91], v2 offset:0
    v_mfma_f32_16x16x32_bf16 v[20:23], v[128:131], v[140:143], v[20:23]
    ds_read_b128 v[104:107], v4 offset:0
    v_mfma_f32_16x16x32_bf16 v[24:27], v[132:135], v[140:143], v[24:27]
    ds_read_b128 v[92:95], v2 offset:2048
    v_mfma_f32_16x16x32_bf16 v[28:31], v[136:139], v[140:143], v[28:31]
    ds_read_b128 v[96:99], v3 offset:0
    v_mfma_f32_16x16x32_bf16 v[44:47], v[136:139], v[144:147], v[44:47]
    ds_read_b128 v[100:103], v3 offset:2048
    v_mfma_f32_16x16x32_bf16 v[40:43], v[132:135], v[144:147], v[40:43]
    ds_read_b128 v[108:111], v4 offset:2048
    v_mfma_f32_16x16x32_bf16 v[36:39], v[128:131], v[144:147], v[36:39]
    ds_read_b128 v[112:115], v4 offset:4096
    v_mfma_f32_16x16x32_bf16 v[32:35], v[124:127], v[144:147], v[32:35]
    ds_read_b128 v[116:119], v4 offset:6144
    v_mfma_f32_16x16x32_bf16 v[48:51], v[124:127], v[148:151], v[48:51]
    ds_read_b128 v[120:123], v5 offset:0
    v_mfma_f32_16x16x32_bf16 v[52:55], v[128:131], v[148:151], v[52:55]
    v_mfma_f32_16x16x32_bf16 v[56:59], v[132:135], v[148:151], v[56:59]
    v_mfma_f32_16x16x32_bf16 v[60:63], v[136:139], v[148:151], v[60:63]
    v_mfma_f32_16x16x32_bf16 v[76:79], v[136:139], v[152:155], v[76:79]
    v_mfma_f32_16x16x32_bf16 v[72:75], v[132:135], v[152:155], v[72:75]
    v_mfma_f32_16x16x32_bf16 v[68:71], v[128:131], v[152:155], v[68:71]
    v_mfma_f32_16x16x32_bf16 v[64:67], v[124:127], v[152:155], v[64:67]
    v_mfma_f32_16x16x32_bf16 v[80:83], v[124:127], v[156:159], v[80:83]
    v_mfma_f32_16x16x32_bf16 v[84:87], v[128:131], v[156:159], v[84:87]
    s_waitcnt lgkmcnt(7)
    v_mfma_f32_16x16x32_bf16 v[16:19], v[88:91], v[104:107], v[16:19]
    ds_read_b128 v[124:127], v2 offset:1024
    s_waitcnt lgkmcnt(7)
    v_mfma_f32_16x16x32_bf16 v[20:23], v[92:95], v[104:107], v[20:23]
    ds_read_b128 v[140:143], v4 offset:1024
    s_waitcnt lgkmcnt(7)
    v_mfma_f32_16x16x32_bf16 v[24:27], v[96:99], v[104:107], v[24:27]
    ds_read_b128 v[128:131], v2 offset:3072
    s_waitcnt lgkmcnt(7)
    v_mfma_f32_16x16x32_bf16 v[28:31], v[100:103], v[104:107], v[28:31]
    ds_read_b128 v[132:135], v3 offset:1024
    s_waitcnt lgkmcnt(7)
    v_mfma_f32_16x16x32_bf16 v[44:47], v[100:103], v[108:111], v[44:47]
    ds_read_b128 v[136:139], v3 offset:3072
    v_mfma_f32_16x16x32_bf16 v[40:43], v[96:99], v[108:111], v[40:43]
    ds_read_b128 v[144:147], v4 offset:3072
    v_mfma_f32_16x16x32_bf16 v[36:39], v[92:95], v[108:111], v[36:39]
    ds_read_b128 v[148:151], v4 offset:5120
    v_mfma_f32_16x16x32_bf16 v[32:35], v[88:91], v[108:111], v[32:35]
    ds_read_b128 v[152:155], v4 offset:7168
    s_waitcnt lgkmcnt(10)
    v_mfma_f32_16x16x32_bf16 v[48:51], v[88:91], v[112:115], v[48:51]
    ds_read_b128 v[156:159], v5 offset:1024
    v_mfma_f32_16x16x32_bf16 v[52:55], v[92:95], v[112:115], v[52:55]
    s_add_u32 s37, s37, 1
    s_cmp_eq_u32 s37, 4
    s_cselect_b32 s37, 0, s37
    v_mfma_f32_16x16x32_bf16 v[56:59], v[96:99], v[112:115], v[56:59]
    s_cselect_b32 s38, s40, 16384
    v_mfma_f32_16x16x32_bf16 v[60:63], v[100:103], v[112:115], v[60:63]
    s_cselect_b32 s39, s41, 18432
    s_waitcnt lgkmcnt(10)
    v_mfma_f32_16x16x32_bf16 v[76:79], v[100:103], v[116:119], v[76:79]
    v_add_u32 v2, s38, v2
    v_mfma_f32_16x16x32_bf16 v[72:75], v[96:99], v[116:119], v[72:75]
    v_add_u32 v3, s38, v3
    v_mfma_f32_16x16x32_bf16 v[68:71], v[92:95], v[116:119], v[68:71]
    v_add_u32 v4, s39, v4
    v_mfma_f32_16x16x32_bf16 v[64:67], v[88:91], v[116:119], v[64:67]
    v_add_u32 v5, s39, v5
    s_waitcnt lgkmcnt(9)
    v_mfma_f32_16x16x32_bf16 v[80:83], v[88:91], v[120:123], v[80:83]
    s_sub_u32 s36, s36, 1
    v_mfma_f32_16x16x32_bf16 v[84:87], v[92:95], v[120:123], v[84:87]
    s_cmp_lg_u32 s36, 0
    s_cbranch_scc1 L_m_mm86
    s_waitcnt lgkmcnt(7)
    v_mfma_f32_16x16x32_bf16 v[16:19], v[124:127], v[140:143], v[16:19]
    s_waitcnt lgkmcnt(0)
    s_barrier
    v_mfma_f32_16x16x32_bf16 v[20:23], v[128:131], v[140:143], v[20:23]
    v_mfma_f32_16x16x32_bf16 v[24:27], v[132:135], v[140:143], v[24:27]
    v_mfma_f32_16x16x32_bf16 v[28:31], v[136:139], v[140:143], v[28:31]
    v_mfma_f32_16x16x32_bf16 v[44:47], v[136:139], v[144:147], v[44:47]
    v_mfma_f32_16x16x32_bf16 v[40:43], v[132:135], v[144:147], v[40:43]
    v_mfma_f32_16x16x32_bf16 v[36:39], v[128:131], v[144:147], v[36:39]
    v_mfma_f32_16x16x32_bf16 v[32:35], v[124:127], v[144:147], v[32:35]
    v_mfma_f32_16x16x32_bf16 v[48:51], v[124:127], v[148:151], v[48:51]
    v_mfma_f32_16x16x32_bf16 v[52:55], v[128:131], v[148:151], v[52:55]
    v_mfma_f32_16x16x32_bf16 v[56:59], v[132:135], v[148:151], v[56:59]
    v_mfma_f32_16x16x32_bf16 v[60:63], v[136:139], v[148:151], v[60:63]
    v_mfma_f32_16x16x32_bf16 v[76:79], v[136:139], v[152:155], v[76:79]
    v_mfma_f32_16x16x32_bf16 v[72:75], v[132:135], v[152:155], v[72:75]
    v_mfma_f32_16x16x32_bf16 v[68:71], v[128:131], v[152:155], v[68:71]
    v_mfma_f32_16x16x32_bf16 v[64:67], v[124:127], v[152:155], v[64:67]
    v_mfma_f32_16x16x32_bf16 v[80:83], v[124:127], v[156:159], v[80:83]
    v_mfma_f32_16x16x32_bf16 v[84:87], v[128:131], v[156:159], v[84:87]
    s_setprio 0
    ds_read_b128 v[160:163], v8 offset:0
    ds_read_b128 v[164:167], v8 offset:64
    ds_read_b128 v[168:171], v9 offset:0
    ds_read_b128 v[172:175], v9 offset:64
    ds_read_b32 v226, v14 offset:0
    ds_read_b32 v228, v14 offset:64
    ds_read_b32 v230, v14 offset:128
    ds_read_b32 v232, v14 offset:192
    ds_read_b32 v234, v15 offset:256
    s_setprio 2
    s_add_u32 m0, s57, 0
    s_nop 0
    buffer_load_dwordx4 v240, s[24:27], s60 offen sc1 lds
    s_waitcnt lgkmcnt(0)
    buffer_load_dwordx4 v240, s[24:27], s60 offen offset:1024 sc1 lds
    v_pk_fma_f32 v[16:17], v[16:17], v[160:161], v[226:227] op_sel_hi:[1,1,0]
    v_pk_fma_f32 v[18:19], v[18:19], v[162:163], v[226:227] op_sel_hi:[1,1,0]
    v_pk_fma_f32 v[20:21], v[20:21], v[164:165], v[226:227] op_sel_hi:[1,1,0]
    v_pk_fma_f32 v[22:23], v[22:23], v[166:167], v[226:227] op_sel_hi:[1,1,0]
    v_pk_mul_f32 v[218:219], v[16:17], v[16:17]
    v_pk_mul_f32 v[220:221], v[18:19], v[18:19]
    v_pk_mul_f32 v[222:223], v[20:21], v[20:21]
    v_pk_mul_f32 v[224:225], v[22:23], v[22:23]
    v_pk_fma_f32 v[218:219], v[218:219], v[184:185], v[182:183]
    v_pk_fma_f32 v[220:221], v[220:221], v[184:185], v[182:183]
    v_pk_fma_f32 v[222:223], v[222:223], v[184:185], v[182:183]
    v_pk_fma_f32 v[224:225], v[224:225], v[184:185], v[182:183]
    v_pk_mul_f32 v[218:219], v[218:219], v[16:17]
    v_pk_mul_f32 v[220:221], v[220:221], v[18:19]
    v_pk_mul_f32 v[222:223], v[222:223], v[20:21]
    v_pk_mul_f32 v[224:225], v[224:225], v[22:23]
    v_exp_f32 v218, v218
    v_exp_f32 v220, v220
    v_exp_f32 v222, v222
    v_exp_f32 v224, v224
    v_exp_f32 v219, v219
    v_exp_f32 v221, v221
    v_exp_f32 v223, v223
    v_exp_f32 v225, v225
    v_pk_add_f32 v[218:219], v[218:219], 1.0 op_sel_hi:[1,0]
    v_pk_add_f32 v[220:221], v[220:221], 1.0 op_sel_hi:[1,0]
    v_pk_add_f32 v[222:223], v[222:223], 1.0 op_sel_hi:[1,0]
    v_pk_add_f32 v[224:225], v[224:225], 1.0 op_sel_hi:[1,0]
    v_rcp_f32 v218, v218
    v_rcp_f32 v220, v220
    v_rcp_f32 v222, v222
    v_rcp_f32 v224, v224
    v_rcp_f32 v219, v219
    v_rcp_f32 v221, v221
    v_rcp_f32 v223, v223
    v_rcp_f32 v225, v225
    v_pk_mul_f32 v[16:17], v[16:17], v[218:219]
    v_pk_mul_f32 v[18:19], v[18:19], v[220:221]
    v_pk_mul_f32 v[20:21], v[20:21], v[222:223]
    v_pk_mul_f32 v[22:23], v[22:23], v[224:225]
    v_pk_mul_f32 v[202:203], v[16:17], v[16:17]
    v_pk_mul_f32 v[204:205], v[18:19], v[18:19]
    v_pk_mul_f32 v[206:207], v[20:21], v[20:21]
    v_pk_mul_f32 v[208:209], v[22:23], v[22:23]
    v_pk_fma_f32 v[24:25], v[24:25], v[168:169], v[226:227] op_sel_hi:[1,1,0]
    v_pk_fma_f32 v[26:27], v[26:27], v[170:171], v[226:227] op_sel_hi:[1,1,0]
    v_pk_fma_f32 v[28:29], v[28:29], v[172:173], v[226:227] op_sel_hi:[1,1,0]
    v_pk_fma_f32 v[30:31], v[30:31], v[174:175], v[226:227] op_sel_hi:[1,1,0]
    v_pk_mul_f32 v[218:219], v[24:25], v[24:25]
    buffer_load_dwordx4 v241, s[24:27], s60 offen offset:2048 sc1 lds
    v_pk_mul_f32 v[220:221], v[26:27], v[26:27]
    v_pk_mul_f32 v[222:223], v[28:29], v[28:29]
    v_pk_mul_f32 v[224:225], v[30:31], v[30:31]
    v_pk_fma_f32 v[218:219], v[218:219], v[184:185], v[182:183]
    v_pk_fma_f32 v[220:221], v[220:221], v[184:185], v[182:183]
    v_pk_fma_f32 v[222:223], v[222:223], v[184:185], v[182:183]
    v_pk_fma_f32 v[224:225], v[224:225], v[184:185], v[182:183]
    v_pk_mul_f32 v[218:219], v[218:219], v[24:25]
    v_pk_mul_f32 v[220:221], v[220:221], v[26:27]
    v_pk_mul_f32 v[222:223], v[222:223], v[28:29]
    v_pk_mul_f32 v[224:225], v[224:225], v[30:31]
    v_exp_f32 v218, v218
    v_exp_f32 v220, v220
    v_exp_f32 v222, v222
    v_exp_f32 v224, v224
    v_exp_f32 v219, v219
    v_exp_f32 v221, v221
    v_exp_f32 v223, v223
    v_exp_f32 v225, v225
    v_pk_add_f32 v[218:219], v[218:219], 1.0 op_sel_hi:[1,0]
    v_pk_add_f32 v[220:221], v[220:221], 1.0 op_sel_hi:[1,0]
    v_pk_add_f32 v[222:223], v[222:223], 1.0 op_sel_hi:[1,0]
    v_pk_add_f32 v[224:225], v[224:225], 1.0 op_sel_hi:[1,0]
    v_rcp_f32 v218, v218
    v_rcp_f32 v220, v220
    v_rcp_f32 v222, v222
    v_rcp_f32 v224, v224
    v_rcp_f32 v219, v219
    v_rcp_f32 v221, v221
    v_rcp_f32 v223, v223
    v_rcp_f32 v225, v225
    v_pk_mul_f32 v[24:25], v[24:25], v[218:219]
    v_pk_mul_f32 v[26:27], v[26:27], v[220:221]
    v_pk_mul_f32 v[28:29], v[28:29], v[222:223]
    v_pk_mul_f32 v[30:31], v[30:31], v[224:225]
    v_pk_mul_f32 v[210:211], v[24:25], v[24:25]
    v_pk_mul_f32 v[212:213], v[26:27], v[26:27]
    v_pk_mul_f32 v[214:215], v[28:29], v[28:29]
    v_pk_mul_f32 v[216:217], v[30:31], v[30:31]
    v_pk_fma_f32 v[32:33], v[32:33], v[160:161], v[228:229] op_sel_hi:[1,1,0]
    v_pk_fma_f32 v[34:35], v[34:35], v[162:163], v[228:229] op_sel_hi:[1,1,0]
    v_pk_fma_f32 v[36:37], v[36:37], v[164:165], v[228:229] op_sel_hi:[1,1,0]
    v_pk_fma_f32 v[38:39], v[38:39], v[166:167], v[228:229] op_sel_hi:[1,1,0]
    v_pk_mul_f32 v[218:219], v[32:33], v[32:33]
    v_pk_mul_f32 v[220:221], v[34:35], v[34:35]
    v_pk_mul_f32 v[222:223], v[36:37], v[36:37]
    v_pk_mul_f32 v[224:225], v[38:39], v[38:39]
    v_pk_fma_f32 v[218:219], v[218:219], v[184:185], v[182:183]
    v_pk_fma_f32 v[220:221], v[220:221], v[184:185], v[182:183]
    buffer_load_dwordx4 v241, s[24:27], s60 offen offset:3072 sc1 lds
    v_pk_fma_f32 v[222:223], v[222:223], v[184:185], v[182:183]
    v_pk_fma_f32 v[224:225], v[224:225], v[184:185], v[182:183]
    v_pk_mul_f32 v[218:219], v[218:219], v[32:33]
    v_pk_mul_f32 v[220:221], v[220:221], v[34:35]
    v_pk_mul_f32 v[222:223], v[222:223], v[36:37]
    v_pk_mul_f32 v[224:225], v[224:225], v[38:39]
    v_exp_f32 v218, v218
    v_exp_f32 v220, v220
    v_exp_f32 v222, v222
    v_exp_f32 v224, v224
    v_exp_f32 v219, v219
    v_exp_f32 v221, v221
    v_exp_f32 v223, v223
    v_exp_f32 v225, v225
    v_pk_add_f32 v[218:219], v[218:219], 1.0 op_sel_hi:[1,0]
    v_pk_add_f32 v[220:221], v[220:221], 1.0 op_sel_hi:[1,0]
    v_pk_add_f32 v[222:223], v[222:223], 1.0 op_sel_hi:[1,0]
    v_pk_add_f32 v[224:225], v[224:225], 1.0 op_sel_hi:[1,0]
    v_rcp_f32 v218, v218
    v_rcp_f32 v220, v220
    v_rcp_f32 v222, v222
    v_rcp_f32 v224, v224
    v_rcp_f32 v219, v219
    v_rcp_f32 v221, v221
    v_rcp_f32 v223, v223
    v_rcp_f32 v225, v225
    v_pk_mul_f32 v[32:33], v[32:33], v[218:219]
    v_pk_mul_f32 v[34:35], v[34:35], v[220:221]
    v_pk_mul_f32 v[36:37], v[36:37], v[222:223]
    v_pk_mul_f32 v[38:39], v[38:39], v[224:225]
    v_pk_add_f32 v[186:187], v[16:17], v[32:33]
    v_pk_add_f32 v[188:189], v[18:19], v[34:35]
    v_pk_add_f32 v[190:191], v[20:21], v[36:37]
    v_pk_add_f32 v[192:193], v[22:23], v[38:39]
    v_pk_fma_f32 v[202:203], v[32:33], v[32:33], v[202:203]
    v_pk_fma_f32 v[204:205], v[34:35], v[34:35], v[204:205]
    v_pk_fma_f32 v[206:207], v[36:37], v[36:37], v[206:207]
    v_pk_fma_f32 v[208:209], v[38:39], v[38:39], v[208:209]
    v_pk_fma_f32 v[40:41], v[40:41], v[168:169], v[228:229] op_sel_hi:[1,1,0]
    v_pk_fma_f32 v[42:43], v[42:43], v[170:171], v[228:229] op_sel_hi:[1,1,0]
    v_pk_fma_f32 v[44:45], v[44:45], v[172:173], v[228:229] op_sel_hi:[1,1,0]
    v_pk_fma_f32 v[46:47], v[46:47], v[174:175], v[228:229] op_sel_hi:[1,1,0]
    v_pk_mul_f32 v[218:219], v[40:41], v[40:41]
    v_pk_mul_f32 v[220:221], v[42:43], v[42:43]
    v_pk_mul_f32 v[222:223], v[44:45], v[44:45]
    v_pk_mul_f32 v[224:225], v[46:47], v[46:47]
    v_pk_fma_f32 v[218:219], v[218:219], v[184:185], v[182:183]
    v_pk_fma_f32 v[220:221], v[220:221], v[184:185], v[182:183]
    v_pk_fma_f32 v[222:223], v[222:223], v[184:185], v[182:183]
    s_add_u32 m0, s58, 0
    s_nop 0
    buffer_load_dwordx4 v240, s[28:31], s61 offen sc1 lds
    v_pk_fma_f32 v[224:225], v[224:225], v[184:185], v[182:183]
    v_pk_mul_f32 v[218:219], v[218:219], v[40:41]
    v_pk_mul_f32 v[220:221], v[220:221], v[42:43]
    v_pk_mul_f32 v[222:223], v[222:223], v[44:45]
    v_pk_mul_f32 v[224:225], v[224:225], v[46:47]
    v_exp_f32 v218, v218
    v_exp_f32 v220, v220
    v_exp_f32 v222, v222
    v_exp_f32 v224, v224
    v_exp_f32 v219, v219
    v_exp_f32 v221, v221
    v_exp_f32 v223, v223
    v_exp_f32 v225, v225
    v_pk_add_f32 v[218:219], v[218:219], 1.0 op_sel_hi:[1,0]
    v_pk_add_f32 v[220:221], v[220:221], 1.0 op_sel_hi:[1,0]
    v_pk_add_f32 v[222:223], v[222:223], 1.0 op_sel_hi:[1,0]
    v_pk_add_f32 v[224:225], v[224:225], 1.0 op_sel_hi:[1,0]
    v_rcp_f32 v218, v218
    v_rcp_f32 v220, v220
    v_rcp_f32 v222, v222
    v_rcp_f32 v224, v224
    v_rcp_f32 v219, v219
    v_rcp_f32 v221, v221
    v_rcp_f32 v223, v223
    v_rcp_f32 v225, v225
    v_pk_mul_f32 v[40:41], v[40:41], v[218:219]
    v_pk_mul_f32 v[42:43], v[42:43], v[220:221]
    v_pk_mul_f32 v[44:45], v[44:45], v[222:223]
    v_pk_mul_f32 v[46:47], v[46:47], v[224:225]
    v_pk_add_f32 v[194:195], v[24:25], v[40:41]
    v_pk_add_f32 v[196:197], v[26:27], v[42:43]
    v_pk_add_f32 v[198:199], v[28:29], v[44:45]
    v_pk_add_f32 v[200:201], v[30:31], v[46:47]
    v_pk_fma_f32 v[210:211], v[40:41], v[40:41], v[210:211]
    v_pk_fma_f32 v[212:213], v[42:43], v[42:43], v[212:213]
    v_pk_fma_f32 v[214:215], v[44:45], v[44:45], v[214:215]
    v_pk_fma_f32 v[216:217], v[46:47], v[46:47], v[216:217]
    v_pk_fma_f32 v[48:49], v[48:49], v[160:161], v[230:231] op_sel_hi:[1,1,0]
    v_pk_fma_f32 v[50:51], v[50:51], v[162:163], v[230:231] op_sel_hi:[1,1,0]
    v_pk_fma_f32 v[52:53], v[52:53], v[164:165], v[230:231] op_sel_hi:[1,1,0]
    v_pk_fma_f32 v[54:55], v[54:55], v[166:167], v[230:231] op_sel_hi:[1,1,0]
    v_pk_mul_f32 v[218:219], v[48:49], v[48:49]
    v_pk_mul_f32 v[220:221], v[50:51], v[50:51]
    v_pk_mul_f32 v[222:223], v[52:53], v[52:53]
    v_pk_mul_f32 v[224:225], v[54:55], v[54:55]
    v_pk_fma_f32 v[218:219], v[218:219], v[184:185], v[182:183]
    v_pk_fma_f32 v[220:221], v[220:221], v[184:185], v[182:183]
    v_pk_fma_f32 v[222:223], v[222:223], v[184:185], v[182:183]
    v_pk_fma_f32 v[224:225], v[224:225], v[184:185], v[182:183]
    buffer_load_dwordx4 v240, s[28:31], s61 offen offset:1024 sc1 lds
    v_pk_mul_f32 v[218:219], v[218:219], v[48:49]
    v_pk_mul_f32 v[220:221], v[220:221], v[50:51]
    v_pk_mul_f32 v[222:223], v[222:223], v[52:53]
    v_pk_mul_f32 v[224:225], v[224:225], v[54:55]
    v_exp_f32 v218, v218
    v_exp_f32 v220, v220
    v_exp_f32 v222, v222
    v_exp_f32 v224, v224
    v_exp_f32 v219, v219
    v_exp_f32 v221, v221
    v_exp_f32 v223, v223
    v_exp_f32 v225, v225
    v_pk_add_f32 v[218:219], v[218:219], 1.0 op_sel_hi:[1,0]
    v_pk_add_f32 v[220:221], v[220:221], 1.0 op_sel_hi:[1,0]
    v_pk_add_f32 v[222:223], v[222:223], 1.0 op_sel_hi:[1,0]
    v_pk_add_f32 v[224:225], v[224:225], 1.0 op_sel_hi:[1,0]
    v_rcp_f32 v218, v218
    v_rcp_f32 v220, v220
    v_rcp_f32 v222, v222
    v_rcp_f32 v224, v224
    v_rcp_f32 v219, v219
    v_rcp_f32 v221, v221
    v_rcp_f32 v223, v223
    v_rcp_f32 v225, v225
    v_pk_mul_f32 v[48:49], v[48:49], v[218:219]
    v_pk_mul_f32 v[50:51], v[50:51], v[220:221]
    v_pk_mul_f32 v[52:53], v[52:53], v[222:223]
    v_pk_mul_f32 v[54:55], v[54:55], v[224:225]
    v_pk_add_f32 v[186:187], v[186:187], v[48:49]
    v_pk_add_f32 v[188:189], v[188:189], v[50:51]
    v_pk_add_f32 v[190:191], v[190:191], v[52:53]
    v_pk_add_f32 v[192:193], v[192:193], v[54:55]
    v_pk_fma_f32 v[202:203], v[48:49], v[48:49], v[202:203]
    v_pk_fma_f32 v[204:205], v[50:51], v[50:51], v[204:205]
    v_pk_fma_f32 v[206:207], v[52:53], v[52:53], v[206:207]
    v_pk_fma_f32 v[208:209], v[54:55], v[54:55], v[208:209]
    v_pk_fma_f32 v[56:57], v[56:57], v[168:169], v[230:231] op_sel_hi:[1,1,0]
    v_pk_fma_f32 v[58:59], v[58:59], v[170:171], v[230:231] op_sel_hi:[1,1,0]
    v_pk_fma_f32 v[60:61], v[60:61], v[172:173], v[230:231] op_sel_hi:[1,1,0]
    v_pk_fma_f32 v[62:63], v[62:63], v[174:175], v[230:231] op_sel_hi:[1,1,0]
    v_pk_mul_f32 v[218:219], v[56:57], v[56:57]
    v_pk_mul_f32 v[220:221], v[58:59], v[58:59]
    v_pk_mul_f32 v[222:223], v[60:61], v[60:61]
    v_pk_mul_f32 v[224:225], v[62:63], v[62:63]
    v_pk_fma_f32 v[218:219], v[218:219], v[184:185], v[182:183]
    v_pk_fma_f32 v[220:221], v[220:221], v[184:185], v[182:183]
    v_pk_fma_f32 v[222:223], v[222:223], v[184:185], v[182:183]
    v_pk_fma_f32 v[224:225], v[224:225], v[184:185], v[182:183]
    v_pk_mul_f32 v[218:219], v[218:219], v[56:57]
    buffer_load_dwordx4 v240, s[28:31], s61 offen offset:2048 sc1 lds
    v_pk_mul_f32 v[220:221], v[220:221], v[58:59]
    v_pk_mul_f32 v[222:223], v[222:223], v[60:61]
    v_pk_mul_f32 v[224:225], v[224:225], v[62:63]
    v_exp_f32 v218, v218
    v_exp_f32 v220, v220
    v_exp_f32 v222, v222
    v_exp_f32 v224, v224
    v_exp_f32 v219, v219
    v_exp_f32 v221, v221
    v_exp_f32 v223, v223
    v_exp_f32 v225, v225
    v_pk_add_f32 v[218:219], v[218:219], 1.0 op_sel_hi:[1,0]
    v_pk_add_f32 v[220:221], v[220:221], 1.0 op_sel_hi:[1,0]
    v_pk_add_f32 v[222:223], v[222:223], 1.0 op_sel_hi:[1,0]
    v_pk_add_f32 v[224:225], v[224:225], 1.0 op_sel_hi:[1,0]
    v_rcp_f32 v218, v218
    v_rcp_f32 v220, v220
    v_rcp_f32 v222, v222
    v_rcp_f32 v224, v224
    v_rcp_f32 v219, v219
    v_rcp_f32 v221, v221
    v_rcp_f32 v223, v223
    v_rcp_f32 v225, v225
    v_pk_mul_f32 v[56:57], v[56:57], v[218:219]
    v_pk_mul_f32 v[58:59], v[58:59], v[220:221]
    v_pk_mul_f32 v[60:61], v[60:61], v[222:223]
    v_pk_mul_f32 v[62:63], v[62:63], v[224:225]
    v_pk_add_f32 v[194:195], v[194:195], v[56:57]
    v_pk_add_f32 v[196:197], v[196:197], v[58:59]
    v_pk_add_f32 v[198:199], v[198:199], v[60:61]
    v_pk_add_f32 v[200:201], v[200:201], v[62:63]
    v_pk_fma_f32 v[210:211], v[56:57], v[56:57], v[210:211]
    v_pk_fma_f32 v[212:213], v[58:59], v[58:59], v[212:213]
    v_pk_fma_f32 v[214:215], v[60:61], v[60:61], v[214:215]
    v_pk_fma_f32 v[216:217], v[62:63], v[62:63], v[216:217]
    v_pk_fma_f32 v[64:65], v[64:65], v[160:161], v[232:233] op_sel_hi:[1,1,0]
    v_pk_fma_f32 v[66:67], v[66:67], v[162:163], v[232:233] op_sel_hi:[1,1,0]
    v_pk_fma_f32 v[68:69], v[68:69], v[164:165], v[232:233] op_sel_hi:[1,1,0]
    v_pk_fma_f32 v[70:71], v[70:71], v[166:167], v[232:233] op_sel_hi:[1,1,0]
    v_pk_mul_f32 v[218:219], v[64:65], v[64:65]
    v_pk_mul_f32 v[220:221], v[66:67], v[66:67]
    v_pk_mul_f32 v[222:223], v[68:69], v[68:69]
    v_pk_mul_f32 v[224:225], v[70:71], v[70:71]
    v_pk_fma_f32 v[218:219], v[218:219], v[184:185], v[182:183]
    v_pk_fma_f32 v[220:221], v[220:221], v[184:185], v[182:183]
    v_pk_fma_f32 v[222:223], v[222:223], v[184:185], v[182:183]
    v_pk_fma_f32 v[224:225], v[224:225], v[184:185], v[182:183]
    v_pk_mul_f32 v[218:219], v[218:219], v[64:65]
    v_pk_mul_f32 v[220:221], v[220:221], v[66:67]
    buffer_load_dwordx4 v240, s[28:31], s61 offen offset:3072 sc1 lds
    v_pk_mul_f32 v[222:223], v[222:223], v[68:69]
    v_pk_mul_f32 v[224:225], v[224:225], v[70:71]
    v_exp_f32 v218, v218
    v_exp_f32 v220, v220
    v_exp_f32 v222, v222
    v_exp_f32 v224, v224
    v_exp_f32 v219, v219
    v_exp_f32 v221, v221
    v_exp_f32 v223, v223
    v_exp_f32 v225, v225
    v_pk_add_f32 v[218:219], v[218:219], 1.0 op_sel_hi:[1,0]
    v_pk_add_f32 v[220:221], v[220:221], 1.0 op_sel_hi:[1,0]
    v_pk_add_f32 v[222:223], v[222:223], 1.0 op_sel_hi:[1,0]
    v_pk_add_f32 v[224:225], v[224:225], 1.0 op_sel_hi:[1,0]
    v_rcp_f32 v218, v218
    v_rcp_f32 v220, v220
    v_rcp_f32 v222, v222
    v_rcp_f32 v224, v224
    v_rcp_f32 v219, v219
    v_rcp_f32 v221, v221
    v_rcp_f32 v223, v223
    v_rcp_f32 v225, v225
    v_pk_mul_f32 v[64:65], v[64:65], v[218:219]
    v_pk_mul_f32 v[66:67], v[66:67], v[220:221]
    v_pk_mul_f32 v[68:69], v[68:69], v[222:223]
    v_pk_mul_f32 v[70:71], v[70:71], v[224:225]
    v_pk_add_f32 v[186:187], v[186:187], v[64:65]
    v_pk_add_f32 v[188:189], v[188:189], v[66:67]
    v_pk_add_f32 v[190:191], v[190:191], v[68:69]
    v_pk_add_f32 v[192:193], v[192:193], v[70:71]
    v_pk_fma_f32 v[202:203], v[64:65], v[64:65], v[202:203]
    v_pk_fma_f32 v[204:205], v[66:67], v[66:67], v[204:205]
    v_pk_fma_f32 v[206:207], v[68:69], v[68:69], v[206:207]
    v_pk_fma_f32 v[208:209], v[70:71], v[70:71], v[208:209]
    v_pk_fma_f32 v[72:73], v[72:73], v[168:169], v[232:233] op_sel_hi:[1,1,0]
    v_pk_fma_f32 v[74:75], v[74:75], v[170:171], v[232:233] op_sel_hi:[1,1,0]
    v_pk_fma_f32 v[76:77], v[76:77], v[172:173], v[232:233] op_sel_hi:[1,1,0]
    v_pk_fma_f32 v[78:79], v[78:79], v[174:175], v[232:233] op_sel_hi:[1,1,0]
    v_pk_mul_f32 v[218:219], v[72:73], v[72:73]
    v_pk_mul_f32 v[220:221], v[74:75], v[74:75]
    v_pk_mul_f32 v[222:223], v[76:77], v[76:77]
    v_pk_mul_f32 v[224:225], v[78:79], v[78:79]
    v_pk_fma_f32 v[218:219], v[218:219], v[184:185], v[182:183]
    v_pk_fma_f32 v[220:221], v[220:221], v[184:185], v[182:183]
    v_pk_fma_f32 v[222:223], v[222:223], v[184:185], v[182:183]
    v_pk_fma_f32 v[224:225], v[224:225], v[184:185], v[182:183]
    v_pk_mul_f32 v[218:219], v[218:219], v[72:73]
    v_pk_mul_f32 v[220:221], v[220:221], v[74:75]
    v_pk_mul_f32 v[222:223], v[222:223], v[76:77]
    s_add_u32 m0, s64, 0
    s_cmp_lt_u32 s19, 2
    s_cbranch_scc0 L_m_g87
    buffer_load_dwordx4 v242, s[28:31], s61 offen sc1 lds
L_m_g87:
    v_readlane_b32 s60, v245, 13
    v_readlane_b32 s61, v246, 13
    s_nop 3
    v_pk_mul_f32 v[224:225], v[224:225], v[78:79]
    v_exp_f32 v218, v218
    v_exp_f32 v220, v220
    v_exp_f32 v222, v222
    v_exp_f32 v224, v224
    v_exp_f32 v219, v219
    v_exp_f32 v221, v221
    v_exp_f32 v223, v223
    v_exp_f32 v225, v225
    v_pk_add_f32 v[218:219], v[218:219], 1.0 op_sel_hi:[1,0]
    v_pk_add_f32 v[220:221], v[220:221], 1.0 op_sel_hi:[1,0]
    v_pk_add_f32 v[222:223], v[222:223], 1.0 op_sel_hi:[1,0]
    v_pk_add_f32 v[224:225], v[224:225], 1.0 op_sel_hi:[1,0]
    v_rcp_f32 v218, v218
    v_rcp_f32 v220, v220
    v_rcp_f32 v222, v222
    v_rcp_f32 v224, v224
    v_rcp_f32 v219, v219
    v_rcp_f32 v221, v221
    v_rcp_f32 v223, v223
    v_rcp_f32 v225, v225
    v_pk_mul_f32 v[72:73], v[72:73], v[218:219]
    v_pk_mul_f32 v[74:75], v[74:75], v[220:221]
    v_pk_mul_f32 v[76:77], v[76:77], v[222:223]
    v_pk_mul_f32 v[78:79], v[78:79], v[224:225]
    v_pk_add_f32 v[194:195], v[194:195], v[72:73]
    v_pk_add_f32 v[196:197], v[196:197], v[74:75]
    v_pk_add_f32 v[198:199], v[198:199], v[76:77]
    v_pk_add_f32 v[200:201], v[200:201], v[78:79]
    v_pk_fma_f32 v[210:211], v[72:73], v[72:73], v[210:211]
    v_pk_fma_f32 v[212:213], v[74:75], v[74:75], v[212:213]
    v_pk_fma_f32 v[214:215], v[76:77], v[76:77], v[214:215]
    v_pk_fma_f32 v[216:217], v[78:79], v[78:79], v[216:217]
    v_pk_fma_f32 v[80:81], v[80:81], v[160:161], v[234:235] op_sel_hi:[1,1,0]
    v_pk_fma_f32 v[82:83], v[82:83], v[162:163], v[234:235] op_sel_hi:[1,1,0]
    v_pk_fma_f32 v[84:85], v[84:85], v[164:165], v[234:235] op_sel_hi:[1,1,0]
    v_pk_fma_f32 v[86:87], v[86:87], v[166:167], v[234:235] op_sel_hi:[1,1,0]
    v_pk_mul_f32 v[218:219], v[80:81], v[80:81]
    v_pk_mul_f32 v[220:221], v[82:83], v[82:83]
    v_pk_mul_f32 v[222:223], v[84:85], v[84:85]
    v_pk_mul_f32 v[224:225], v[86:87], v[86:87]
    v_pk_fma_f32 v[218:219], v[218:219], v[184:185], v[182:183]
    v_pk_fma_f32 v[220:221], v[220:221], v[184:185], v[182:183]
    v_pk_fma_f32 v[222:223], v[222:223], v[184:185], v[182:183]
    v_pk_fma_f32 v[224:225], v[224:225], v[184:185], v[182:183]
    v_pk_mul_f32 v[218:219], v[218:219], v[80:81]
    v_pk_mul_f32 v[220:221], v[220:221], v[82:83]
    v_pk_mul_f32 v[222:223], v[222:223], v[84:85]
    v_pk_mul_f32 v[224:225], v[224:225], v[86:87]
    v_exp_f32 v218, v218
    v_exp_f32 v220, v220
    v_exp_f32 v222, v222
    v_exp_f32 v224, v224
    v_exp_f32 v219, v219
    v_exp_f32 v221, v221
    v_exp_f32 v223, v223
    v_exp_f32 v225, v225
    v_pk_add_f32 v[218:219], v[218:219], 1.0 op_sel_hi:[1,0]
    v_pk_add_f32 v[220:221], v[220:221], 1.0 op_sel_hi:[1,0]
    v_pk_add_f32 v[222:223], v[222:223], 1.0 op_sel_hi:[1,0]
    v_pk_add_f32 v[224:225], v[224:225], 1.0 op_sel_hi:[1,0]
    v_rcp_f32 v218, v218
    v_rcp_f32 v220, v220
    v_rcp_f32 v222, v222
    v_rcp_f32 v224, v224
    v_rcp_f32 v219, v219
    v_rcp_f32 v221, v221
    v_rcp_f32 v223, v223
    v_rcp_f32 v225, v225
    v_pk_mul_f32 v[80:81], v[80:81], v[218:219]
    v_pk_mul_f32 v[82:83], v[82:83], v[220:221]
    v_pk_mul_f32 v[84:85], v[84:85], v[222:223]
    v_pk_mul_f32 v[86:87], v[86:87], v[224:225]
    v_pk_add_f32 v[186:187], v[186:187], v[80:81]
    v_pk_add_f32 v[188:189], v[188:189], v[82:83]
    v_pk_add_f32 v[190:191], v[190:191], v[84:85]
    v_pk_add_f32 v[192:193], v[192:193], v[86:87]
    v_pk_fma_f32 v[202:203], v[80:81], v[80:81], v[202:203]
    v_pk_fma_f32 v[204:205], v[82:83], v[82:83], v[204:205]
    v_pk_fma_f32 v[206:207], v[84:85], v[84:85], v[206:207]
    v_pk_fma_f32 v[208:209], v[86:87], v[86:87], v[208:209]
    v_add_f32 v218, v208, v209
    s_nop 1
    v_add_f32_dpp v186, v186, v186 row_ror:8 row_mask:0xf bank_mask:0x3
    v_add_f32_dpp v187, v187, v187 row_ror:8 row_mask:0xf bank_mask:0x3
    v_add_f32_dpp v188, v188, v188 row_ror:8 row_mask:0xf bank_mask:0x3
    v_add_f32_dpp v189, v189, v189 row_ror:8 row_mask:0xf bank_mask:0x3
    v_add_f32_dpp v190, v190, v190 row_ror:8 row_mask:0xf bank_mask:0x3
    v_add_f32_dpp v191, v191, v191 row_ror:8 row_mask:0xf bank_mask:0x3
    v_add_f32_dpp v192, v192, v192 row_ror:8 row_mask:0xf bank_mask:0x3
    v_add_f32_dpp v193, v193, v193 row_ror:8 row_mask:0xf bank_mask:0x3
    v_add_f32_dpp v194, v194, v194 row_ror:8 row_mask:0xf bank_mask:0x3
    v_add_f32_dpp v195, v195, v195 row_ror:8 row_mask:0xf bank_mask:0x3
    v_add_f32_dpp v196, v196, v196 row_ror:8 row_mask:0xf bank_mask:0x3
    v_add_f32_dpp v197, v197, v197 row_ror:8 row_mask:0xf bank_mask:0x3
    v_add_f32_dpp v198, v198, v198 row_ror:8 row_mask:0xf bank_mask:0x3
    v_add_f32_dpp v199, v199, v199 row_ror:8 row_mask:0xf bank_mask:0x3
    v_add_f32_dpp v200, v200, v200 row_ror:8 row_mask:0xf bank_mask:0x3
    v_add_f32_dpp v201, v201, v201 row_ror:8 row_mask:0xf bank_mask:0x3
    v_add_f32_dpp v186, v202, v202 row_ror:8 row_mask:0xf bank_mask:0xc
    v_add_f32_dpp v187, v203, v203 row_ror:8 row_mask:0xf bank_mask:0xc
    v_add_f32_dpp v188, v204, v204 row_ror:8 row_mask:0xf bank_mask:0xc
    v_add_f32_dpp v189, v205, v205 row_ror:8 row_mask:0xf bank_mask:0xc
    v_add_f32_dpp v190, v206, v206 row_ror:8 row_mask:0xf bank_mask:0xc
    v_add_f32_dpp v191, v207, v207 row_ror:8 row_mask:0xf bank_mask:0xc
    v_add_f32_dpp v192, v208, v208 row_ror:8 row_mask:0xf bank_mask:0xc
    v_add_f32_dpp v193, v209, v209 row_ror:8 row_mask:0xf bank_mask:0xc
    v_add_f32_dpp v194, v210, v210 row_ror:8 row_mask:0xf bank_mask:0xc
    v_add_f32_dpp v195, v211, v211 row_ror:8 row_mask:0xf bank_mask:0xc
    v_add_f32_dpp v196, v212, v212 row_ror:8 row_mask:0xf bank_mask:0xc
    v_add_f32_dpp v197, v213, v213 row_ror:8 row_mask:0xf bank_mask:0xc
    v_add_f32_dpp v198, v214, v214 row_ror:8 row_mask:0xf bank_mask:0xc
    v_add_f32_dpp v199, v215, v215 row_ror:8 row_mask:0xf bank_mask:0xc
    v_add_f32_dpp v200, v216, v216 row_ror:8 row_mask:0xf bank_mask:0xc
    v_add_f32_dpp v201, v217, v217 row_ror:8 row_mask:0xf bank_mask:0xc
    v_add_f32_dpp v186, v186, v186 row_half_mirror row_mask:0xf bank_mask:0x5
    v_add_f32_dpp v187, v187, v187 row_half_mirror row_mask:0xf bank_mask:0x5
    v_add_f32_dpp v188, v188, v188 row_half_mirror row_mask:0xf bank_mask:0x5
    v_add_f32_dpp v189, v189, v189 row_half_mirror row_mask:0xf bank_mask:0x5
    v_add_f32_dpp v194, v194, v194 row_half_mirror row_mask:0xf bank_mask:0x5
    v_add_f32_dpp v195, v195, v195 row_half_mirror row_mask:0xf bank_mask:0x5
    v_add_f32_dpp v196, v196, v196 row_half_mirror row_mask:0xf bank_mask:0x5
    v_add_f32_dpp v197, v197, v197 row_half_mirror row_mask:0xf bank_mask:0x5
    v_add_f32_dpp v186, v190, v190 row_half_mirror row_mask:0xf bank_mask:0xa
    v_add_f32_dpp v187, v191, v191 row_half_mirror row_mask:0xf bank_mask:0xa
    v_add_f32_dpp v188, v192, v192 row_half_mirror row_mask:0xf bank_mask:0xa
    v_add_f32_dpp v189, v193, v193 row_half_mirror row_mask:0xf bank_mask:0xa
    v_add_f32_dpp v194, v198, v198 row_half_mirror row_mask:0xf bank_mask:0xa
    v_add_f32_dpp v195, v199, v199 row_half_mirror row_mask:0xf bank_mask:0xa
    v_add_f32_dpp v196, v200, v200 row_half_mirror row_mask:0xf bank_mask:0xa
    v_add_f32_dpp v197, v201, v201 row_half_mirror row_mask:0xf bank_mask:0xa
    v_add_f32_dpp v186, v186, v186 quad_perm:[1,0,3,2] row_mask:0xf bank_mask:0xf
    v_add_f32_dpp v187, v187, v187 quad_perm:[1,0,3,2] row_mask:0xf bank_mask:0xf
    v_add_f32_dpp v188, v188, v188 quad_perm:[1,0,3,2] row_mask:0xf bank_mask:0xf
    v_add_f32_dpp v189, v189, v189 quad_perm:[1,0,3,2] row_mask:0xf bank_mask:0xf
    v_add_f32_dpp v194, v194, v194 quad_perm:[1,0,3,2] row_mask:0xf bank_mask:0xf
    v_add_f32_dpp v195, v195, v195 quad_perm:[1,0,3,2] row_mask:0xf bank_mask:0xf
    v_add_f32_dpp v196, v196, v196 quad_perm:[1,0,3,2] row_mask:0xf bank_mask:0xf
    v_add_f32_dpp v197, v197, v197 quad_perm:[1,0,3,2] row_mask:0xf bank_mask:0xf
    v_add_f32_dpp v186, v186, v186 quad_perm:[2,3,0,1] row_mask:0xf bank_mask:0xf
    v_add_f32_dpp v187, v187, v187 quad_perm:[2,3,0,1] row_mask:0xf bank_mask:0xf
    v_add_f32_dpp v188, v188, v188 quad_perm:[2,3,0,1] row_mask:0xf bank_mask:0xf
    v_add_f32_dpp v189, v189, v189 quad_perm:[2,3,0,1] row_mask:0xf bank_mask:0xf
    v_add_f32_dpp v194, v194, v194 quad_perm:[2,3,0,1] row_mask:0xf bank_mask:0xf
    v_add_f32_dpp v195, v195, v195 quad_perm:[2,3,0,1] row_mask:0xf bank_mask:0xf
    v_add_f32_dpp v196, v196, v196 quad_perm:[2,3,0,1] row_mask:0xf bank_mask:0xf
    v_add_f32_dpp v197, v197, v197 quad_perm:[2,3,0,1] row_mask:0xf bank_mask:0xf
    v_lshrrev_b32 v202, 3, v7
    v_lshlrev_b32 v202, 9, v202
    v_bfe_u32 v203, v7, 2, 1
    v_lshl_add_u32 v202, v203, 6, v202
    s_lshl_b32 s10, s16, 10
    v_add_u32 v202, s10, v202
    v_add_u32 v203, v202, v9
    v_add_u32 v202, v202, v8
    s_mov_b32 exec_lo, 0x11111111
    s_mov_b32 exec_hi, 0x11111111
    ds_write_b128 v202, v[186:189] offset:2560
    ds_write_b128 v203, v[194:197] offset:2560
    s_mov_b64 exec, -1
    s_add_u32 s10, s51, 139264
    v_and_b32 v3, 31, v1
    v_lshl_add_u32 v2, v3, 2, s10
    s_lshl_b32 s11, s21, 14
    s_lshl_b32 s12, s19, 8
    s_add_u32 s12, s12, s11
    s_lshl_b32 s13, s22, 10
    s_add_u32 s12, s12, s13
    s_lshr_b32 s13, s19, 1
    s_lshl_b32 s13, s13, 9
    s_add_u32 s11, s11, s13
    v_lshlrev_b32 v3, 3, v3
    v_lshrrev_b32 v5, 5, v1
    v_lshlrev_b32 v5, 13, v5
    v_lshl_add_u32 v5, v3, 1, v5
    s_lshl_b32 s13, s19, 9
    s_add_u32 s13, s13, 143872
    v_add_u32 v4, s13, v3
    s_waitcnt lgkmcnt(0)
    s_barrier
    s_add_u32 s36, s92, 176128
    s_addc_u32 s37, s93, 0
    s_mov_b32 s38, 262144
    s_mov_b32 s39, 0x20000
    ds_read_b32 v88, v2 offset:2560
    ds_read_b32 v89, v2 offset:3072
    ds_read_b32 v90, v2 offset:3584
    ds_read_b32 v91, v2 offset:4096
    s_waitcnt lgkmcnt(0)
    v_add_f32 v88, v88, v90
    v_add_f32 v89, v89, v91
    v_max_f32 v89, 0, v89
    s_mov_b32 exec_hi, 0
    buffer_store_dwordx2 v[88:89], v3, s[36:39], s12 offen sc1
    s_mov_b32 exec_hi, -1
    s_add_u32 m0, s57, 16384
    s_nop 0
    buffer_load_dwordx4 v240, s[24:27], s60 offen sc1 lds
    buffer_load_dwordx4 v240, s[24:27], s60 offen offset:1024 sc1 lds
    buffer_load_dwordx4 v241, s[24:27], s60 offen offset:2048 sc1 lds
    buffer_load_dwordx4 v241, s[24:27], s60 offen offset:3072 sc1 lds
    s_add_u32 m0, s58, 18432
    s_nop 0
    buffer_load_dwordx4 v240, s[28:31], s61 offen sc1 lds
    buffer_load_dwordx4 v240, s[28:31], s61 offen offset:1024 sc1 lds
    buffer_load_dwordx4 v240, s[28:31], s61 offen offset:2048 sc1 lds
    buffer_load_dwordx4 v240, s[28:31], s61 offen offset:3072 sc1 lds
    s_add_u32 m0, s64, 18432
    s_cmp_lt_u32 s19, 2
    s_cbranch_scc0 L_m_g88
    buffer_load_dwordx4 v242, s[28:31], s61 offen sc1 lds
L_m_g88:
    v_readlane_b32 s60, v245, 14
    v_readlane_b32 s61, v246, 14
    s_nop 3
    s_barrier
    s_add_u32 m0, s57, 32768
    s_nop 0
    buffer_load_dwordx4 v240, s[24:27], s60 offen sc1 lds
    buffer_load_dwordx4 v240, s[24:27], s60 offen offset:1024 sc1 lds
    buffer_load_dwordx4 v241, s[24:27], s60 offen offset:2048 sc1 lds
    buffer_load_dwordx4 v241, s[24:27], s60 offen offset:3072 sc1 lds
    s_add_u32 m0, s58, 36864
    s_nop 0
    buffer_load_dwordx4 v240, s[28:31], s61 offen sc1 lds
    buffer_load_dwordx4 v240, s[28:31], s61 offen offset:1024 sc1 lds
    buffer_load_dwordx4 v240, s[28:31], s61 offen offset:2048 sc1 lds
    buffer_load_dwordx4 v240, s[28:31], s61 offen offset:3072 sc1 lds
    s_add_u32 m0, s64, 36864
    s_cmp_lt_u32 s19, 2
    s_cbranch_scc0 L_m_g89
    buffer_load_dwordx4 v242, s[28:31], s61 offen sc1 lds
L_m_g89:
    v_readlane_b32 s60, v245, 15
    v_readlane_b32 s61, v246, 15
    s_nop 3
    s_waitcnt vmcnt(17)
    s_barrier
    s_add_u32 m0, s57, 49152
    s_nop 0
    buffer_load_dwordx4 v240, s[24:27], s60 offen sc1 lds
    buffer_load_dwordx4 v240, s[24:27], s60 offen offset:1024 sc1 lds
    buffer_load_dwordx4 v241, s[24:27], s60 offen offset:2048 sc1 lds
    buffer_load_dwordx4 v241, s[24:27], s60 offen offset:3072 sc1 lds
    s_add_u32 m0, s58, 55296
    s_nop 0
    buffer_load_dwordx4 v240, s[28:31], s61 offen sc1 lds
    buffer_load_dwordx4 v240, s[28:31], s61 offen offset:1024 sc1 lds
    buffer_load_dwordx4 v240, s[28:31], s61 offen offset:2048 sc1 lds
    buffer_load_dwordx4 v240, s[28:31], s61 offen offset:3072 sc1 lds
    s_add_u32 m0, s64, 55296
    s_cmp_lt_u32 s19, 2
    s_cbranch_scc0 L_m_g90
    buffer_load_dwordx4 v242, s[28:31], s61 offen sc1 lds
L_m_g90:
    v_readlane_b32 s60, v245, 16
    v_readlane_b32 s61, v246, 16
    s_nop 3
    s_waitcnt vmcnt(16)
    s_barrier
    s_add_u32 s10, s11, 4096
    buffer_load_dwordx4 v[92:95], v5, s[36:39], s11 offen offset:0 sc1
    buffer_load_dwordx4 v[96:99], v5, s[36:39], s11 offen offset:1024 sc1
    buffer_load_dwordx4 v[100:103], v5, s[36:39], s11 offen offset:2048 sc1
    buffer_load_dwordx4 v[104:107], v5, s[36:39], s11 offen offset:3072 sc1
    buffer_load_dwordx4 v[108:111], v5, s[36:39], s10 offen offset:0 sc1
    buffer_load_dwordx4 v[112:115], v5, s[36:39], s10 offen offset:1024 sc1
    buffer_load_dwordx4 v[116:119], v5, s[36:39], s10 offen offset:2048 sc1
    buffer_load_dwordx4 v[120:123], v5, s[36:39], s10 offen offset:3072 sc1
    s_add_u32 m0, s57, 0
    s_nop 0
    buffer_load_dwordx4 v240, s[24:27], s60 offen sc1 lds
    buffer_load_dwordx4 v240, s[24:27], s60 offen offset:1024 sc1 lds
    buffer_load_dwordx4 v241, s[24:27], s60 offen offset:2048 sc1 lds
    buffer_load_dwordx4 v241, s[24:27], s60 offen offset:3072 sc1 lds
    s_add_u32 m0, s58, 0
    s_nop 0
    buffer_load_dwordx4 v240, s[28:31], s61 offen sc1 lds
    buffer_load_dwordx4 v240, s[28:31], s61 offen offset:1024 sc1 lds
    buffer_load_dwordx4 v240, s[28:31], s61 offen offset:2048 sc1 lds
    buffer_load_dwordx4 v240, s[28:31], s61 offen offset:3072 sc1 lds
    s_add_u32 m0, s64, 0
    s_cmp_lt_u32 s19, 2
    s_cbranch_scc0 L_m_g91
    buffer_load_dwordx4 v242, s[28:31], s61 offen sc1 lds
L_m_g91:
    v_readlane_b32 s60, v245, 17
    v_readlane_b32 s61, v246, 17
    s_nop 3
    s_waitcnt vmcnt(24)
    s_barrier
    s_add_u32 m0, s57, 16384
    s_nop 0
    buffer_load_dwordx4 v240, s[24:27], s60 offen sc1 lds
    buffer_load_dwordx4 v240, s[24:27], s60 offen offset:1024 sc1 lds
    buffer_load_dwordx4 v241, s[24:27], s60 offen offset:2048 sc1 lds
    buffer_load_dwordx4 v241, s[24:27], s60 offen offset:3072 sc1 lds
    s_add_u32 m0, s58, 18432
    s_nop 0
    buffer_load_dwordx4 v240, s[28:31], s61 offen sc1 lds
    buffer_load_dwordx4 v240, s[28:31], s61 offen offset:1024 sc1 lds
    buffer_load_dwordx4 v240, s[28:31], s61 offen offset:2048 sc1 lds
    buffer_load_dwordx4 v240, s[28:31], s61 offen offset:3072 sc1 lds
    s_add_u32 m0, s64, 18432
    s_cmp_lt_u32 s19, 2
    s_cbranch_scc0 L_m_g92
    buffer_load_dwordx4 v242, s[28:31], s61 offen sc1 lds
L_m_g92:
    v_readlane_b32 s60, v245, 18
    v_readlane_b32 s61, v246, 18
    s_nop 3
    s_mov_b32 s13, 131072
    s_mov_b32 s44, 1
    s_waitcnt vmcnt(16)
    s_branch L_p4_chk
L_p4_poll:
    s_add_u32 s10, s11, 4096
    buffer_load_dwordx4 v[92:95], v5, s[36:39], s11 offen offset:0 sc1
    buffer_load_dwordx4 v[96:99], v5, s[36:39], s11 offen offset:1024 sc1
    buffer_load_dwordx4 v[100:103], v5, s[36:39], s11 offen offset:2048 sc1
    buffer_load_dwordx4 v[104:107], v5, s[36:39], s11 offen offset:3072 sc1
    buffer_load_dwordx4 v[108:111], v5, s[36:39], s10 offen offset:0 sc1
    buffer_load_dwordx4 v[112:115], v5, s[36:39], s10 offen offset:1024 sc1
    buffer_load_dwordx4 v[116:119], v5, s[36:39], s10 offen offset:2048 sc1
    buffer_load_dwordx4 v[120:123], v5, s[36:39], s10 offen offset:3072 sc1
    s_cmp_eq_u32 s44, 0
    s_cbranch_scc1 L_p4_nb
    s_mov_b32 s44, 0
    s_waitcnt vmcnt(8)
    s_barrier
L_p4_nb:
    s_sub_u32 s13, s13, 1
    s_waitcnt vmcnt(0)
L_p4_chk:
    v_min3_i32 v124, v93, v95, v97
    v_min3_i32 v125, v99, v101, v103
    v_min3_i32 v126, v105, v107, v109
    v_min3_i32 v127, v111, v113, v115
    v_min3_i32 v124, v124, v117, v119
    v_min3_i32 v125, v125, v121, v123
    v_min3_i32 v124, v124, v125, v126
    v_min_i32 v124, v124, v127
    v_cmp_gt_i32 vcc, 0, v124
    s_cmp_eq_u32 s13, 0
    s_cbranch_scc1 L_p4_pend
    s_nop 2
    s_cbranch_vccnz L_p4_poll
L_p4_pend:
    v_pk_add_f32 v[92:93], v[92:93], v[108:109]
    v_pk_add_f32 v[94:95], v[94:95], v[110:111]
    v_pk_add_f32 v[96:97], v[96:97], v[112:113]
    v_pk_add_f32 v[98:99], v[98:99], v[114:115]
    v_pk_add_f32 v[100:101], v[100:101], v[116:117]
    v_pk_add_f32 v[102:103], v[102:103], v[118:119]
    v_pk_add_f32 v[104:105], v[104:105], v[120:121]
    v_pk_add_f32 v[106:107], v[106:107], v[122:123]
    v_pk_add_f32 v[92:93], v[92:93], v[100:101]
    v_pk_add_f32 v[94:95], v[94:95], v[102:103]
    v_pk_add_f32 v[96:97], v[96:97], v[104:105]
    v_pk_add_f32 v[98:99], v[98:99], v[106:107]
    v_pk_add_f32 v[92:93], v[92:93], v[96:97]
    v_pk_add_f32 v[94:95], v[94:95], v[98:99]
    v_mov_b32 v96, v92
    v_mov_b32 v97, v93
    v_mov_b32 v98, v94
    v_mov_b32 v99, v95
    s_nop 0
    v_permlane32_swap_b32 v92, v96
    v_permlane32_swap_b32 v93, v97
    v_permlane32_swap_b32 v94, v98
    v_permlane32_swap_b32 v95, v99
    v_pk_add_f32 v[92:93], v[92:93], v[96:97]
    v_pk_add_f32 v[94:95], v[94:95], v[98:99]
    s_mov_b32 s14, 971214393
    v_mov_b32 v100, 925353388
    v_mul_f32 v92, s14, v92
    v_mul_f32 v94, s14, v94
    v_fma_f32 v93, v93, s14, v100
    v_fma_f32 v95, v95, s14, v100
    v_fma_f32 v93, -v92, v92, v93
    v_fma_f32 v95, -v94, v94, v95
    v_max_f32 v93, v93, v100
    v_max_f32 v95, v95, v100
    v_rsq_f32 v96, v93
    v_rsq_f32 v97, v95
    v_and_b32 v3, 1, v6
    v_mul_f32 v98, -v92, v96
    v_mul_f32 v99, -v94, v97
    ds_write_b64 v4, v[96:97]
    ds_write_b64 v4, v[98:99] offset:256
    s_lshl_b32 s10, s16, 7
    s_lshl_b32 s13, s19, 9
    s_add_u32 s13, s13, 143872
    s_add_u32 s10, s10, s13
    v_lshl_add_u32 v8, v6, 4, s10
    v_xor_b32 v9, 128, v8
    v_lshrrev_b32 v4, 1, v6
    v_lshlrev_b32 v4, 8, v4
    v_lshl_add_u32 v4, v3, 9, v4
    v_lshl_add_u32 v4, v7, 4, v4
    s_waitcnt lgkmcnt(0)
    ds_read_b128 v[160:163], v8 offset:0
    ds_read_b128 v[176:179], v8 offset:256
    ds_read_b128 v[164:167], v8 offset:64
    ds_read_b128 v[180:183], v8 offset:320
    ds_read_b128 v[168:171], v9 offset:0
    ds_read_b128 v[184:187], v9 offset:256
    ds_read_b128 v[172:175], v9 offset:64
    ds_read_b128 v[188:191], v9 offset:320
    s_waitcnt lgkmcnt(0)
    v_pk_fma_f32 v[16:17], v[16:17], v[160:161], v[176:177]
    v_pk_fma_f32 v[18:19], v[18:19], v[162:163], v[178:179]
    v_pk_fma_f32 v[20:21], v[20:21], v[164:165], v[180:181]
    v_pk_fma_f32 v[22:23], v[22:23], v[166:167], v[182:183]
    v_cvt_pk_bf16_f32 v88, v16, v17
    v_cvt_pk_bf16_f32 v89, v18, v19
    v_cvt_pk_bf16_f32 v90, v20, v21
    v_cvt_pk_bf16_f32 v91, v22, v23
    s_nop 1
    v_permlane16_swap_b32 v88, v90
    v_permlane16_swap_b32 v89, v91
    v_pk_fma_f32 v[24:25], v[24:25], v[168:169], v[184:185]
    v_pk_fma_f32 v[26:27], v[26:27], v[170:171], v[186:187]
    v_pk_fma_f32 v[28:29], v[28:29], v[172:173], v[188:189]
    v_pk_fma_f32 v[30:31], v[30:31], v[174:175], v[190:191]
    v_cvt_pk_bf16_f32 v92, v24, v25
    v_cvt_pk_bf16_f32 v93, v26, v27
    v_cvt_pk_bf16_f32 v94, v28, v29
    v_cvt_pk_bf16_f32 v95, v30, v31
    s_nop 1
    v_permlane16_swap_b32 v92, v94
    v_permlane16_swap_b32 v93, v95
    v_pk_fma_f32 v[32:33], v[32:33], v[160:161], v[176:177]
    v_pk_fma_f32 v[34:35], v[34:35], v[162:163], v[178:179]
    v_pk_fma_f32 v[36:37], v[36:37], v[164:165], v[180:181]
    v_pk_fma_f32 v[38:39], v[38:39], v[166:167], v[182:183]
    v_cvt_pk_bf16_f32 v96, v32, v33
    v_cvt_pk_bf16_f32 v97, v34, v35
    v_cvt_pk_bf16_f32 v98, v36, v37
    v_cvt_pk_bf16_f32 v99, v38, v39
    s_nop 1
    v_permlane16_swap_b32 v96, v98
    v_permlane16_swap_b32 v97, v99
    v_pk_fma_f32 v[40:41], v[40:41], v[168:169], v[184:185]
    v_pk_fma_f32 v[42:43], v[42:43], v[170:171], v[186:187]
    v_pk_fma_f32 v[44:45], v[44:45], v[172:173], v[188:189]
    v_pk_fma_f32 v[46:47], v[46:47], v[174:175], v[190:191]
    v_cvt_pk_bf16_f32 v100, v40, v41
    v_cvt_pk_bf16_f32 v101, v42, v43
    v_cvt_pk_bf16_f32 v102, v44, v45
    v_cvt_pk_bf16_f32 v103, v46, v47
    s_nop 1
    v_permlane16_swap_b32 v100, v102
    v_permlane16_swap_b32 v101, v103
    v_pk_fma_f32 v[48:49], v[48:49], v[160:161], v[176:177]
    v_pk_fma_f32 v[50:51], v[50:51], v[162:163], v[178:179]
    v_pk_fma_f32 v[52:53], v[52:53], v[164:165], v[180:181]
    v_pk_fma_f32 v[54:55], v[54:55], v[166:167], v[182:183]
    v_cvt_pk_bf16_f32 v104, v48, v49
    v_cvt_pk_bf16_f32 v105, v50, v51
    v_cvt_pk_bf16_f32 v106, v52, v53
    v_cvt_pk_bf16_f32 v107, v54, v55
    s_nop 1
    v_permlane16_swap_b32 v104, v106
    v_permlane16_swap_b32 v105, v107
    v_pk_fma_f32 v[56:57], v[56:57], v[168:169], v[184:185]
    v_pk_fma_f32 v[58:59], v[58:59], v[170:171], v[186:187]
    v_pk_fma_f32 v[60:61], v[60:61], v[172:173], v[188:189]
    v_pk_fma_f32 v[62:63], v[62:63], v[174:175], v[190:191]
    v_cvt_pk_bf16_f32 v108, v56, v57
    v_cvt_pk_bf16_f32 v109, v58, v59
    v_cvt_pk_bf16_f32 v110, v60, v61
    v_cvt_pk_bf16_f32 v111, v62, v63
    s_nop 1
    v_permlane16_swap_b32 v108, v110
    v_permlane16_swap_b32 v109, v111
    v_pk_fma_f32 v[64:65], v[64:65], v[160:161], v[176:177]
    v_pk_fma_f32 v[66:67], v[66:67], v[162:163], v[178:179]
    v_pk_fma_f32 v[68:69], v[68:69], v[164:165], v[180:181]
    v_pk_fma_f32 v[70:71], v[70:71], v[166:167], v[182:183]
    v_cvt_pk_bf16_f32 v112, v64, v65
    v_cvt_pk_bf16_f32 v113, v66, v67
    v_cvt_pk_bf16_f32 v114, v68, v69
    v_cvt_pk_bf16_f32 v115, v70, v71
    s_nop 1
    v_permlane16_swap_b32 v112, v114
    v_permlane16_swap_b32 v113, v115
    v_pk_fma_f32 v[72:73], v[72:73], v[168:169], v[184:185]
    v_pk_fma_f32 v[74:75], v[74:75], v[170:171], v[186:187]
    v_pk_fma_f32 v[76:77], v[76:77], v[172:173], v[188:189]
    v_pk_fma_f32 v[78:79], v[78:79], v[174:175], v[190:191]
    v_cvt_pk_bf16_f32 v116, v72, v73
    v_cvt_pk_bf16_f32 v117, v74, v75
    v_cvt_pk_bf16_f32 v118, v76, v77
    v_cvt_pk_bf16_f32 v119, v78, v79
    s_nop 1
    v_permlane16_swap_b32 v116, v118
    v_permlane16_swap_b32 v117, v119
    v_pk_fma_f32 v[80:81], v[80:81], v[160:161], v[176:177]
    v_pk_fma_f32 v[82:83], v[82:83], v[162:163], v[178:179]
    v_pk_fma_f32 v[84:85], v[84:85], v[164:165], v[180:181]
    v_pk_fma_f32 v[86:87], v[86:87], v[166:167], v[182:183]
    v_cvt_pk_bf16_f32 v120, v80, v81
    v_cvt_pk_bf16_f32 v121, v82, v83
    v_cvt_pk_bf16_f32 v122, v84, v85
    v_cvt_pk_bf16_f32 v123, v86, v87
    s_nop 1
    v_permlane16_swap_b32 v120, v122
    v_permlane16_swap_b32 v121, v123
    s_cmp_eq_u32 s44, 0
    s_cbranch_scc1 L_p4_nc
    s_waitcnt vmcnt(0)
    s_barrier
L_p4_nc:
    buffer_store_dwordx4 v[88:91], v4, s[32:35], s48 offen sc1
    buffer_store_dwordx4 v[92:95], v4, s[32:35], s49 offen sc1
    s_add_u32 s48, s48, 65536
    s_add_u32 s49, s49, 65536
    buffer_store_dwordx4 v[96:99], v4, s[32:35], s48 offen sc1
    buffer_store_dwordx4 v[100:103], v4, s[32:35], s49 offen sc1
    s_add_u32 s48, s48, 65536
    s_add_u32 s49, s49, 65536
    buffer_store_dwordx4 v[104:107], v4, s[32:35], s48 offen sc1
    buffer_store_dwordx4 v[108:111], v4, s[32:35], s49 offen sc1
    s_add_u32 s48, s48, 65536
    s_add_u32 s49, s49, 65536
    buffer_store_dwordx4 v[112:115], v4, s[32:35], s48 offen sc1
    buffer_store_dwordx4 v[116:119], v4, s[32:35], s49 offen sc1
    s_add_u32 s48, s48, 65536
    s_add_u32 s49, s49, 65536
    buffer_store_dwordx4 v[120:123], v4, s[32:35], s50 offen sc1
    s_waitcnt vmcnt(0)
    v_mov_b32 v2, 163792
    v_mov_b32 v3, 1
    s_mov_b64 exec, 1
    ds_add_rtn_u32 v3, v2, v3
    s_mov_b64 exec, -1
    s_waitcnt lgkmcnt(0)
    v_readfirstlane_b32 s10, v3
    s_cmp_eq_u32 s10, 3
    s_cbranch_scc0 L_p4_end
    s_lshl_b32 s10, s2, 7
    s_add_u32 s10, s10, 196608
    v_mov_b32 v2, s3
    v_mov_b32 v3, 0
    s_mov_b64 exec, 1
    buffer_store_dword v2, v3, s[96:99], s10 offen sc1
    s_mov_b64 exec, -1
L_p4_end:
L_ph5:
    s_and_b32 s10, s2, 56
    s_add_u32 s10, s10, s20
    s_cmp_eq_u32 s10, 7
    s_cbranch_scc0 L_ph5n
    v_lshlrev_b32 v250, 7, v1
    s_mov_b32 s10, L_ph5-adaLN_cond__softmax_full_mha__mixer_gmlp__prompt_kernel-0
    buffer_load_dword v251, v250, s[4:7], s10 offen
    s_add_u32 s10, s10, 8192
    buffer_load_dword v251, v250, s[4:7], s10 offen
    s_add_u32 s10, s10, 8192
L_ph5n:
    s_and_b32 s10, s2, 7
    s_lshr_b32 s11, s2, 3
    s_and_b32 s12, s10, 1
    s_lshl_b32 s12, s12, 3
    s_and_b32 s13, s11, 7
    s_add_u32 s21, s12, s13
    s_lshr_b32 s12, s10, 1
    s_lshl_b32 s12, s12, 2
    s_lshr_b32 s14, s11, 3
    s_add_u32 s22, s12, s14
    s_lshl_b32 s14, s14, 1
    s_add_u32 s23, s13, s14
    s_and_b32 s19, s20, 3
    s_cmp_ge_u32 s20, 4
    s_cbranch_scc0 L_p5_cons
    s_mul_i32 s10, s21, 524288
    s_mul_i32 s11, s22, 589824
    s_mov_b32 s41, 4096
    v_lshrrev_b32 v2, 3, v1
    v_lshrrev_b32 v3, 4, v1
    v_xor_b32 v3, v3, v1
    v_and_b32 v3, 7, v3
    v_lshlrev_b32 v3, 4, v3
    v_mad_u32_u24 v2, v2, s41, v3
    v_xor_b32 v3, 64, v2
    v_add_u32 v4, 31744, v3
    v_add_u32 v5, 63488, v2
    v_add_u32 v6, 95232, v3
    s_mul_i32 s43, s19, 4096
    v_lshlrev_b32 v7, 4, v1
    v_add_u32 v8, 63488, v7
    s_mul_i32 s41, s19, 4294837248
    s_add_u32 s41, s41, 524288
    v_add_u32 v9, s41, v7
    s_lshl_b32 s50, s19, 10
    s_add_u32 s50, s50, 81920
    s_mul_i32 s44, s19, 4096
    s_add_u32 s44, s44, 65536
    v_subrev_u32 v12, 32, v1
    v_min_u32 v12, v12, v1
    v_subrev_u32 v10, s23, v12
    v_add_u32 v10, 4, v10
    v_and_b32 v10, 7, v10
    v_cmp_gt_u32 vcc, 6, v10
    v_mov_b32 v11, 0
    s_nop 0
    v_cndmask_b32 v11, v11, -2, vcc
    v_cmp_gt_u32 vcc, 2, v10
    v_sub_u32 v10, v12, v10
    v_subrev_u32 v10, 0, v10
    v_cndmask_b32 v11, v11, 4, vcc
    v_cmp_ge_u32 vcc, 26, v10
    s_nop 1
    v_cndmask_b32 v11, 0, v11, vcc
    v_add_u32 v11, v11, v12
    v_cmp_le_u32 vcc, 32, v1
    v_mul_u32_u24 v12, 128, v11
    v_mul_u32_u24 v13, 2048, v11
    s_mov_b32 s46, 0
    s_mov_b32 s47, 0
    s_mul_i32 s41, s19, 131072
    s_sub_u32 s26, 524288, s41
    s_add_u32 s41, s41, s10
    s_add_u32 s24, s78, s41
    s_addc_u32 s25, s79, 0
    s_mov_b32 s27, 0x20000
    s_mul_i32 s41, s19, 131072
    s_sub_u32 s30, 589824, s41
    s_add_u32 s41, s41, s11
    s_add_u32 s41, s41, 14319616
    s_add_u32 s28, s92, s41
    s_addc_u32 s29, s93, 0
    s_mov_b32 s31, 0x20000
    v_readlane_b32 s46, v12, 0
    v_readlane_b32 s47, v13, 0
    s_nop 3
    v_mov_b32 v20, 163796
    s_mov_b32 s11, 131072
L_m_sp93:
    ds_read_b32 v21, v20
    s_sub_u32 s11, s11, 1
    s_waitcnt lgkmcnt(0)
    v_readfirstlane_b32 s10, v21
    s_cmp_eq_u32 s11, 0
    s_cbranch_scc1 L_m_se94
    s_cmp_eq_u32 s10, 4
    s_cbranch_scc0 L_m_sp93
L_m_se94:
    s_add_u32 m0, s43, 0
    s_nop 0
    buffer_load_dwordx4 v2, s[24:27], s46 offen  lds
    buffer_load_dwordx4 v4, s[24:27], s46 offen offset:1024  lds
    buffer_load_dwordx4 v5, s[24:27], s46 offen offset:2048  lds
    buffer_load_dwordx4 v6, s[24:27], s46 offen offset:3072  lds
    v_readlane_b32 s46, v12, 1
    s_nop 3
    s_add_u32 m0, s43, 16384
    s_nop 0
    buffer_load_dwordx4 v2, s[24:27], s46 offen  lds
    buffer_load_dwordx4 v4, s[24:27], s46 offen offset:1024  lds
    buffer_load_dwordx4 v5, s[24:27], s46 offen offset:2048  lds
    buffer_load_dwordx4 v6, s[24:27], s46 offen offset:3072  lds
    v_readlane_b32 s46, v12, 2
    s_nop 3
    s_add_u32 m0, s43, 32768
    s_nop 0
    buffer_load_dwordx4 v2, s[24:27], s46 offen  lds
    buffer_load_dwordx4 v4, s[24:27], s46 offen offset:1024  lds
    buffer_load_dwordx4 v5, s[24:27], s46 offen offset:2048  lds
    buffer_load_dwordx4 v6, s[24:27], s46 offen offset:3072  lds
    v_readlane_b32 s46, v12, 3
    s_nop 3
    s_cmp_eq_u32 s19, 0
    s_cbranch_scc0 L_m_gw95
    v_and_b32 v22, 15, v1
    v_mov_b32 v23, s22
    v_lshrrev_b32 v20, 3, v22
    v_lshrrev_b32 v21, 2, v23
    v_lshl_add_u32 v20, v21, 1, v20
    v_and_b32 v21, 7, v22
    v_lshl_add_u32 v20, v21, 3, v20
    v_and_b32 v21, 3, v23
    v_lshl_add_u32 v20, v21, 6, v20
    v_lshlrev_b32 v20, 7, v20
    v_add_u32 v20, 196608, v20
    s_mov_b32 s11, 131072
L_m_pl97:
    buffer_load_dword v248, v20, s[96:99], 0 offen sc1
    s_waitcnt vmcnt(0)
    v_cmp_ne_u32 vcc, s3, v248
    s_sub_u32 s11, s11, 1
    s_cmp_eq_u32 s11, 0
    s_cbranch_scc1 L_m_pe98
    s_cbranch_vccnz L_m_pl97
L_m_pe98:
    v_mov_b32 v20, 163804
    v_mov_b32 v21, 1
    ds_write_b32 v20, v21
    s_branch L_m_gx96
L_m_gw95:
    v_mov_b32 v20, 163804
    s_mov_b32 s11, 131072
L_m_sp99:
    ds_read_b32 v21, v20
    s_sub_u32 s11, s11, 1
    s_waitcnt lgkmcnt(0)
    v_readfirstlane_b32 s10, v21
    s_cmp_eq_u32 s11, 0
    s_cbranch_scc1 L_m_se100
    s_cmp_eq_u32 s10, 1
    s_cbranch_scc0 L_m_sp99
L_m_se100:
L_m_gx96:
    s_mov_b32 s60, s90
    s_mov_b32 s61, s91
    s_mov_b32 s62, 256
    s_mov_b32 s63, 0x20000
    s_or_b32 s10, s2, s19
    s_cmp_eq_u32 s10, 0
    s_cbranch_scc0 L_p5_nc
    v_mov_b32 v20, 0
    s_mov_b64 exec, 1
    buffer_store_dword v20, v20, s[60:63], 0 offen sc1
    s_mov_b64 exec, -1
L_p5_nc:
    s_add_u32 m0, s44, 0
    s_nop 0
    buffer_load_dwordx4 v7, s[28:31], s47 offen sc1 lds
    buffer_load_dwordx4 v7, s[28:31], s47 offen offset:1024 sc1 lds
    buffer_load_dwordx4 v8, s[28:31], s47 offen offset:2048 sc1 lds
    buffer_load_dwordx4 v8, s[28:31], s47 offen offset:3072 sc1 lds
    s_add_u32 m0, s50, 0
    s_cmp_lt_u32 s19, 2
    s_cbranch_scc0 L_m_g101
    buffer_load_dwordx4 v9, s[28:31], s47 offen sc1 lds
L_m_g101:
    v_readlane_b32 s47, v13, 1
    s_nop 3
    s_add_u32 m0, s44, 18432
    s_nop 0
    buffer_load_dwordx4 v7, s[28:31], s47 offen sc1 lds
    buffer_load_dwordx4 v7, s[28:31], s47 offen offset:1024 sc1 lds
    buffer_load_dwordx4 v8, s[28:31], s47 offen offset:2048 sc1 lds
    buffer_load_dwordx4 v8, s[28:31], s47 offen offset:3072 sc1 lds
    s_add_u32 m0, s50, 18432
    s_cmp_lt_u32 s19, 2
    s_cbranch_scc0 L_m_g102
    buffer_load_dwordx4 v9, s[28:31], s47 offen sc1 lds
L_m_g102:
    v_readlane_b32 s47, v13, 2
    s_nop 3
    s_add_u32 m0, s44, 36864
    s_nop 0
    buffer_load_dwordx4 v7, s[28:31], s47 offen sc1 lds
    buffer_load_dwordx4 v7, s[28:31], s47 offen offset:1024 sc1 lds
    buffer_load_dwordx4 v8, s[28:31], s47 offen offset:2048 sc1 lds
    buffer_load_dwordx4 v8, s[28:31], s47 offen offset:3072 sc1 lds
    s_add_u32 m0, s50, 36864
    s_cmp_lt_u32 s19, 2
    s_cbranch_scc0 L_m_g103
    buffer_load_dwordx4 v9, s[28:31], s47 offen sc1 lds
L_m_g103:
    v_readlane_b32 s47, v13, 3
    s_nop 3
    s_mov_b32 s40, 4
    s_waitcnt vmcnt(8)
    s_barrier
    s_add_u32 m0, s43, 49152
    s_nop 0
    buffer_load_dwordx4 v2, s[24:27], s46 offen  lds
    buffer_load_dwordx4 v4, s[24:27], s46 offen offset:1024  lds
    buffer_load_dwordx4 v5, s[24:27], s46 offen offset:2048  lds
    buffer_load_dwordx4 v6, s[24:27], s46 offen offset:3072  lds
    s_add_u32 m0, s44, 55296
    s_nop 0
    buffer_load_dwordx4 v7, s[28:31], s47 offen sc1 lds
    buffer_load_dwordx4 v7, s[28:31], s47 offen offset:1024 sc1 lds
    buffer_load_dwordx4 v8, s[28:31], s47 offen offset:2048 sc1 lds
    buffer_load_dwordx4 v8, s[28:31], s47 offen offset:3072 sc1 lds
    s_add_u32 m0, s50, 55296
    s_cmp_lt_u32 s19, 2
    s_cbranch_scc0 L_m_g104
    buffer_load_dwordx4 v9, s[28:31], s47 offen sc1 lds
L_m_g104:
    v_readlane_b32 s46, v12, s40
    v_readlane_b32 s47, v13, s40
    s_add_u32 s40, s40, 1
    s_nop 0
    s_waitcnt vmcnt(12)
    s_barrier
    s_add_u32 m0, s43, 0
    s_nop 0
    buffer_load_dwordx4 v2, s[24:27], s46 offen  lds
    buffer_load_dwordx4 v4, s[24:27], s46 offen offset:1024  lds
    buffer_load_dwordx4 v5, s[24:27], s46 offen offset:2048  lds
    buffer_load_dwordx4 v6, s[24:27], s46 offen offset:3072  lds
    s_add_u32 m0, s44, 0
    s_nop 0
    buffer_load_dwordx4 v7, s[28:31], s47 offen sc1 lds
    buffer_load_dwordx4 v7, s[28:31], s47 offen offset:1024 sc1 lds
    buffer_load_dwordx4 v8, s[28:31], s47 offen offset:2048 sc1 lds
    buffer_load_dwordx4 v8, s[28:31], s47 offen offset:3072 sc1 lds
    s_add_u32 m0, s50, 0
    s_cmp_lt_u32 s19, 2
    s_cbranch_scc0 L_m_g105
    buffer_load_dwordx4 v9, s[28:31], s47 offen sc1 lds
L_m_g105:
    v_readlane_b32 s46, v12, s40
    v_readlane_b32 s47, v13, s40
    s_add_u32 s40, s40, 1
    s_nop 0
    s_waitcnt vmcnt(16)
    s_barrier
    s_add_u32 m0, s43, 16384
    s_nop 0
    buffer_load_dwordx4 v2, s[24:27], s46 offen  lds
    buffer_load_dwordx4 v4, s[24:27], s46 offen offset:1024  lds
    buffer_load_dwordx4 v5, s[24:27], s46 offen offset:2048  lds
    buffer_load_dwordx4 v6, s[24:27], s46 offen offset:3072  lds
    s_add_u32 m0, s44, 18432
    s_nop 0
    buffer_load_dwordx4 v7, s[28:31], s47 offen sc1 lds
    buffer_load_dwordx4 v7, s[28:31], s47 offen offset:1024 sc1 lds
    buffer_load_dwordx4 v8, s[28:31], s47 offen offset:2048 sc1 lds
    buffer_load_dwordx4 v8, s[28:31], s47 offen offset:3072 sc1 lds
    s_add_u32 m0, s50, 18432
    s_cmp_lt_u32 s19, 2
    s_cbranch_scc0 L_m_g106
    buffer_load_dwordx4 v9, s[28:31], s47 offen sc1 lds
L_m_g106:
    v_readlane_b32 s46, v12, s40
    v_readlane_b32 s47, v13, s40
    s_add_u32 s40, s40, 1
    s_nop 0
    s_mov_b32 s42, 6
L_m_ld107:
    s_waitcnt vmcnt(16)
    s_barrier
    s_add_u32 m0, s43, 32768
    s_nop 0
    buffer_load_dwordx4 v2, s[24:27], s46 offen  lds
    buffer_load_dwordx4 v4, s[24:27], s46 offen offset:1024  lds
    buffer_load_dwordx4 v5, s[24:27], s46 offen offset:2048  lds
    buffer_load_dwordx4 v6, s[24:27], s46 offen offset:3072  lds
    s_add_u32 m0, s44, 36864
    s_nop 0
    buffer_load_dwordx4 v7, s[28:31], s47 offen sc1 lds
    buffer_load_dwordx4 v7, s[28:31], s47 offen offset:1024 sc1 lds
    buffer_load_dwordx4 v8, s[28:31], s47 offen offset:2048 sc1 lds
    buffer_load_dwordx4 v8, s[28:31], s47 offen offset:3072 sc1 lds
    s_add_u32 m0, s50, 36864
    s_cmp_lt_u32 s19, 2
    s_cbranch_scc0 L_m_g108
    buffer_load_dwordx4 v9, s[28:31], s47 offen sc1 lds
L_m_g108:
    v_readlane_b32 s46, v12, s40
    v_readlane_b32 s47, v13, s40
    s_add_u32 s40, s40, 1
    s_nop 0
    s_waitcnt vmcnt(16)
    s_barrier
    s_add_u32 m0, s43, 49152
    s_nop 0
    buffer_load_dwordx4 v2, s[24:27], s46 offen  lds
    buffer_load_dwordx4 v4, s[24:27], s46 offen offset:1024  lds
    buffer_load_dwordx4 v5, s[24:27], s46 offen offset:2048  lds
    buffer_load_dwordx4 v6, s[24:27], s46 offen offset:3072  lds
    s_add_u32 m0, s44, 55296
    s_nop 0
    buffer_load_dwordx4 v7, s[28:31], s47 offen sc1 lds
    buffer_load_dwordx4 v7, s[28:31], s47 offen offset:1024 sc1 lds
    buffer_load_dwordx4 v8, s[28:31], s47 offen offset:2048 sc1 lds
    buffer_load_dwordx4 v8, s[28:31], s47 offen offset:3072 sc1 lds
    s_add_u32 m0, s50, 55296
    s_cmp_lt_u32 s19, 2
    s_cbranch_scc0 L_m_g109
    buffer_load_dwordx4 v9, s[28:31], s47 offen sc1 lds
L_m_g109:
    v_readlane_b32 s46, v12, s40
    v_readlane_b32 s47, v13, s40
    s_add_u32 s40, s40, 1
    s_nop 0
    s_waitcnt vmcnt(16)
    s_barrier
    s_add_u32 m0, s43, 0
    s_nop 0
    buffer_load_dwordx4 v2, s[24:27], s46 offen  lds
    buffer_load_dwordx4 v4, s[24:27], s46 offen offset:1024  lds
    buffer_load_dwordx4 v5, s[24:27], s46 offen offset:2048  lds
    buffer_load_dwordx4 v6, s[24:27], s46 offen offset:3072  lds
    s_add_u32 m0, s44, 0
    s_nop 0
    buffer_load_dwordx4 v7, s[28:31], s47 offen sc1 lds
    buffer_load_dwordx4 v7, s[28:31], s47 offen offset:1024 sc1 lds
    buffer_load_dwordx4 v8, s[28:31], s47 offen offset:2048 sc1 lds
    buffer_load_dwordx4 v8, s[28:31], s47 offen offset:3072 sc1 lds
    s_add_u32 m0, s50, 0
    s_cmp_lt_u32 s19, 2
    s_cbranch_scc0 L_m_g110
    buffer_load_dwordx4 v9, s[28:31], s47 offen sc1 lds
L_m_g110:
    v_readlane_b32 s46, v12, s40
    v_readlane_b32 s47, v13, s40
    s_add_u32 s40, s40, 1
    s_nop 0
    s_waitcnt vmcnt(16)
    s_barrier
    s_add_u32 m0, s43, 16384
    s_nop 0
    buffer_load_dwordx4 v2, s[24:27], s46 offen  lds
    buffer_load_dwordx4 v4, s[24:27], s46 offen offset:1024  lds
    buffer_load_dwordx4 v5, s[24:27], s46 offen offset:2048  lds
    buffer_load_dwordx4 v6, s[24:27], s46 offen offset:3072  lds
    s_add_u32 m0, s44, 18432
    s_nop 0
    buffer_load_dwordx4 v7, s[28:31], s47 offen sc1 lds
    buffer_load_dwordx4 v7, s[28:31], s47 offen offset:1024 sc1 lds
    buffer_load_dwordx4 v8, s[28:31], s47 offen offset:2048 sc1 lds
    buffer_load_dwordx4 v8, s[28:31], s47 offen offset:3072 sc1 lds
    s_add_u32 m0, s50, 18432
    s_cmp_lt_u32 s19, 2
    s_cbranch_scc0 L_m_g111
    buffer_load_dwordx4 v9, s[28:31], s47 offen sc1 lds
L_m_g111:
    v_readlane_b32 s46, v12, s40
    v_readlane_b32 s47, v13, s40
    s_add_u32 s40, s40, 1
    s_nop 0
    s_sub_u32 s42, s42, 1
    s_cmp_lg_u32 s42, 0
    s_cbranch_scc1 L_m_ld107
    s_waitcnt vmcnt(16)
    s_barrier
    s_add_u32 m0, s43, 32768
    s_nop 0
    buffer_load_dwordx4 v2, s[24:27], s46 offen  lds
    buffer_load_dwordx4 v4, s[24:27], s46 offen offset:1024  lds
    buffer_load_dwordx4 v5, s[24:27], s46 offen offset:2048  lds
    buffer_load_dwordx4 v6, s[24:27], s46 offen offset:3072  lds
    s_add_u32 m0, s44, 36864
    s_nop 0
    buffer_load_dwordx4 v7, s[28:31], s47 offen sc1 lds
    buffer_load_dwordx4 v7, s[28:31], s47 offen offset:1024 sc1 lds
    buffer_load_dwordx4 v8, s[28:31], s47 offen offset:2048 sc1 lds
    buffer_load_dwordx4 v8, s[28:31], s47 offen offset:3072 sc1 lds
    s_add_u32 m0, s50, 36864
    s_cmp_lt_u32 s19, 2
    s_cbranch_scc0 L_m_g112
    buffer_load_dwordx4 v9, s[28:31], s47 offen sc1 lds
L_m_g112:
    v_readlane_b32 s46, v12, s40
    v_readlane_b32 s47, v13, s40
    s_add_u32 s40, s40, 1
    s_nop 0
    s_waitcnt vmcnt(16)
    s_barrier
    s_add_u32 m0, s43, 49152
    s_nop 0
    buffer_load_dwordx4 v2, s[24:27], s46 offen  lds
    buffer_load_dwordx4 v4, s[24:27], s46 offen offset:1024  lds
    buffer_load_dwordx4 v5, s[24:27], s46 offen offset:2048  lds
    buffer_load_dwordx4 v6, s[24:27], s46 offen offset:3072  lds
    s_add_u32 m0, s44, 55296
    s_nop 0
    buffer_load_dwordx4 v7, s[28:31], s47 offen sc1 lds
    buffer_load_dwordx4 v7, s[28:31], s47 offen offset:1024 sc1 lds
    buffer_load_dwordx4 v8, s[28:31], s47 offen offset:2048 sc1 lds
    buffer_load_dwordx4 v8, s[28:31], s47 offen offset:3072 sc1 lds
    s_add_u32 m0, s50, 55296
    s_cmp_lt_u32 s19, 2
    s_cbranch_scc0 L_m_g113
    buffer_load_dwordx4 v9, s[28:31], s47 offen sc1 lds
L_m_g113:
    v_readlane_b32 s46, v12, s40
    v_readlane_b32 s47, v13, s40
    s_add_u32 s40, s40, 1
    s_nop 0
    s_waitcnt vmcnt(16)
    s_barrier
    s_and_b32 s10, s2, 56
    s_add_u32 s10, s10, s20
    s_cmp_eq_u32 s10, 7
    s_cbranch_scc0 L_ph6n
    v_lshlrev_b32 v250, 7, v1
    s_mov_b32 s10, L_ph6-adaLN_cond__softmax_full_mha__mixer_gmlp__prompt_kernel-3072
    buffer_load_dword v251, v250, s[4:7], s10 offen
    s_add_u32 s10, s10, 8192
L_ph6n:
    s_and_b32 s10, s2, 7
    s_lshr_b32 s11, s2, 3
    s_lshl_b32 s10, s10, 2
    s_lshr_b32 s12, s11, 3
    s_add_u32 s21, s10, s12
    s_and_b32 s22, s11, 7
    s_lshl_b32 s12, s12, 1
    s_add_u32 s23, s22, s12
    s_mul_i32 s23, s23, 1
    s_and_b32 s19, s20, 3
    s_mul_i32 s10, s21, 294912
    s_mul_i32 s11, s22, 331776
    v_lshlrev_b32 v2, 4, v1
    s_mul_i32 s43, s19, 2048
    s_mul_i32 s41, s19, 4294966272
    s_add_u32 s41, s41, 8192
    v_add_u32 v3, s41, v2
    s_lshl_b32 s50, s19, 10
    s_add_u32 s50, s50, 73728
    s_mul_i32 s44, s19, 2048
    s_add_u32 s44, s44, 65536
    v_subrev_u32 v6, 36, v1
    v_min_u32 v6, v6, v1
    v_subrev_u32 v4, s23, v6
    v_add_u32 v4, 4, v4
    v_and_b32 v4, 7, v4
    v_cmp_gt_u32 vcc, 6, v4
    v_mov_b32 v5, 0
    s_nop 0
    v_cndmask_b32 v5, v5, -2, vcc
    v_cmp_gt_u32 vcc, 2, v4
    v_sub_u32 v4, v6, v4
    v_subrev_u32 v4, 0, v4
    v_cndmask_b32 v5, v5, 4, vcc
    v_cmp_ge_u32 vcc, 30, v4
    s_nop 1
    v_cndmask_b32 v5, 0, v5, vcc
    v_add_u32 v5, v5, v6
    v_cmp_le_u32 vcc, 36, v1
    v_mul_u32_u24 v6, 2048, v5
    v_mul_u32_u24 v7, 9216, v5
    s_mov_b32 s46, 0
    s_mov_b32 s47, 0
    s_mul_i32 s41, s19, 73728
    s_sub_u32 s26, 294912, s41
    s_add_u32 s41, s41, s10
    s_add_u32 s41, s41, 23756800
    s_add_u32 s24, s92, s41
    s_addc_u32 s25, s93, 0
    s_mov_b32 s27, 0x20000
    s_mul_i32 s41, s19, 2048
    s_sub_u32 s30, 331776, s41
    s_add_u32 s41, s41, s11
    s_add_u32 s41, s41, 39186432
    s_add_u32 s28, s92, s41
    s_addc_u32 s29, s93, 0
    s_mov_b32 s31, 0x20000
    v_readlane_b32 s46, v6, 0
    v_readlane_b32 s47, v7, 0
    s_nop 3
    s_add_u32 m0, s44, 0
    s_nop 0
    buffer_load_dwordx4 v2, s[28:31], s47 offen  lds
    buffer_load_dwordx4 v2, s[28:31], s47 offen offset:1024  lds
    s_add_u32 m0, s50, 0
    s_cmp_lt_u32 s19, 1
    s_cbranch_scc0 L_m_g114
    buffer_load_dwordx4 v3, s[28:31], s47 offen  lds
L_m_g114:
    v_readlane_b32 s47, v7, 1
    s_nop 3
    s_add_u32 m0, s44, 9216
    s_nop 0
    buffer_load_dwordx4 v2, s[28:31], s47 offen  lds
    buffer_load_dwordx4 v2, s[28:31], s47 offen offset:1024  lds
    s_add_u32 m0, s50, 9216
    s_cmp_lt_u32 s19, 1
    s_cbranch_scc0 L_m_g115
    buffer_load_dwordx4 v3, s[28:31], s47 offen  lds
L_m_g115:
    v_readlane_b32 s47, v7, 2
    s_nop 3
    s_waitcnt vmcnt(12)
    s_barrier
    s_add_u32 m0, s44, 18432
    s_nop 0
    buffer_load_dwordx4 v2, s[28:31], s47 offen  lds
    buffer_load_dwordx4 v2, s[28:31], s47 offen offset:1024  lds
    s_add_u32 m0, s50, 18432
    s_cmp_lt_u32 s19, 1
    s_cbranch_scc0 L_m_g116
    buffer_load_dwordx4 v3, s[28:31], s47 offen  lds
L_m_g116:
    v_readlane_b32 s47, v7, 3
    s_nop 3
    s_add_u32 m0, s44, 27648
    s_nop 0
    buffer_load_dwordx4 v2, s[28:31], s47 offen  lds
    buffer_load_dwordx4 v2, s[28:31], s47 offen offset:1024  lds
    s_add_u32 m0, s50, 27648
    s_cmp_lt_u32 s19, 1
    s_cbranch_scc0 L_m_g117
    buffer_load_dwordx4 v3, s[28:31], s47 offen  lds
L_m_g117:
    v_readlane_b32 s47, v7, 4
    s_nop 3
    s_waitcnt vmcnt(8)
    s_barrier
    s_add_u32 m0, s44, 36864
    s_nop 0
    buffer_load_dwordx4 v2, s[28:31], s47 offen  lds
    buffer_load_dwordx4 v2, s[28:31], s47 offen offset:1024  lds
    s_add_u32 m0, s50, 36864
    s_cmp_lt_u32 s19, 1
    s_cbranch_scc0 L_m_g118
    buffer_load_dwordx4 v3, s[28:31], s47 offen  lds
L_m_g118:
    v_readlane_b32 s47, v7, 5
    s_nop 3
    s_branch L_p6_ld
L_p5_cons:
    s_mov_b32 s24, s80
    s_mov_b32 s25, s81
    s_mov_b32 s26, 4096
    s_mov_b32 s27, 0x20000
    s_setprio 1
    s_and_b32 s16, s19, 1
    s_xor_b32 s12, s19, 1
    s_lshl_b32 s10, s21, 2
    s_add_u32 s11, s19, s10
    s_add_u32 s17, s12, s10
    v_and_b32 v10, 15, v1
    v_lshlrev_b32 v201, 1, v10
    s_lshl_b32 s43, s11, 6
    s_lshl_b32 s44, s17, 6
    buffer_load_ushort v160, v201, s[24:27], s43 offen offset:0
    buffer_load_ushort v162, v201, s[24:27], s43 offen offset:32
    buffer_load_ushort v164, v201, s[24:27], s44 offen offset:0
    buffer_load_ushort v166, v201, s[24:27], s44 offen offset:32
    s_lshl_b32 s13, s19, 12
    s_lshl_b32 s14, s12, 12
    s_mul_i32 s15, s16, 10240
    s_add_u32 s15, s15, 65536
    v_and_b32 v10, 15, v1
    v_lshrrev_b32 v11, 1, v10
    v_lshrrev_b32 v8, 4, v1
    v_xor_b32 v8, v8, v11
    v_lshlrev_b32 v8, 4, v8
    v_lshl_add_u32 v8, v10, 7, v8
    v_xor_b32 v9, 64, v8
    v_add_u32 v2, s13, v8
    v_add_u32 v3, s13, v9
    v_add_u32 v4, s14, v8
    v_add_u32 v5, s14, v9
    v_lshlrev_b32 v8, 4, v1
    v_add_u32 v6, s15, v8
    v_add_u32 v7, 73728, v8
    s_mul_i32 s13, s22, 9
    s_mul_i32 s14, s16, 5
    s_add_u32 s14, s14, s13
    s_mul_i32 s45, s11, 147456
    s_mul_i32 s47, s17, 147456
    s_lshl_b32 s10, s13, 9
    s_add_u32 s49, s45, s10
    s_add_u32 s49, s49, 2048
    s_lshl_b32 s10, s14, 9
    s_add_u32 s45, s45, s10
    s_add_u32 s47, s47, s10
    s_add_u32 s46, s45, 73728
    s_add_u32 s48, s47, 73728
    s_add_u32 s32, s92, 23756800
    s_addc_u32 s33, s93, 0
    s_mov_b32 s34, 9437184
    s_mov_b32 s35, 0x20000
    v_and_b32 v10, 15, v1
    v_lshrrev_b32 v11, 4, v1
    v_and_b32 v12, 1, v11
    v_lshrrev_b32 v11, 1, v11
    v_lshlrev_b32 v11, 8, v11
    v_lshl_add_u32 v13, v10, 4, v11
    v_lshl_add_u32 v202, v12, 9, v13
    v_mul_u32_u24 v12, 73728, v12
    v_add_u32 v203, v12, v13
    s_mov_b32 s37, 0
    s_mov_b32 s40, 4294918144
    s_mov_b32 s41, 4294912000
    s_waitcnt lgkmcnt(0)
    s_barrier
    ds_read_b128 v[88:91], v2 offset:0
    ds_read_b128 v[104:107], v6 offset:0
    ds_read_b128 v[92:95], v2 offset:2048
    ds_read_b128 v[96:99], v4 offset:0
    ds_read_b128 v[100:103], v4 offset:2048
    ds_read_b128 v[108:111], v6 offset:2048
    ds_read_b128 v[112:115], v6 offset:4096
    ds_read_b128 v[116:119], v6 offset:6144
    ds_read_b128 v[120:123], v7 offset:0
    s_waitcnt lgkmcnt(7)
    v_mfma_f32_16x16x32_bf16 v[16:19], v[104:107], v[88:91], 0
    ds_read_b128 v[206:209], v3 offset:0
    s_waitcnt lgkmcnt(7)
    v_mfma_f32_16x16x32_bf16 v[20:23], v[104:107], v[92:95], 0
    ds_read_b128 v[222:225], v6 offset:1024
    s_waitcnt lgkmcnt(7)
    v_mfma_f32_16x16x32_bf16 v[24:27], v[104:107], v[96:99], 0
    ds_read_b128 v[210:213], v3 offset:2048
    s_waitcnt lgkmcnt(7)
    v_mfma_f32_16x16x32_bf16 v[28:31], v[104:107], v[100:103], 0
    ds_read_b128 v[214:217], v5 offset:0
    s_waitcnt lgkmcnt(7)
    v_mfma_f32_16x16x32_bf16 v[44:47], v[108:111], v[100:103], 0
    ds_read_b128 v[218:221], v5 offset:2048
    v_mfma_f32_16x16x32_bf16 v[40:43], v[108:111], v[96:99], 0
    ds_read_b128 v[226:229], v6 offset:3072
    v_mfma_f32_16x16x32_bf16 v[36:39], v[108:111], v[92:95], 0
    ds_read_b128 v[230:233], v6 offset:5120
    v_mfma_f32_16x16x32_bf16 v[32:35], v[108:111], v[88:91], 0
    ds_read_b128 v[234:237], v6 offset:7168
    s_waitcnt lgkmcnt(10)
    v_mfma_f32_16x16x32_bf16 v[48:51], v[112:115], v[88:91], 0
    ds_read_b128 v[238:241], v7 offset:1024
    v_mfma_f32_16x16x32_bf16 v[52:55], v[112:115], v[92:95], 0
    s_add_u32 s37, s37, 1
    s_cmp_eq_u32 s37, 4
    s_cselect_b32 s37, 0, s37
    v_mfma_f32_16x16x32_bf16 v[56:59], v[112:115], v[96:99], 0
    s_cselect_b32 s38, s40, 16384
    v_mfma_f32_16x16x32_bf16 v[60:63], v[112:115], v[100:103], 0
    s_cselect_b32 s39, s41, 18432
    s_waitcnt lgkmcnt(10)
    v_mfma_f32_16x16x32_bf16 v[76:79], v[116:119], v[100:103], 0
    v_add_u32 v2, s38, v2
    v_mfma_f32_16x16x32_bf16 v[72:75], v[116:119], v[96:99], 0
    v_add_u32 v3, s38, v3
    v_mfma_f32_16x16x32_bf16 v[68:71], v[116:119], v[92:95], 0
    v_add_u32 v4, s38, v4
    v_mfma_f32_16x16x32_bf16 v[64:67], v[116:119], v[88:91], 0
    v_add_u32 v5, s38, v5
    s_waitcnt lgkmcnt(9)
    v_mfma_f32_16x16x32_bf16 v[80:83], v[120:123], v[88:91], 0
    v_add_u32 v6, s39, v6
    v_mfma_f32_16x16x32_bf16 v[84:87], v[120:123], v[92:95], 0
    v_add_u32 v7, s39, v7
    s_mov_b32 s36, 15
.p2align 3
L_m_mm119:
    s_waitcnt lgkmcnt(7)
    v_mfma_f32_16x16x32_bf16 v[16:19], v[222:225], v[206:209], v[16:19]
    s_waitcnt lgkmcnt(0)
    s_barrier
    ds_read_b128 v[88:91], v2 offset:0
    v_mfma_f32_16x16x32_bf16 v[20:23], v[222:225], v[210:213], v[20:23]
    ds_read_b128 v[104:107], v6 offset:0
    v_mfma_f32_16x16x32_bf16 v[24:27], v[222:225], v[214:217], v[24:27]
    ds_read_b128 v[92:95], v2 offset:2048
    v_mfma_f32_16x16x32_bf16 v[28:31], v[222:225], v[218:221], v[28:31]
    ds_read_b128 v[96:99], v4 offset:0
    v_mfma_f32_16x16x32_bf16 v[44:47], v[226:229], v[218:221], v[44:47]
    ds_read_b128 v[100:103], v4 offset:2048
    v_mfma_f32_16x16x32_bf16 v[40:43], v[226:229], v[214:217], v[40:43]
    ds_read_b128 v[108:111], v6 offset:2048
    v_mfma_f32_16x16x32_bf16 v[36:39], v[226:229], v[210:213], v[36:39]
    ds_read_b128 v[112:115], v6 offset:4096
    v_mfma_f32_16x16x32_bf16 v[32:35], v[226:229], v[206:209], v[32:35]
    ds_read_b128 v[116:119], v6 offset:6144
    v_mfma_f32_16x16x32_bf16 v[48:51], v[230:233], v[206:209], v[48:51]
    ds_read_b128 v[120:123], v7 offset:0
    v_mfma_f32_16x16x32_bf16 v[52:55], v[230:233], v[210:213], v[52:55]
    v_mfma_f32_16x16x32_bf16 v[56:59], v[230:233], v[214:217], v[56:59]
    v_mfma_f32_16x16x32_bf16 v[60:63], v[230:233], v[218:221], v[60:63]
    v_mfma_f32_16x16x32_bf16 v[76:79], v[234:237], v[218:221], v[76:79]
    v_mfma_f32_16x16x32_bf16 v[72:75], v[234:237], v[214:217], v[72:75]
    v_mfma_f32_16x16x32_bf16 v[68:71], v[234:237], v[210:213], v[68:71]
    v_mfma_f32_16x16x32_bf16 v[64:67], v[234:237], v[206:209], v[64:67]
    v_mfma_f32_16x16x32_bf16 v[80:83], v[238:241], v[206:209], v[80:83]
    v_mfma_f32_16x16x32_bf16 v[84:87], v[238:241], v[210:213], v[84:87]
    s_waitcnt lgkmcnt(7)
    v_mfma_f32_16x16x32_bf16 v[16:19], v[104:107], v[88:91], v[16:19]
    ds_read_b128 v[206:209], v3 offset:0
    s_waitcnt lgkmcnt(7)
    v_mfma_f32_16x16x32_bf16 v[20:23], v[104:107], v[92:95], v[20:23]
    ds_read_b128 v[222:225], v6 offset:1024
    s_waitcnt lgkmcnt(7)
    v_mfma_f32_16x16x32_bf16 v[24:27], v[104:107], v[96:99], v[24:27]
    ds_read_b128 v[210:213], v3 offset:2048
    s_waitcnt lgkmcnt(7)
    v_mfma_f32_16x16x32_bf16 v[28:31], v[104:107], v[100:103], v[28:31]
    ds_read_b128 v[214:217], v5 offset:0
    s_waitcnt lgkmcnt(7)
    v_mfma_f32_16x16x32_bf16 v[44:47], v[108:111], v[100:103], v[44:47]
    ds_read_b128 v[218:221], v5 offset:2048
    v_mfma_f32_16x16x32_bf16 v[40:43], v[108:111], v[96:99], v[40:43]
    ds_read_b128 v[226:229], v6 offset:3072
    v_mfma_f32_16x16x32_bf16 v[36:39], v[108:111], v[92:95], v[36:39]
    ds_read_b128 v[230:233], v6 offset:5120
    v_mfma_f32_16x16x32_bf16 v[32:35], v[108:111], v[88:91], v[32:35]
    ds_read_b128 v[234:237], v6 offset:7168
    s_waitcnt lgkmcnt(10)
    v_mfma_f32_16x16x32_bf16 v[48:51], v[112:115], v[88:91], v[48:51]
    ds_read_b128 v[238:241], v7 offset:1024
    v_mfma_f32_16x16x32_bf16 v[52:55], v[112:115], v[92:95], v[52:55]
    s_add_u32 s37, s37, 1
    s_cmp_eq_u32 s37, 4
    s_cselect_b32 s37, 0, s37
    v_mfma_f32_16x16x32_bf16 v[56:59], v[112:115], v[96:99], v[56:59]
    s_cselect_b32 s38, s40, 16384
    v_mfma_f32_16x16x32_bf16 v[60:63], v[112:115], v[100:103], v[60:63]
    s_cselect_b32 s39, s41, 18432
    s_waitcnt lgkmcnt(10)
    v_mfma_f32_16x16x32_bf16 v[76:79], v[116:119], v[100:103], v[76:79]
    v_add_u32 v2, s38, v2
    v_mfma_f32_16x16x32_bf16 v[72:75], v[116:119], v[96:99], v[72:75]
    v_add_u32 v3, s38, v3
    v_mfma_f32_16x16x32_bf16 v[68:71], v[116:119], v[92:95], v[68:71]
    v_add_u32 v4, s38, v4
    v_mfma_f32_16x16x32_bf16 v[64:67], v[116:119], v[88:91], v[64:67]
    v_add_u32 v5, s38, v5
    s_waitcnt lgkmcnt(9)
    v_mfma_f32_16x16x32_bf16 v[80:83], v[120:123], v[88:91], v[80:83]
    v_add_u32 v6, s39, v6
    v_mfma_f32_16x16x32_bf16 v[84:87], v[120:123], v[92:95], v[84:87]
    v_add_u32 v7, s39, v7
    s_waitcnt lgkmcnt(7)
    v_mfma_f32_16x16x32_bf16 v[16:19], v[222:225], v[206:209], v[16:19]
    s_waitcnt lgkmcnt(0)
    s_barrier
    ds_read_b128 v[88:91], v2 offset:0
    v_mfma_f32_16x16x32_bf16 v[20:23], v[222:225], v[210:213], v[20:23]
    ds_read_b128 v[104:107], v6 offset:0
    v_mfma_f32_16x16x32_bf16 v[24:27], v[222:225], v[214:217], v[24:27]
    ds_read_b128 v[92:95], v2 offset:2048
    v_mfma_f32_16x16x32_bf16 v[28:31], v[222:225], v[218:221], v[28:31]
    ds_read_b128 v[96:99], v4 offset:0
    v_mfma_f32_16x16x32_bf16 v[44:47], v[226:229], v[218:221], v[44:47]
    ds_read_b128 v[100:103], v4 offset:2048
    v_mfma_f32_16x16x32_bf16 v[40:43], v[226:229], v[214:217], v[40:43]
    ds_read_b128 v[108:111], v6 offset:2048
    v_mfma_f32_16x16x32_bf16 v[36:39], v[226:229], v[210:213], v[36:39]
    ds_read_b128 v[112:115], v6 offset:4096
    v_mfma_f32_16x16x32_bf16 v[32:35], v[226:229], v[206:209], v[32:35]
    ds_read_b128 v[116:119], v6 offset:6144
    v_mfma_f32_16x16x32_bf16 v[48:51], v[230:233], v[206:209], v[48:51]
    ds_read_b128 v[120:123], v7 offset:0
    v_mfma_f32_16x16x32_bf16 v[52:55], v[230:233], v[210:213], v[52:55]
    v_mfma_f32_16x16x32_bf16 v[56:59], v[230:233], v[214:217], v[56:59]
    v_mfma_f32_16x16x32_bf16 v[60:63], v[230:233], v[218:221], v[60:63]
    v_mfma_f32_16x16x32_bf16 v[76:79], v[234:237], v[218:221], v[76:79]
    v_mfma_f32_16x16x32_bf16 v[72:75], v[234:237], v[214:217], v[72:75]
    v_mfma_f32_16x16x32_bf16 v[68:71], v[234:237], v[210:213], v[68:71]
    v_mfma_f32_16x16x32_bf16 v[64:67], v[234:237], v[206:209], v[64:67]
    v_mfma_f32_16x16x32_bf16 v[80:83], v[238:241], v[206:209], v[80:83]
    v_mfma_f32_16x16x32_bf16 v[84:87], v[238:241], v[210:213], v[84:87]
    s_waitcnt lgkmcnt(7)
    v_mfma_f32_16x16x32_bf16 v[16:19], v[104:107], v[88:91], v[16:19]
    ds_read_b128 v[206:209], v3 offset:0
    s_waitcnt lgkmcnt(7)
    v_mfma_f32_16x16x32_bf16 v[20:23], v[104:107], v[92:95], v[20:23]
    ds_read_b128 v[222:225], v6 offset:1024
    s_waitcnt lgkmcnt(7)
    v_mfma_f32_16x16x32_bf16 v[24:27], v[104:107], v[96:99], v[24:27]
    ds_read_b128 v[210:213], v3 offset:2048
    s_waitcnt lgkmcnt(7)
    v_mfma_f32_16x16x32_bf16 v[28:31], v[104:107], v[100:103], v[28:31]
    ds_read_b128 v[214:217], v5 offset:0
    s_waitcnt lgkmcnt(7)
    v_mfma_f32_16x16x32_bf16 v[44:47], v[108:111], v[100:103], v[44:47]
    ds_read_b128 v[218:221], v5 offset:2048
    v_mfma_f32_16x16x32_bf16 v[40:43], v[108:111], v[96:99], v[40:43]
    ds_read_b128 v[226:229], v6 offset:3072
    v_mfma_f32_16x16x32_bf16 v[36:39], v[108:111], v[92:95], v[36:39]
    ds_read_b128 v[230:233], v6 offset:5120
    v_mfma_f32_16x16x32_bf16 v[32:35], v[108:111], v[88:91], v[32:35]
    ds_read_b128 v[234:237], v6 offset:7168
    s_waitcnt lgkmcnt(10)
    v_mfma_f32_16x16x32_bf16 v[48:51], v[112:115], v[88:91], v[48:51]
    ds_read_b128 v[238:241], v7 offset:1024
    v_mfma_f32_16x16x32_bf16 v[52:55], v[112:115], v[92:95], v[52:55]
    s_add_u32 s37, s37, 1
    s_cmp_eq_u32 s37, 4
    s_cselect_b32 s37, 0, s37
    v_mfma_f32_16x16x32_bf16 v[56:59], v[112:115], v[96:99], v[56:59]
    s_cselect_b32 s38, s40, 16384
    s_cselect_b32 s39, s41, 18432
    v_mfma_f32_16x16x32_bf16 v[60:63], v[112:115], v[100:103], v[60:63]
    v_add_u32 v2, s38, v2
    v_add_u32 v3, s38, v3
    s_waitcnt lgkmcnt(10)
    v_mfma_f32_16x16x32_bf16 v[76:79], v[116:119], v[100:103], v[76:79]
    v_add_u32 v4, s38, v4
    v_mfma_f32_16x16x32_bf16 v[72:75], v[116:119], v[96:99], v[72:75]
    v_add_u32 v5, s38, v5
    v_mfma_f32_16x16x32_bf16 v[68:71], v[116:119], v[92:95], v[68:71]
    v_add_u32 v6, s39, v6
    v_mfma_f32_16x16x32_bf16 v[64:67], v[116:119], v[88:91], v[64:67]
    v_add_u32 v7, s39, v7
    s_waitcnt lgkmcnt(9)
    v_mfma_f32_16x16x32_bf16 v[80:83], v[120:123], v[88:91], v[80:83]
    s_sub_u32 s36, s36, 1
    v_mfma_f32_16x16x32_bf16 v[84:87], v[120:123], v[92:95], v[84:87]
    s_cmp_lg_u32 s36, 0
    s_cbranch_scc1 L_m_mm119
    s_waitcnt lgkmcnt(7)
    v_mfma_f32_16x16x32_bf16 v[16:19], v[222:225], v[206:209], v[16:19]
    s_waitcnt lgkmcnt(0)
    s_barrier
    ds_read_b128 v[88:91], v2 offset:0
    v_mfma_f32_16x16x32_bf16 v[20:23], v[222:225], v[210:213], v[20:23]
    ds_read_b128 v[104:107], v6 offset:0
    v_mfma_f32_16x16x32_bf16 v[24:27], v[222:225], v[214:217], v[24:27]
    ds_read_b128 v[92:95], v2 offset:2048
    v_mfma_f32_16x16x32_bf16 v[28:31], v[222:225], v[218:221], v[28:31]
    ds_read_b128 v[96:99], v4 offset:0
    v_mfma_f32_16x16x32_bf16 v[44:47], v[226:229], v[218:221], v[44:47]
    ds_read_b128 v[100:103], v4 offset:2048
    v_mfma_f32_16x16x32_bf16 v[40:43], v[226:229], v[214:217], v[40:43]
    ds_read_b128 v[108:111], v6 offset:2048
    v_mfma_f32_16x16x32_bf16 v[36:39], v[226:229], v[210:213], v[36:39]
    ds_read_b128 v[112:115], v6 offset:4096
    v_mfma_f32_16x16x32_bf16 v[32:35], v[226:229], v[206:209], v[32:35]
    ds_read_b128 v[116:119], v6 offset:6144
    v_mfma_f32_16x16x32_bf16 v[48:51], v[230:233], v[206:209], v[48:51]
    ds_read_b128 v[120:123], v7 offset:0
    v_mfma_f32_16x16x32_bf16 v[52:55], v[230:233], v[210:213], v[52:55]
    v_mfma_f32_16x16x32_bf16 v[56:59], v[230:233], v[214:217], v[56:59]
    v_mfma_f32_16x16x32_bf16 v[60:63], v[230:233], v[218:221], v[60:63]
    v_mfma_f32_16x16x32_bf16 v[76:79], v[234:237], v[218:221], v[76:79]
    v_mfma_f32_16x16x32_bf16 v[72:75], v[234:237], v[214:217], v[72:75]
    v_mfma_f32_16x16x32_bf16 v[68:71], v[234:237], v[210:213], v[68:71]
    v_mfma_f32_16x16x32_bf16 v[64:67], v[234:237], v[206:209], v[64:67]
    v_mfma_f32_16x16x32_bf16 v[80:83], v[238:241], v[206:209], v[80:83]
    v_mfma_f32_16x16x32_bf16 v[84:87], v[238:241], v[210:213], v[84:87]
    s_waitcnt lgkmcnt(7)
    v_mfma_f32_16x16x32_bf16 v[16:19], v[104:107], v[88:91], v[16:19]
    ds_read_b128 v[206:209], v3 offset:0
    s_waitcnt lgkmcnt(7)
    v_mfma_f32_16x16x32_bf16 v[20:23], v[104:107], v[92:95], v[20:23]
    ds_read_b128 v[222:225], v6 offset:1024
    s_waitcnt lgkmcnt(7)
    v_mfma_f32_16x16x32_bf16 v[24:27], v[104:107], v[96:99], v[24:27]
    ds_read_b128 v[210:213], v3 offset:2048
    s_waitcnt lgkmcnt(7)
    v_mfma_f32_16x16x32_bf16 v[28:31], v[104:107], v[100:103], v[28:31]
    ds_read_b128 v[214:217], v5 offset:0
    s_waitcnt lgkmcnt(7)
    v_mfma_f32_16x16x32_bf16 v[44:47], v[108:111], v[100:103], v[44:47]
    ds_read_b128 v[218:221], v5 offset:2048
    v_mfma_f32_16x16x32_bf16 v[40:43], v[108:111], v[96:99], v[40:43]
    ds_read_b128 v[226:229], v6 offset:3072
    v_mfma_f32_16x16x32_bf16 v[36:39], v[108:111], v[92:95], v[36:39]
    ds_read_b128 v[230:233], v6 offset:5120
    v_mfma_f32_16x16x32_bf16 v[32:35], v[108:111], v[88:91], v[32:35]
    ds_read_b128 v[234:237], v6 offset:7168
    s_waitcnt lgkmcnt(10)
    v_mfma_f32_16x16x32_bf16 v[48:51], v[112:115], v[88:91], v[48:51]
    ds_read_b128 v[238:241], v7 offset:1024
    v_mfma_f32_16x16x32_bf16 v[52:55], v[112:115], v[92:95], v[52:55]
    s_add_u32 s37, s37, 1
    s_cmp_eq_u32 s37, 4
    s_cselect_b32 s37, 0, s37
    v_mfma_f32_16x16x32_bf16 v[56:59], v[112:115], v[96:99], v[56:59]
    s_cselect_b32 s38, s40, 16384
    v_mfma_f32_16x16x32_bf16 v[60:63], v[112:115], v[100:103], v[60:63]
    s_cselect_b32 s39, s41, 18432
    s_waitcnt lgkmcnt(10)
    v_mfma_f32_16x16x32_bf16 v[76:79], v[116:119], v[100:103], v[76:79]
    v_add_u32 v2, s38, v2
    v_mfma_f32_16x16x32_bf16 v[72:75], v[116:119], v[96:99], v[72:75]
    v_add_u32 v3, s38, v3
    v_mfma_f32_16x16x32_bf16 v[68:71], v[116:119], v[92:95], v[68:71]
    v_add_u32 v4, s38, v4
    v_mfma_f32_16x16x32_bf16 v[64:67], v[116:119], v[88:91], v[64:67]
    v_add_u32 v5, s38, v5
    s_waitcnt lgkmcnt(9)
    v_mfma_f32_16x16x32_bf16 v[80:83], v[120:123], v[88:91], v[80:83]
    v_add_u32 v6, s39, v6
    v_mfma_f32_16x16x32_bf16 v[84:87], v[120:123], v[92:95], v[84:87]
    v_add_u32 v7, s39, v7
    s_waitcnt lgkmcnt(7)
    v_mfma_f32_16x16x32_bf16 v[16:19], v[222:225], v[206:209], v[16:19]
    s_waitcnt lgkmcnt(6)
    v_mfma_f32_16x16x32_bf16 v[20:23], v[222:225], v[210:213], v[20:23]
    s_waitcnt lgkmcnt(5)
    v_mfma_f32_16x16x32_bf16 v[24:27], v[222:225], v[214:217], v[24:27]
    s_waitcnt lgkmcnt(4)
    v_mfma_f32_16x16x32_bf16 v[28:31], v[222:225], v[218:221], v[28:31]
    s_waitcnt lgkmcnt(3)
    v_mfma_f32_16x16x32_bf16 v[44:47], v[226:229], v[218:221], v[44:47]
    v_mfma_f32_16x16x32_bf16 v[40:43], v[226:229], v[214:217], v[40:43]
    v_mfma_f32_16x16x32_bf16 v[36:39], v[226:229], v[210:213], v[36:39]
    v_mfma_f32_16x16x32_bf16 v[32:35], v[226:229], v[206:209], v[32:35]
    s_waitcnt lgkmcnt(2)
    v_mfma_f32_16x16x32_bf16 v[48:51], v[230:233], v[206:209], v[48:51]
    v_mfma_f32_16x16x32_bf16 v[52:55], v[230:233], v[210:213], v[52:55]
    v_mfma_f32_16x16x32_bf16 v[56:59], v[230:233], v[214:217], v[56:59]
    v_mfma_f32_16x16x32_bf16 v[60:63], v[230:233], v[218:221], v[60:63]
    s_waitcnt lgkmcnt(1)
    v_mfma_f32_16x16x32_bf16 v[76:79], v[234:237], v[218:221], v[76:79]
    v_mfma_f32_16x16x32_bf16 v[72:75], v[234:237], v[214:217], v[72:75]
    v_mfma_f32_16x16x32_bf16 v[68:71], v[234:237], v[210:213], v[68:71]
    v_mfma_f32_16x16x32_bf16 v[64:67], v[234:237], v[206:209], v[64:67]
    s_waitcnt lgkmcnt(0)
    v_mfma_f32_16x16x32_bf16 v[80:83], v[238:241], v[206:209], v[80:83]
    v_mfma_f32_16x16x32_bf16 v[84:87], v[238:241], v[210:213], v[84:87]
    s_waitcnt vmcnt(0)
    v_lshlrev_b32 v160, 16, v160
    v_lshlrev_b32 v162, 16, v162
    v_lshlrev_b32 v164, 16, v164
    v_lshlrev_b32 v166, 16, v166
    v_pk_add_f32 v[16:17], v[16:17], v[160:161] op_sel_hi:[1,0]
    v_pk_add_f32 v[32:33], v[32:33], v[160:161] op_sel_hi:[1,0]
    v_pk_add_f32 v[18:19], v[18:19], v[160:161] op_sel_hi:[1,0]
    v_pk_add_f32 v[34:35], v[34:35], v[160:161] op_sel_hi:[1,0]
    v_lshlrev_b32 v206, 16, v124
    v_lshlrev_b32 v210, 16, v132
    v_and_b32 v207, 0xffff0000, v124
    v_and_b32 v211, 0xffff0000, v132
    v_lshlrev_b32 v208, 16, v125
    v_lshlrev_b32 v212, 16, v133
    v_and_b32 v209, 0xffff0000, v125
    v_and_b32 v213, 0xffff0000, v133
    v_pk_mul_f32 v[16:17], v[16:17], v[206:207]
    v_pk_mul_f32 v[32:33], v[32:33], v[210:211]
    v_pk_mul_f32 v[18:19], v[18:19], v[208:209]
    v_pk_mul_f32 v[34:35], v[34:35], v[212:213]
    v_cvt_pk_bf16_f32 v88, v16, v17
    v_cvt_pk_bf16_f32 v90, v32, v33
    v_cvt_pk_bf16_f32 v89, v18, v19
    v_cvt_pk_bf16_f32 v91, v34, v35
    s_nop 1
    v_permlane16_swap_b32 v88, v90
    v_permlane16_swap_b32 v89, v91
    buffer_store_dwordx4 v[88:91], v202, s[32:35], s45 offen offset:0 sc1
    v_pk_add_f32 v[48:49], v[48:49], v[160:161] op_sel_hi:[1,0]
    v_pk_add_f32 v[64:65], v[64:65], v[160:161] op_sel_hi:[1,0]
    v_pk_add_f32 v[50:51], v[50:51], v[160:161] op_sel_hi:[1,0]
    v_pk_add_f32 v[66:67], v[66:67], v[160:161] op_sel_hi:[1,0]
    v_lshlrev_b32 v206, 16, v140
    v_lshlrev_b32 v210, 16, v148
    v_and_b32 v207, 0xffff0000, v140
    v_and_b32 v211, 0xffff0000, v148
    v_lshlrev_b32 v208, 16, v141
    v_lshlrev_b32 v212, 16, v149
    v_and_b32 v209, 0xffff0000, v141
    v_and_b32 v213, 0xffff0000, v149
    v_pk_mul_f32 v[48:49], v[48:49], v[206:207]
    v_pk_mul_f32 v[64:65], v[64:65], v[210:211]
    v_pk_mul_f32 v[50:51], v[50:51], v[208:209]
    v_pk_mul_f32 v[66:67], v[66:67], v[212:213]
    v_cvt_pk_bf16_f32 v92, v48, v49
    v_cvt_pk_bf16_f32 v94, v64, v65
    v_cvt_pk_bf16_f32 v93, v50, v51
    v_cvt_pk_bf16_f32 v95, v66, v67
    s_nop 1
    v_permlane16_swap_b32 v92, v94
    v_permlane16_swap_b32 v93, v95
    buffer_store_dwordx4 v[92:95], v202, s[32:35], s45 offen offset:1024 sc1
    v_pk_add_f32 v[20:21], v[20:21], v[162:163] op_sel_hi:[1,0]
    v_pk_add_f32 v[36:37], v[36:37], v[162:163] op_sel_hi:[1,0]
    v_pk_add_f32 v[22:23], v[22:23], v[162:163] op_sel_hi:[1,0]
    v_pk_add_f32 v[38:39], v[38:39], v[162:163] op_sel_hi:[1,0]
    v_lshlrev_b32 v206, 16, v126
    v_lshlrev_b32 v210, 16, v134
    v_and_b32 v207, 0xffff0000, v126
    v_and_b32 v211, 0xffff0000, v134
    v_lshlrev_b32 v208, 16, v127
    v_lshlrev_b32 v212, 16, v135
    v_and_b32 v209, 0xffff0000, v127
    v_and_b32 v213, 0xffff0000, v135
    v_pk_mul_f32 v[20:21], v[20:21], v[206:207]
    v_pk_mul_f32 v[36:37], v[36:37], v[210:211]
    v_pk_mul_f32 v[22:23], v[22:23], v[208:209]
    v_pk_mul_f32 v[38:39], v[38:39], v[212:213]
    v_cvt_pk_bf16_f32 v96, v20, v21
    v_cvt_pk_bf16_f32 v98, v36, v37
    v_cvt_pk_bf16_f32 v97, v22, v23
    v_cvt_pk_bf16_f32 v99, v38, v39
    s_nop 1
    v_permlane16_swap_b32 v96, v98
    v_permlane16_swap_b32 v97, v99
    buffer_store_dwordx4 v[96:99], v202, s[32:35], s46 offen offset:0 sc1
    v_pk_add_f32 v[52:53], v[52:53], v[162:163] op_sel_hi:[1,0]
    v_pk_add_f32 v[68:69], v[68:69], v[162:163] op_sel_hi:[1,0]
    v_pk_add_f32 v[54:55], v[54:55], v[162:163] op_sel_hi:[1,0]
    v_pk_add_f32 v[70:71], v[70:71], v[162:163] op_sel_hi:[1,0]
    v_lshlrev_b32 v206, 16, v142
    v_lshlrev_b32 v210, 16, v150
    v_and_b32 v207, 0xffff0000, v142
    v_and_b32 v211, 0xffff0000, v150
    v_lshlrev_b32 v208, 16, v143
    v_lshlrev_b32 v212, 16, v151
    v_and_b32 v209, 0xffff0000, v143
    v_and_b32 v213, 0xffff0000, v151
    v_pk_mul_f32 v[52:53], v[52:53], v[206:207]
    v_pk_mul_f32 v[68:69], v[68:69], v[210:211]
    v_pk_mul_f32 v[54:55], v[54:55], v[208:209]
    v_pk_mul_f32 v[70:71], v[70:71], v[212:213]
    v_cvt_pk_bf16_f32 v100, v52, v53
    v_cvt_pk_bf16_f32 v102, v68, v69
    v_cvt_pk_bf16_f32 v101, v54, v55
    v_cvt_pk_bf16_f32 v103, v70, v71
    s_nop 1
    v_permlane16_swap_b32 v100, v102
    v_permlane16_swap_b32 v101, v103
    buffer_store_dwordx4 v[100:103], v202, s[32:35], s46 offen offset:1024 sc1
    v_pk_add_f32 v[24:25], v[24:25], v[164:165] op_sel_hi:[1,0]
    v_pk_add_f32 v[40:41], v[40:41], v[164:165] op_sel_hi:[1,0]
    v_pk_add_f32 v[26:27], v[26:27], v[164:165] op_sel_hi:[1,0]
    v_pk_add_f32 v[42:43], v[42:43], v[164:165] op_sel_hi:[1,0]
    v_lshlrev_b32 v206, 16, v128
    v_lshlrev_b32 v210, 16, v136
    v_and_b32 v207, 0xffff0000, v128
    v_and_b32 v211, 0xffff0000, v136
    v_lshlrev_b32 v208, 16, v129
    v_lshlrev_b32 v212, 16, v137
    v_and_b32 v209, 0xffff0000, v129
    v_and_b32 v213, 0xffff0000, v137
    v_pk_mul_f32 v[24:25], v[24:25], v[206:207]
    v_pk_mul_f32 v[40:41], v[40:41], v[210:211]
    v_pk_mul_f32 v[26:27], v[26:27], v[208:209]
    v_pk_mul_f32 v[42:43], v[42:43], v[212:213]
    v_cvt_pk_bf16_f32 v104, v24, v25
    v_cvt_pk_bf16_f32 v106, v40, v41
    v_cvt_pk_bf16_f32 v105, v26, v27
    v_cvt_pk_bf16_f32 v107, v42, v43
    s_nop 1
    v_permlane16_swap_b32 v104, v106
    v_permlane16_swap_b32 v105, v107
    buffer_store_dwordx4 v[104:107], v202, s[32:35], s47 offen offset:0 sc1
    v_pk_add_f32 v[56:57], v[56:57], v[164:165] op_sel_hi:[1,0]
    v_pk_add_f32 v[72:73], v[72:73], v[164:165] op_sel_hi:[1,0]
    v_pk_add_f32 v[58:59], v[58:59], v[164:165] op_sel_hi:[1,0]
    v_pk_add_f32 v[74:75], v[74:75], v[164:165] op_sel_hi:[1,0]
    v_lshlrev_b32 v206, 16, v144
    v_lshlrev_b32 v210, 16, v152
    v_and_b32 v207, 0xffff0000, v144
    v_and_b32 v211, 0xffff0000, v152
    v_lshlrev_b32 v208, 16, v145
    v_lshlrev_b32 v212, 16, v153
    v_and_b32 v209, 0xffff0000, v145
    v_and_b32 v213, 0xffff0000, v153
    v_pk_mul_f32 v[56:57], v[56:57], v[206:207]
    v_pk_mul_f32 v[72:73], v[72:73], v[210:211]
    v_pk_mul_f32 v[58:59], v[58:59], v[208:209]
    v_pk_mul_f32 v[74:75], v[74:75], v[212:213]
    v_cvt_pk_bf16_f32 v108, v56, v57
    v_cvt_pk_bf16_f32 v110, v72, v73
    v_cvt_pk_bf16_f32 v109, v58, v59
    v_cvt_pk_bf16_f32 v111, v74, v75
    s_nop 1
    v_permlane16_swap_b32 v108, v110
    v_permlane16_swap_b32 v109, v111
    buffer_store_dwordx4 v[108:111], v202, s[32:35], s47 offen offset:1024 sc1
    v_pk_add_f32 v[28:29], v[28:29], v[166:167] op_sel_hi:[1,0]
    v_pk_add_f32 v[44:45], v[44:45], v[166:167] op_sel_hi:[1,0]
    v_pk_add_f32 v[30:31], v[30:31], v[166:167] op_sel_hi:[1,0]
    v_pk_add_f32 v[46:47], v[46:47], v[166:167] op_sel_hi:[1,0]
    v_lshlrev_b32 v206, 16, v130
    v_lshlrev_b32 v210, 16, v138
    v_and_b32 v207, 0xffff0000, v130
    v_and_b32 v211, 0xffff0000, v138
    v_lshlrev_b32 v208, 16, v131
    v_lshlrev_b32 v212, 16, v139
    v_and_b32 v209, 0xffff0000, v131
    v_and_b32 v213, 0xffff0000, v139
    v_pk_mul_f32 v[28:29], v[28:29], v[206:207]
    v_pk_mul_f32 v[44:45], v[44:45], v[210:211]
    v_pk_mul_f32 v[30:31], v[30:31], v[208:209]
    v_pk_mul_f32 v[46:47], v[46:47], v[212:213]
    v_cvt_pk_bf16_f32 v112, v28, v29
    v_cvt_pk_bf16_f32 v114, v44, v45
    v_cvt_pk_bf16_f32 v113, v30, v31
    v_cvt_pk_bf16_f32 v115, v46, v47
    s_nop 1
    v_permlane16_swap_b32 v112, v114
    v_permlane16_swap_b32 v113, v115
    buffer_store_dwordx4 v[112:115], v202, s[32:35], s48 offen offset:0 sc1
    v_pk_add_f32 v[60:61], v[60:61], v[166:167] op_sel_hi:[1,0]
    v_pk_add_f32 v[76:77], v[76:77], v[166:167] op_sel_hi:[1,0]
    v_pk_add_f32 v[62:63], v[62:63], v[166:167] op_sel_hi:[1,0]
    v_pk_add_f32 v[78:79], v[78:79], v[166:167] op_sel_hi:[1,0]
    v_lshlrev_b32 v206, 16, v146
    v_lshlrev_b32 v210, 16, v154
    v_and_b32 v207, 0xffff0000, v146
    v_and_b32 v211, 0xffff0000, v154
    v_lshlrev_b32 v208, 16, v147
    v_lshlrev_b32 v212, 16, v155
    v_and_b32 v209, 0xffff0000, v147
    v_and_b32 v213, 0xffff0000, v155
    v_pk_mul_f32 v[60:61], v[60:61], v[206:207]
    v_pk_mul_f32 v[76:77], v[76:77], v[210:211]
    v_pk_mul_f32 v[62:63], v[62:63], v[208:209]
    v_pk_mul_f32 v[78:79], v[78:79], v[212:213]
    v_cvt_pk_bf16_f32 v116, v60, v61
    v_cvt_pk_bf16_f32 v118, v76, v77
    v_cvt_pk_bf16_f32 v117, v62, v63
    v_cvt_pk_bf16_f32 v119, v78, v79
    s_nop 1
    v_permlane16_swap_b32 v116, v118
    v_permlane16_swap_b32 v117, v119
    buffer_store_dwordx4 v[116:119], v202, s[32:35], s48 offen offset:1024 sc1
    v_pk_add_f32 v[80:81], v[80:81], v[160:161] op_sel_hi:[1,0]
    v_pk_add_f32 v[84:85], v[84:85], v[162:163] op_sel_hi:[1,0]
    v_pk_add_f32 v[82:83], v[82:83], v[160:161] op_sel_hi:[1,0]
    v_pk_add_f32 v[86:87], v[86:87], v[162:163] op_sel_hi:[1,0]
    v_lshlrev_b32 v206, 16, v156
    v_lshlrev_b32 v210, 16, v158
    v_and_b32 v207, 0xffff0000, v156
    v_and_b32 v211, 0xffff0000, v158
    v_lshlrev_b32 v208, 16, v157
    v_lshlrev_b32 v212, 16, v159
    v_and_b32 v209, 0xffff0000, v157
    v_and_b32 v213, 0xffff0000, v159
    v_pk_mul_f32 v[80:81], v[80:81], v[206:207]
    v_pk_mul_f32 v[84:85], v[84:85], v[210:211]
    v_pk_mul_f32 v[82:83], v[82:83], v[208:209]
    v_pk_mul_f32 v[86:87], v[86:87], v[212:213]
    v_cvt_pk_bf16_f32 v120, v80, v81
    v_cvt_pk_bf16_f32 v122, v84, v85
    v_cvt_pk_bf16_f32 v121, v82, v83
    v_cvt_pk_bf16_f32 v123, v86, v87
    s_nop 1
    v_permlane16_swap_b32 v120, v122
    v_permlane16_swap_b32 v121, v123
    buffer_store_dwordx4 v[120:123], v203, s[32:35], s49 offen sc1
    s_setprio 0
    s_waitcnt vmcnt(0)
    v_mov_b32 v2, 163812
    v_mov_b32 v3, 1
    s_mov_b64 exec, 1
    ds_add_rtn_u32 v3, v2, v3
    s_mov_b64 exec, -1
    s_waitcnt lgkmcnt(0)
    v_readfirstlane_b32 s10, v3
    s_cmp_eq_u32 s10, 3
    s_cbranch_scc0 L_p5_end
    s_lshl_b32 s10, s2, 7
    s_add_u32 s10, s10, 229376
    v_mov_b32 v2, s3
    v_mov_b32 v3, 0
    s_mov_b64 exec, 1
    buffer_store_dword v2, v3, s[96:99], s10 offen sc1
    s_mov_b64 exec, -1
L_p5_end:
L_ph6:
    s_and_b32 s10, s2, 7
    s_lshr_b32 s11, s2, 3
    s_lshl_b32 s10, s10, 2
    s_lshr_b32 s12, s11, 3
    s_add_u32 s21, s10, s12
    s_and_b32 s22, s11, 7
    s_lshl_b32 s12, s12, 1
    s_add_u32 s23, s22, s12
    s_mul_i32 s23, s23, 1
    s_and_b32 s19, s20, 3
    s_branch L_p6_cons
L_p6_ld:
    s_cmp_eq_u32 s19, 0
    s_cbranch_scc0 L_m_gw120
    s_lshr_b32 s10, s21, 1
    v_mov_b32 v22, s10
    v_and_b32 v23, 15, v1
    v_lshrrev_b32 v20, 3, v22
    v_lshrrev_b32 v21, 2, v23
    v_lshl_add_u32 v20, v21, 1, v20
    v_and_b32 v21, 7, v22
    v_lshl_add_u32 v20, v21, 3, v20
    v_and_b32 v21, 3, v23
    v_lshl_add_u32 v20, v21, 6, v20
    v_lshlrev_b32 v20, 7, v20
    v_add_u32 v20, 229376, v20
    s_mov_b32 s11, 131072
L_m_pl122:
    buffer_load_dword v248, v20, s[96:99], 0 offen sc1
    s_waitcnt vmcnt(0)
    v_cmp_ne_u32 vcc, s3, v248
    s_sub_u32 s11, s11, 1
    s_cmp_eq_u32 s11, 0
    s_cbranch_scc1 L_m_pe123
    s_cbranch_vccnz L_m_pl122
L_m_pe123:
    v_mov_b32 v20, 163816
    v_mov_b32 v21, 1
    ds_write_b32 v20, v21
    s_branch L_m_gx121
L_m_gw120:
    v_mov_b32 v20, 163816
    s_mov_b32 s11, 131072
L_m_sp124:
    ds_read_b32 v21, v20
    s_sub_u32 s11, s11, 1
    s_waitcnt lgkmcnt(0)
    v_readfirstlane_b32 s10, v21
    s_cmp_eq_u32 s11, 0
    s_cbranch_scc1 L_m_se125
    s_cmp_eq_u32 s10, 1
    s_cbranch_scc0 L_m_sp124
L_m_se125:
L_m_gx121:
    s_add_u32 m0, s43, 0
    s_nop 0
    buffer_load_dwordx4 v2, s[24:27], s46 offen sc1 lds
    buffer_load_dwordx4 v2, s[24:27], s46 offen offset:1024 sc1 lds
    v_readlane_b32 s46, v6, 1
    s_nop 3
    s_add_u32 m0, s43, 8192
    s_nop 0
    buffer_load_dwordx4 v2, s[24:27], s46 offen sc1 lds
    buffer_load_dwordx4 v2, s[24:27], s46 offen offset:1024 sc1 lds
    v_readlane_b32 s46, v6, 2
    s_nop 3
    s_add_u32 m0, s43, 16384
    s_nop 0
    buffer_load_dwordx4 v2, s[24:27], s46 offen sc1 lds
    buffer_load_dwordx4 v2, s[24:27], s46 offen offset:1024 sc1 lds
    v_readlane_b32 s46, v6, 3
    s_nop 3
    s_add_u32 m0, s43, 24576
    s_nop 0
    buffer_load_dwordx4 v2, s[24:27], s46 offen sc1 lds
    buffer_load_dwordx4 v2, s[24:27], s46 offen offset:1024 sc1 lds
    v_readlane_b32 s46, v6, 4
    s_nop 3
    s_add_u32 m0, s43, 32768
    s_nop 0
    buffer_load_dwordx4 v2, s[24:27], s46 offen sc1 lds
    buffer_load_dwordx4 v2, s[24:27], s46 offen offset:1024 sc1 lds
    v_readlane_b32 s46, v6, 5
    s_nop 3
    s_mov_b32 s40, 6
    s_waitcnt vmcnt(8)
    s_barrier
    s_add_u32 m0, s43, 40960
    s_nop 0
    buffer_load_dwordx4 v2, s[24:27], s46 offen sc1 lds
    buffer_load_dwordx4 v2, s[24:27], s46 offen offset:1024 sc1 lds
    s_add_u32 m0, s44, 46080
    s_nop 0
    buffer_load_dwordx4 v2, s[28:31], s47 offen  lds
    buffer_load_dwordx4 v2, s[28:31], s47 offen offset:1024  lds
    s_add_u32 m0, s50, 46080
    s_cmp_lt_u32 s19, 1
    s_cbranch_scc0 L_m_g126
    buffer_load_dwordx4 v3, s[28:31], s47 offen  lds
L_m_g126:
    v_readlane_b32 s46, v6, s40
    v_readlane_b32 s47, v7, s40
    s_add_u32 s40, s40, 1
    s_nop 0
    s_waitcnt vmcnt(10)
    s_barrier
    s_add_u32 m0, s43, 0
    s_nop 0
    buffer_load_dwordx4 v2, s[24:27], s46 offen sc1 lds
    buffer_load_dwordx4 v2, s[24:27], s46 offen offset:1024 sc1 lds
    s_add_u32 m0, s44, 0
    s_nop 0
    buffer_load_dwordx4 v2, s[28:31], s47 offen  lds
    buffer_load_dwordx4 v2, s[28:31], s47 offen offset:1024  lds
    s_add_u32 m0, s50, 0
    s_cmp_lt_u32 s19, 1
    s_cbranch_scc0 L_m_g127
    buffer_load_dwordx4 v3, s[28:31], s47 offen  lds
L_m_g127:
    v_readlane_b32 s46, v6, s40
    v_readlane_b32 s47, v7, s40
    s_add_u32 s40, s40, 1
    s_nop 0
    s_waitcnt vmcnt(12)
    s_barrier
    s_add_u32 m0, s43, 8192
    s_nop 0
    buffer_load_dwordx4 v2, s[24:27], s46 offen sc1 lds
    buffer_load_dwordx4 v2, s[24:27], s46 offen offset:1024 sc1 lds
    s_add_u32 m0, s44, 9216
    s_nop 0
    buffer_load_dwordx4 v2, s[28:31], s47 offen  lds
    buffer_load_dwordx4 v2, s[28:31], s47 offen offset:1024  lds
    s_add_u32 m0, s50, 9216
    s_cmp_lt_u32 s19, 1
    s_cbranch_scc0 L_m_g128
    buffer_load_dwordx4 v3, s[28:31], s47 offen  lds
L_m_g128:
    v_readlane_b32 s46, v6, s40
    v_readlane_b32 s47, v7, s40
    s_add_u32 s40, s40, 1
    s_nop 0
    s_waitcnt vmcnt(14)
    s_barrier
    s_add_u32 m0, s43, 16384
    s_nop 0
    buffer_load_dwordx4 v2, s[24:27], s46 offen sc1 lds
    buffer_load_dwordx4 v2, s[24:27], s46 offen offset:1024 sc1 lds
    s_add_u32 m0, s44, 18432
    s_nop 0
    buffer_load_dwordx4 v2, s[28:31], s47 offen  lds
    buffer_load_dwordx4 v2, s[28:31], s47 offen offset:1024  lds
    s_add_u32 m0, s50, 18432
    s_cmp_lt_u32 s19, 1
    s_cbranch_scc0 L_m_g129
    buffer_load_dwordx4 v3, s[28:31], s47 offen  lds
L_m_g129:
    v_readlane_b32 s46, v6, s40
    v_readlane_b32 s47, v7, s40
    s_add_u32 s40, s40, 1
    s_nop 0
    s_waitcnt vmcnt(16)
    s_barrier
    s_add_u32 m0, s43, 24576
    s_nop 0
    buffer_load_dwordx4 v2, s[24:27], s46 offen sc1 lds
    buffer_load_dwordx4 v2, s[24:27], s46 offen offset:1024 sc1 lds
    s_add_u32 m0, s44, 27648
    s_nop 0
    buffer_load_dwordx4 v2, s[28:31], s47 offen  lds
    buffer_load_dwordx4 v2, s[28:31], s47 offen offset:1024  lds
    s_add_u32 m0, s50, 27648
    s_cmp_lt_u32 s19, 1
    s_cbranch_scc0 L_m_g130
    buffer_load_dwordx4 v3, s[28:31], s47 offen  lds
L_m_g130:
    v_readlane_b32 s46, v6, s40
    v_readlane_b32 s47, v7, s40
    s_add_u32 s40, s40, 1
    s_nop 0
    s_mov_b32 s42, 4
L_m_ld131:
    s_waitcnt vmcnt(16)
    s_barrier
    s_add_u32 m0, s43, 32768
    s_nop 0
    buffer_load_dwordx4 v2, s[24:27], s46 offen sc1 lds
    buffer_load_dwordx4 v2, s[24:27], s46 offen offset:1024 sc1 lds
    s_add_u32 m0, s44, 36864
    s_nop 0
    buffer_load_dwordx4 v2, s[28:31], s47 offen  lds
    buffer_load_dwordx4 v2, s[28:31], s47 offen offset:1024  lds
    s_add_u32 m0, s50, 36864
    s_cmp_lt_u32 s19, 1
    s_cbranch_scc0 L_m_g132
    buffer_load_dwordx4 v3, s[28:31], s47 offen  lds
L_m_g132:
    v_readlane_b32 s46, v6, s40
    v_readlane_b32 s47, v7, s40
    s_add_u32 s40, s40, 1
    s_nop 0
    s_waitcnt vmcnt(16)
    s_barrier
    s_add_u32 m0, s43, 40960
    s_nop 0
    buffer_load_dwordx4 v2, s[24:27], s46 offen sc1 lds
    buffer_load_dwordx4 v2, s[24:27], s46 offen offset:1024 sc1 lds
    s_add_u32 m0, s44, 46080
    s_nop 0
    buffer_load_dwordx4 v2, s[28:31], s47 offen  lds
    buffer_load_dwordx4 v2, s[28:31], s47 offen offset:1024  lds
    s_add_u32 m0, s50, 46080
    s_cmp_lt_u32 s19, 1
    s_cbranch_scc0 L_m_g133
    buffer_load_dwordx4 v3, s[28:31], s47 offen  lds
L_m_g133:
    v_readlane_b32 s46, v6, s40
    v_readlane_b32 s47, v7, s40
    s_add_u32 s40, s40, 1
    s_nop 0
    s_waitcnt vmcnt(16)
    s_barrier
    s_add_u32 m0, s43, 0
    s_nop 0
    buffer_load_dwordx4 v2, s[24:27], s46 offen sc1 lds
    buffer_load_dwordx4 v2, s[24:27], s46 offen offset:1024 sc1 lds
    s_add_u32 m0, s44, 0
    s_nop 0
    buffer_load_dwordx4 v2, s[28:31], s47 offen  lds
    buffer_load_dwordx4 v2, s[28:31], s47 offen offset:1024  lds
    s_add_u32 m0, s50, 0
    s_cmp_lt_u32 s19, 1
    s_cbranch_scc0 L_m_g134
    buffer_load_dwordx4 v3, s[28:31], s47 offen  lds
L_m_g134:
    v_readlane_b32 s46, v6, s40
    v_readlane_b32 s47, v7, s40
    s_add_u32 s40, s40, 1
    s_nop 0
    s_waitcnt vmcnt(16)
    s_barrier
    s_add_u32 m0, s43, 8192
    s_nop 0
    buffer_load_dwordx4 v2, s[24:27], s46 offen sc1 lds
    buffer_load_dwordx4 v2, s[24:27], s46 offen offset:1024 sc1 lds
    s_add_u32 m0, s44, 9216
    s_nop 0
    buffer_load_dwordx4 v2, s[28:31], s47 offen  lds
    buffer_load_dwordx4 v2, s[28:31], s47 offen offset:1024  lds
    s_add_u32 m0, s50, 9216
    s_cmp_lt_u32 s19, 1
    s_cbranch_scc0 L_m_g135
    buffer_load_dwordx4 v3, s[28:31], s47 offen  lds
L_m_g135:
    v_readlane_b32 s46, v6, s40
    v_readlane_b32 s47, v7, s40
    s_add_u32 s40, s40, 1
    s_nop 0
    s_waitcnt vmcnt(16)
    s_barrier
    s_add_u32 m0, s43, 16384
    s_nop 0
    buffer_load_dwordx4 v2, s[24:27], s46 offen sc1 lds
    buffer_load_dwordx4 v2, s[24:27], s46 offen offset:1024 sc1 lds
    s_add_u32 m0, s44, 18432
    s_nop 0
    buffer_load_dwordx4 v2, s[28:31], s47 offen  lds
    buffer_load_dwordx4 v2, s[28:31], s47 offen offset:1024  lds
    s_add_u32 m0, s50, 18432
    s_cmp_lt_u32 s19, 1
    s_cbranch_scc0 L_m_g136
    buffer_load_dwordx4 v3, s[28:31], s47 offen  lds
L_m_g136:
    v_readlane_b32 s46, v6, s40
    v_readlane_b32 s47, v7, s40
    s_add_u32 s40, s40, 1
    s_nop 0
    s_waitcnt vmcnt(16)
    s_barrier
    s_add_u32 m0, s43, 24576
    s_nop 0
    buffer_load_dwordx4 v2, s[24:27], s46 offen sc1 lds
    buffer_load_dwordx4 v2, s[24:27], s46 offen offset:1024 sc1 lds
    s_add_u32 m0, s44, 27648
    s_nop 0
    buffer_load_dwordx4 v2, s[28:31], s47 offen  lds
    buffer_load_dwordx4 v2, s[28:31], s47 offen offset:1024  lds
    s_add_u32 m0, s50, 27648
    s_cmp_lt_u32 s19, 1
    s_cbranch_scc0 L_m_g137
    buffer_load_dwordx4 v3, s[28:31], s47 offen  lds
L_m_g137:
    v_readlane_b32 s46, v6, s40
    v_readlane_b32 s47, v7, s40
    s_add_u32 s40, s40, 1
    s_nop 0
    s_sub_u32 s42, s42, 1
    s_cmp_lg_u32 s42, 0
    s_cbranch_scc1 L_m_ld131
    s_waitcnt vmcnt(16)
    s_barrier
    s_add_u32 m0, s43, 32768
    s_nop 0
    buffer_load_dwordx4 v2, s[24:27], s46 offen sc1 lds
    buffer_load_dwordx4 v2, s[24:27], s46 offen offset:1024 sc1 lds
    s_add_u32 m0, s44, 36864
    s_nop 0
    buffer_load_dwordx4 v2, s[28:31], s47 offen  lds
    buffer_load_dwordx4 v2, s[28:31], s47 offen offset:1024  lds
    s_add_u32 m0, s50, 36864
    s_cmp_lt_u32 s19, 1
    s_cbranch_scc0 L_m_g138
    buffer_load_dwordx4 v3, s[28:31], s47 offen  lds
L_m_g138:
    v_readlane_b32 s46, v6, s40
    v_readlane_b32 s47, v7, s40
    s_add_u32 s40, s40, 1
    s_nop 0
    s_waitcnt vmcnt(16)
    s_barrier
    s_add_u32 m0, s43, 40960
    s_nop 0
    buffer_load_dwordx4 v2, s[24:27], s46 offen sc1 lds
    buffer_load_dwordx4 v2, s[24:27], s46 offen offset:1024 sc1 lds
    s_add_u32 m0, s44, 46080
    s_nop 0
    buffer_load_dwordx4 v2, s[28:31], s47 offen  lds
    buffer_load_dwordx4 v2, s[28:31], s47 offen offset:1024  lds
    s_add_u32 m0, s50, 46080
    s_cmp_lt_u32 s19, 1
    s_cbranch_scc0 L_m_g139
    buffer_load_dwordx4 v3, s[28:31], s47 offen  lds
L_m_g139:
    v_readlane_b32 s46, v6, s40
    v_readlane_b32 s47, v7, s40
    s_add_u32 s40, s40, 1
    s_nop 0
    s_waitcnt vmcnt(16)
    s_barrier
    s_waitcnt vmcnt(12)
    s_barrier
    s_waitcnt vmcnt(8)
    s_barrier
    s_waitcnt vmcnt(4)
    s_barrier
    s_waitcnt vmcnt(0)
    s_barrier
    s_barrier
    s_branch L_p6_end
L_p6_cons:
L_p6_np:
    s_setprio 1
    s_and_b32 s16, s19, 1
    s_xor_b32 s12, s19, 1
    s_lshl_b32 s13, s16, 10
    v_lshlrev_b32 v6, 4, v1
    v_add_u32 v7, s13, v6
    s_lshl_b32 s14, s19, 11
    s_lshl_b32 s15, s12, 11
    s_add_u32 s14, s14, 0
    s_add_u32 s15, s15, 0
    v_add_u32 v2, s14, v7
    v_add_u32 v3, s15, v7
    v_add_u32 v4, 65536, v7
    v_lshrrev_b32 v8, 4, v1
    v_and_b32 v9, 15, v1
    v_and_b32 v10, 7, v1
    v_lshlrev_b32 v10, 4, v10
    v_lshl_add_u32 v10, v8, 7, v10
    s_lshl_b32 s13, s16, 9
    s_add_u32 s13, s13, 73728
    v_add_u32 v5, s13, v10
    s_mul_i32 s14, s19, 5120
    s_mul_i32 s15, s12, 5120
    s_add_u32 s14, s14, 139264
    s_add_u32 s15, s15, 139264
    v_add_u32 v12, s14, v6
    v_add_u32 v13, s15, v6
    s_lshl_b32 s10, s21, 2
    s_add_u32 s17, s10, s19
    s_mul_i32 s44, s22, 288
    s_add_u32 s44, s44, 11520
    v_lshlrev_b32 v11, 4, v8
    s_mul_i32 s45, s17, 18432
    s_mul_i32 s10, s22, 2304
    s_add_u32 s45, s45, s10
    v_and_b32 v14, 1, v8
    v_lshrrev_b32 v15, 1, v8
    v_lshlrev_b32 v15, 8, v15
    v_lshl_add_u32 v15, v9, 4, v15
    s_mov_b32 s24, s92
    s_mov_b32 s25, s93
    s_mov_b32 s26, 13824
    s_mov_b32 s27, 0x20000
    s_add_u32 s28, s92, 11960320
    s_addc_u32 s29, s93, 0
    s_mov_b32 s30, 2359296
    s_mov_b32 s31, 0x20000
    buffer_load_dwordx4 v[112:115], v11, s[24:27], s44 offen offset:0 sc1
    buffer_load_dwordx4 v[116:119], v11, s[24:27], s44 offen offset:64 sc1
    buffer_load_dwordx4 v[120:123], v11, s[24:27], s44 offen offset:128 sc1
    buffer_load_dwordx4 v[124:127], v11, s[24:27], s44 offen offset:192 sc1
    buffer_load_dwordx4 v[128:131], v11, s[24:27], s44 offen offset:256 sc1
    v_lshl_add_u32 v11, v14, 3, v15
    buffer_load_dwordx2 v[132:133], v11, s[28:31], s45 offen offset:0 sc1
    buffer_load_dwordx2 v[134:135], v11, s[28:31], s45 offen offset:512 sc1
    buffer_load_dwordx2 v[136:137], v11, s[28:31], s45 offen offset:1024 sc1
    buffer_load_dwordx2 v[138:139], v11, s[28:31], s45 offen offset:1536 sc1
    buffer_load_dwordx2 v[140:141], v11, s[28:31], s45 offen offset:2048 sc1
    s_mov_b32 s37, 0
    s_mov_b32 s40, 4294926336
    s_mov_b32 s41, 4294921216
    s_waitcnt lgkmcnt(0)
    s_barrier
    ds_read_b128 v[56:59], v2 offset:0
    ds_read_b128 v[64:67], v4 offset:0
    ds_read_b128 v[60:63], v3 offset:0
    ds_read_b128 v[68:71], v4 offset:2048
    ds_read_b128 v[72:75], v4 offset:4096
    ds_read_b128 v[76:79], v4 offset:6144
    ds_read_b128 v[80:83], v5 offset:0
    s_add_u32 s37, s37, 1
    s_cmp_eq_u32 s37, 6
    s_cselect_b32 s37, 0, s37
    s_cselect_b32 s38, s40, 8192
    s_cselect_b32 s39, s41, 9216
    v_add_u32 v2, s38, v2
    v_add_u32 v3, s38, v3
    v_add_u32 v4, s39, v4
    v_add_u32 v5, s39, v5
    s_waitcnt lgkmcnt(5)
    v_mfma_f32_16x16x32_bf16 v[16:19], v[64:67], v[56:59], 0
    s_waitcnt lgkmcnt(0)
    s_barrier
    ds_read_b128 v[84:87], v2 offset:0
    ds_read_b128 v[92:95], v4 offset:0
    v_mfma_f32_16x16x32_bf16 v[36:39], v[64:67], v[60:63], 0
    ds_read_b128 v[88:91], v3 offset:0
    ds_read_b128 v[96:99], v4 offset:2048
    v_mfma_f32_16x16x32_bf16 v[40:43], v[68:71], v[60:63], 0
    ds_read_b128 v[100:103], v4 offset:4096
    ds_read_b128 v[104:107], v4 offset:6144
    v_mfma_f32_16x16x32_bf16 v[20:23], v[68:71], v[56:59], 0
    ds_read_b128 v[108:111], v5 offset:0
    v_mfma_f32_16x16x32_bf16 v[24:27], v[72:75], v[56:59], 0
    s_add_u32 s37, s37, 1
    s_cmp_eq_u32 s37, 6
    s_cselect_b32 s37, 0, s37
    v_mfma_f32_16x16x32_bf16 v[44:47], v[72:75], v[60:63], 0
    s_cselect_b32 s38, s40, 8192
    s_cselect_b32 s39, s41, 9216
    v_mfma_f32_16x16x32_bf16 v[48:51], v[76:79], v[60:63], 0
    v_add_u32 v2, s38, v2
    v_mfma_f32_16x16x32_bf16 v[28:31], v[76:79], v[56:59], 0
    v_add_u32 v3, s38, v3
    v_mfma_f32_16x16x32_bf16 v[32:35], v[80:83], v[56:59], 0
    v_add_u32 v4, s39, v4
    v_mfma_f32_16x16x32_bf16 v[52:55], v[80:83], v[60:63], 0
    v_add_u32 v5, s39, v5
    s_mov_b32 s36, 17
.p2align 3
L_m_mm140:
    s_waitcnt lgkmcnt(5)
    v_mfma_f32_16x16x32_bf16 v[16:19], v[92:95], v[84:87], v[16:19]
    s_waitcnt lgkmcnt(0)
    s_barrier
    ds_read_b128 v[56:59], v2 offset:0
    ds_read_b128 v[64:67], v4 offset:0
    v_mfma_f32_16x16x32_bf16 v[36:39], v[92:95], v[88:91], v[36:39]
    ds_read_b128 v[60:63], v3 offset:0
    ds_read_b128 v[68:71], v4 offset:2048
    v_mfma_f32_16x16x32_bf16 v[40:43], v[96:99], v[88:91], v[40:43]
    ds_read_b128 v[72:75], v4 offset:4096
    ds_read_b128 v[76:79], v4 offset:6144
    v_mfma_f32_16x16x32_bf16 v[20:23], v[96:99], v[84:87], v[20:23]
    ds_read_b128 v[80:83], v5 offset:0
    v_mfma_f32_16x16x32_bf16 v[24:27], v[100:103], v[84:87], v[24:27]
    s_add_u32 s37, s37, 1
    s_cmp_eq_u32 s37, 6
    s_cselect_b32 s37, 0, s37
    v_mfma_f32_16x16x32_bf16 v[44:47], v[100:103], v[88:91], v[44:47]
    s_cselect_b32 s38, s40, 8192
    s_cselect_b32 s39, s41, 9216
    v_mfma_f32_16x16x32_bf16 v[48:51], v[104:107], v[88:91], v[48:51]
    v_add_u32 v2, s38, v2
    v_mfma_f32_16x16x32_bf16 v[28:31], v[104:107], v[84:87], v[28:31]
    v_add_u32 v3, s38, v3
    v_mfma_f32_16x16x32_bf16 v[32:35], v[108:111], v[84:87], v[32:35]
    v_add_u32 v4, s39, v4
    v_mfma_f32_16x16x32_bf16 v[52:55], v[108:111], v[88:91], v[52:55]
    v_add_u32 v5, s39, v5
    s_waitcnt lgkmcnt(5)
    v_mfma_f32_16x16x32_bf16 v[16:19], v[64:67], v[56:59], v[16:19]
    s_waitcnt lgkmcnt(0)
    s_barrier
    ds_read_b128 v[84:87], v2 offset:0
    ds_read_b128 v[92:95], v4 offset:0
    v_mfma_f32_16x16x32_bf16 v[36:39], v[64:67], v[60:63], v[36:39]
    ds_read_b128 v[88:91], v3 offset:0
    ds_read_b128 v[96:99], v4 offset:2048
    v_mfma_f32_16x16x32_bf16 v[40:43], v[68:71], v[60:63], v[40:43]
    ds_read_b128 v[100:103], v4 offset:4096
    ds_read_b128 v[104:107], v4 offset:6144
    v_mfma_f32_16x16x32_bf16 v[20:23], v[68:71], v[56:59], v[20:23]
    ds_read_b128 v[108:111], v5 offset:0
    v_mfma_f32_16x16x32_bf16 v[24:27], v[72:75], v[56:59], v[24:27]
    s_add_u32 s37, s37, 1
    s_cmp_eq_u32 s37, 6
    s_cselect_b32 s37, 0, s37
    v_mfma_f32_16x16x32_bf16 v[44:47], v[72:75], v[60:63], v[44:47]
    s_cselect_b32 s38, s40, 8192
    s_cselect_b32 s39, s41, 9216
    v_mfma_f32_16x16x32_bf16 v[48:51], v[76:79], v[60:63], v[48:51]
    v_add_u32 v2, s38, v2
    v_add_u32 v3, s38, v3
    v_mfma_f32_16x16x32_bf16 v[28:31], v[76:79], v[56:59], v[28:31]
    v_add_u32 v4, s39, v4
    v_add_u32 v5, s39, v5
    v_mfma_f32_16x16x32_bf16 v[32:35], v[80:83], v[56:59], v[32:35]
    s_sub_u32 s36, s36, 1
    v_mfma_f32_16x16x32_bf16 v[52:55], v[80:83], v[60:63], v[52:55]
    s_cmp_lg_u32 s36, 0
    s_cbranch_scc1 L_m_mm140
    s_waitcnt lgkmcnt(5)
    v_mfma_f32_16x16x32_bf16 v[16:19], v[92:95], v[84:87], v[16:19]
    s_waitcnt lgkmcnt(4)
    v_mfma_f32_16x16x32_bf16 v[36:39], v[92:95], v[88:91], v[36:39]
    s_waitcnt lgkmcnt(3)
    v_mfma_f32_16x16x32_bf16 v[40:43], v[96:99], v[88:91], v[40:43]
    v_mfma_f32_16x16x32_bf16 v[20:23], v[96:99], v[84:87], v[20:23]
    s_waitcnt lgkmcnt(2)
    v_mfma_f32_16x16x32_bf16 v[24:27], v[100:103], v[84:87], v[24:27]
    v_mfma_f32_16x16x32_bf16 v[44:47], v[100:103], v[88:91], v[44:47]
    s_waitcnt lgkmcnt(1)
    v_mfma_f32_16x16x32_bf16 v[48:51], v[104:107], v[88:91], v[48:51]
    v_mfma_f32_16x16x32_bf16 v[28:31], v[104:107], v[84:87], v[28:31]
    s_waitcnt lgkmcnt(0)
    v_mfma_f32_16x16x32_bf16 v[32:35], v[108:111], v[84:87], v[32:35]
    v_mfma_f32_16x16x32_bf16 v[52:55], v[108:111], v[88:91], v[52:55]
    s_nop 7
    ds_write_b128 v12, v[36:39] offset:0
    ds_write_b128 v12, v[40:43] offset:1024
    ds_write_b128 v12, v[44:47] offset:2048
    ds_write_b128 v12, v[48:51] offset:3072
    ds_write_b128 v12, v[52:55] offset:4096
    s_waitcnt lgkmcnt(0)
    s_barrier
    ds_read_b128 v[56:59], v13 offset:0
    ds_read_b128 v[60:63], v13 offset:1024
    ds_read_b128 v[64:67], v13 offset:2048
    ds_read_b128 v[68:71], v13 offset:3072
    ds_read_b128 v[72:75], v13 offset:4096
    s_mul_i32 s10, s19, 2304
    s_add_u32 s10, s10, 49152
    v_mul_u32_u24 v10, 144, v9
    v_lshl_add_u32 v10, v8, 3, v10
    v_add_u32 v10, s10, v10
    s_waitcnt vmcnt(0) lgkmcnt(0)
    v_pk_add_f32 v[16:17], v[16:17], v[56:57]
    v_pk_add_f32 v[20:21], v[20:21], v[60:61]
    v_pk_add_f32 v[24:25], v[24:25], v[64:65]
    v_pk_add_f32 v[28:29], v[28:29], v[68:69]
    v_pk_add_f32 v[32:33], v[32:33], v[72:73]
    v_pk_add_f32 v[18:19], v[18:19], v[58:59]
    v_pk_add_f32 v[22:23], v[22:23], v[62:63]
    v_pk_add_f32 v[26:27], v[26:27], v[66:67]
    v_pk_add_f32 v[30:31], v[30:31], v[70:71]
    v_pk_add_f32 v[34:35], v[34:35], v[74:75]
    v_lshlrev_b32 v84, 16, v132
    v_lshlrev_b32 v88, 16, v134
    v_lshlrev_b32 v92, 16, v136
    v_lshlrev_b32 v96, 16, v138
    v_lshlrev_b32 v100, 16, v140
    v_and_b32 v85, 0xffff0000, v132
    v_and_b32 v89, 0xffff0000, v134
    v_and_b32 v93, 0xffff0000, v136
    v_and_b32 v97, 0xffff0000, v138
    v_and_b32 v101, 0xffff0000, v140
    v_lshlrev_b32 v86, 16, v133
    v_lshlrev_b32 v90, 16, v135
    v_lshlrev_b32 v94, 16, v137
    v_lshlrev_b32 v98, 16, v139
    v_lshlrev_b32 v102, 16, v141
    v_and_b32 v87, 0xffff0000, v133
    v_and_b32 v91, 0xffff0000, v135
    v_and_b32 v95, 0xffff0000, v137
    v_and_b32 v99, 0xffff0000, v139
    v_and_b32 v103, 0xffff0000, v141
    v_pk_fma_f32 v[16:17], v[16:17], v[112:113], v[84:85]
    v_pk_fma_f32 v[20:21], v[20:21], v[116:117], v[88:89]
    v_pk_fma_f32 v[24:25], v[24:25], v[120:121], v[92:93]
    v_pk_fma_f32 v[28:29], v[28:29], v[124:125], v[96:97]
    v_pk_fma_f32 v[32:33], v[32:33], v[128:129], v[100:101]
    v_pk_fma_f32 v[18:19], v[18:19], v[114:115], v[86:87]
    v_pk_fma_f32 v[22:23], v[22:23], v[118:119], v[90:91]
    v_pk_fma_f32 v[26:27], v[26:27], v[122:123], v[94:95]
    v_pk_fma_f32 v[30:31], v[30:31], v[126:127], v[98:99]
    v_pk_fma_f32 v[34:35], v[34:35], v[130:131], v[102:103]
    v_cvt_pk_bf16_f32 v144, v16, v17
    v_cvt_pk_bf16_f32 v146, v20, v21
    v_cvt_pk_bf16_f32 v148, v24, v25
    v_cvt_pk_bf16_f32 v150, v28, v29
    v_cvt_pk_bf16_f32 v152, v32, v33
    v_cvt_pk_bf16_f32 v145, v18, v19
    v_cvt_pk_bf16_f32 v147, v22, v23
    v_cvt_pk_bf16_f32 v149, v26, v27
    v_cvt_pk_bf16_f32 v151, v30, v31
    v_cvt_pk_bf16_f32 v153, v34, v35
    ds_write_b64 v10, v[144:145] offset:0
    ds_write_b64 v10, v[146:147] offset:32
    ds_write_b64 v10, v[148:149] offset:64
    ds_write_b64 v10, v[150:151] offset:96
    s_mov_b32 exec_hi, 0
    ds_write_b64 v10, v[152:153] offset:128
    s_mov_b32 exec_hi, -1
    s_mov_b32 s24, s88
    s_mov_b32 s25, s89
    s_mov_b32 s26, 2359296
    s_mov_b32 s27, 0x20000
    v_add_u32 v12, s10, v6
    s_mul_i32 s10, s17, 18432
    s_mul_i32 s11, s22, 144
    s_add_u32 s10, s10, s11
    s_waitcnt lgkmcnt(0)
    ds_read_b128 v[56:59], v12 offset:0
    ds_read_b128 v[60:63], v12 offset:1024
    ds_read_b128 v[64:67], v12 offset:2048
    v_add_u32 v20, 0, v1
    v_mul_u32_u24 v21, 7282, v20
    v_lshrrev_b32 v21, 16, v21
    v_mul_u32_u24 v23, 9, v21
    v_sub_u32 v22, v20, v23
    v_mul_u32_u24 v21, 1152, v21
    v_lshl_add_u32 v24, v22, 4, v21
    v_add_u32 v20, 64, v1
    v_mul_u32_u24 v21, 7282, v20
    v_lshrrev_b32 v21, 16, v21
    v_mul_u32_u24 v23, 9, v21
    v_sub_u32 v22, v20, v23
    v_mul_u32_u24 v21, 1152, v21
    v_lshl_add_u32 v25, v22, 4, v21
    v_add_u32 v20, 128, v1
    v_mul_u32_u24 v21, 7282, v20
    v_lshrrev_b32 v21, 16, v21
    v_mul_u32_u24 v23, 9, v21
    v_sub_u32 v22, v20, v23
    v_mul_u32_u24 v21, 1152, v21
    v_lshl_add_u32 v26, v22, 4, v21
    s_waitcnt lgkmcnt(0)
    buffer_store_dwordx4 v[56:59], v24, s[24:27], s10 offen
    buffer_store_dwordx4 v[60:63], v25, s[24:27], s10 offen
    s_mov_b64 exec, 0xffff
    buffer_store_dwordx4 v[64:67], v26, s[24:27], s10 offen
    s_mov_b64 exec, -1
L_p6_end:
L_end:
    s_endpgm
.section .rodata,"a"
.p2align 6
.amdhsa_kernel adaLN_cond__softmax_full_mha__mixer_gmlp__prompt_kernel
  .amdhsa_next_free_vgpr 256
  .amdhsa_next_free_sgpr 102
  .amdhsa_accum_offset 256
  .amdhsa_group_segment_fixed_size 0
  .amdhsa_kernarg_size 104
  .amdhsa_user_sgpr_count 2
  .amdhsa_user_sgpr_kernarg_segment_ptr 1
  .amdhsa_system_sgpr_workgroup_id_x 1
.end_amdhsa_kernel
```
